```python
import torch

def _softmax(x, axis=-1):
    return torch.softmax(x, dim=axis)
def _gelu(x):
    return torch.nn.functional.gelu(x, approximate="tanh")
def _silu(x):
    return torch.nn.functional.silu(x)
def _sigmoid(x):
    return torch.sigmoid(x)
def _layernorm(x, axis=-1, eps=1e-5):
    m = x.mean(dim=axis, keepdim=True)
    v = x.var(dim=axis, keepdim=True, unbiased=False)
    return (x - m) / torch.sqrt(v + eps)
def _scatter_add(tgt, idx, src, axis=0):
    return tgt.clone().index_add_(axis, idx, src)
def _segment_sum(src, seg, n):
    out = torch.zeros((n,) + src.shape[1:], dtype=src.dtype)
    return out.index_add_(0, seg, src)
def _pad(x, pw):
    flat = tuple(v for pair in reversed(pw) for v in pair)
    return torch.nn.functional.pad(x, flat)

kernel_name = 'recurrent_scan__sliding_local_dilated__swiglu_ffn__prompt'

def setup_inputs():

    _w = (lambda a: (lambda t: t.to(torch.bfloat16) if t.is_floating_point() else t)(torch.as_tensor(a)))
    def _A_setup():
        B, S, D = 1, 2048, 576
        return {
            "x": _w((lambda *s: torch.randn(*s, dtype=torch.bfloat16) * 0.05)(B, S, D)),
            "wqkv": _w((lambda *s: torch.randn(*s, dtype=torch.bfloat16) * 0.05)(D, 3 * D)),
            "wo": _w((lambda *s: torch.randn(*s, dtype=torch.bfloat16) * 0.05)(D, D)),
        }
    _A_in = _A_setup()

    def _B_setup():
        B, S, D, F = 1, 2048, 576, 4608
        return {
            "x": _w((lambda *s: torch.randn(*s, dtype=torch.bfloat16) * 0.05)(B, S, D)),
            "w_gate": _w((lambda *s: torch.randn(*s, dtype=torch.bfloat16) * 0.05)(D, F)),
            "w_up": _w((lambda *s: torch.randn(*s, dtype=torch.bfloat16) * 0.05)(D, F)),
            "w_down": _w((lambda *s: torch.randn(*s, dtype=torch.bfloat16) * 0.05)(F, D)),
        }
    _B_in = _B_setup()

    return {
        "A_x": _A_in["x"],
        "A_wqkv": _A_in["wqkv"],
        "A_wo": _A_in["wo"],
        "B_x": _B_in["x"],
        "B_w_gate": _B_in["w_gate"],
        "B_w_up": _B_in["w_up"],
        "B_w_down": _B_in["w_down"],
    }

def reference(A_x, A_wqkv, A_wo, B_x, B_w_gate, B_w_up, B_w_down):
    def _A_ref(x, wqkv, wo):
        B, S, D = x.shape
        H = 32; Dh = D // H
        W, dil = 8, 2
        qkv = (lambda x, *d: x.permute(*d))((x @ wqkv).reshape(B, S, 3, H, Dh), 2, 0, 3, 1, 4)
        q, k, v = qkv[0], qkv[1], qkv[2]
        scale = Dh ** -0.5
        pos = torch.arange(S)
        off = torch.arange(W) * dil
        idx = pos[:, None] - off[None, :]
        mask = idx >= 0
        idx_c = torch.where(mask, idx, 0).reshape(-1)
        kg = k[:, :, idx_c, :].reshape(B, H, S, W, Dh)
        vg = v[:, :, idx_c, :].reshape(B, H, S, W, Dh)
        logits = torch.einsum("bhsd,bhswd->bhsw", q, kg) * scale
        logits = torch.where(mask[None, None, :, :], logits, -1e9)
        attn = _softmax(logits, axis=-1)
        o = torch.einsum("bhsw,bhswd->bhsd", attn, vg)
        return (lambda x, *d: x.permute(*d))(o, 0, 2, 1, 3).reshape(B, S, D) @ wo

    def _B_ref(x, w_gate, w_up, w_down):
        g = _silu(x @ w_gate)
        u = x @ w_up
        return (g * u) @ w_down

    x = A_x
    xn = _layernorm(x, axis=-1)
    s = _A_ref(xn, A_wqkv, A_wo)
    g = _silu(_B_ref(xn, B_w_gate, B_w_up, B_w_down))
    return x + s * g
```

```asm
; @launch grid=(256,1,1) block=(256,1,1) lds=163840
.amdgcn_target "amdgcn-amd-amdhsa--gfx950"
.text
    .globl recurrent_scan__sliding_local_dilated__swiglu_ffn__prompt_kernel
    .p2align 8
    .type recurrent_scan__sliding_local_dilated__swiglu_ffn__prompt_kernel,@function
recurrent_scan__sliding_local_dilated__swiglu_ffn__prompt_kernel:
    s_cmp_ge_u32 s2, 256
    s_cbranch_scc1 KF_end
    s_load_dwordx2 s[92:93], s[0:1], 0
    s_load_dwordx2 s[4:5], s[0:1], 8
    s_load_dwordx4 s[8:11], s[0:1], 32
    s_load_dwordx2 s[20:21], s[0:1], 72
    s_load_dwordx2 s[28:29], s[0:1], 64
    s_load_dwordx2 s[88:89], s[0:1], 16
    s_load_dwordx2 s[90:91], s[0:1], 48
    s_memrealtime s[24:25]
    v_lshrrev_b32 v1, 6, v0
    v_and_b32 v0, 63, v0
    s_bfe_u32 s30, s2, 0x20001
    s_lshl_b32 s30, s30, 1
    s_bfe_u32 s31, s2, 0x10005
    s_add_u32 s30, s30, s31
    s_bfe_u32 s31, s2, 0x20003
    s_and_b32 s32, s2, 1
    s_lshl_b32 s32, s32, 2
    s_lshr_b32 s3, s2, 6
    s_add_u32 s32, s32, s3
    v_readfirstlane_b32 s33, v1
    s_mov_b32 s22, 0x10000000
    s_mov_b32 s23, 0x20000
    s_mov_b32 s40, 0xbfb8aa3b
    s_mov_b32 s41, 0xffff0000
    s_lshl_b32 s35, s30, 2
    s_add_u32 s35, s35, s31
    s_lshr_b32 s36, s35, 1
    s_lshl_b32 s37, s32, 4
    s_add_u32 s36, s36, s37
    s_and_b32 s37, s35, 1
    s_lshl_b32 s38, s36, 4
    s_add_u32 s38, s38, s37
    v_and_b32 v79, 7, v0
    v_lshl_add_u32 v77, v79, 1, s38
    v_mul_u32_u24 v80, 1152, v77
    v_lshrrev_b32 v81, 3, v0
    v_lshl_add_u32 v77, v81, 4, v80
    s_mul_i32 s38, s33, 384
    s_mov_b32 s94, 2359296
    s_mov_b32 s95, 0x20000
    s_waitcnt lgkmcnt(0)
    s_cmp_eq_u32 s33, 3
    s_cbranch_scc1 LN_nold
    buffer_load_dwordx4 v[64:67], v77, s[92:95], s38 offen
    buffer_load_dwordx4 v[68:71], v77, s[92:95], s38 offen offset:128
    buffer_load_dwordx4 v[72:75], v77, s[92:95], s38 offen offset:256
    s_add_u32 s38, s38, 384
    s_cmp_eq_u32 s38, 1152
    s_cselect_b32 s38, 0, s38
    buffer_load_dwordx4 v[120:123], v77, s[92:95], s38 offen
    buffer_load_dwordx4 v[124:127], v77, s[92:95], s38 offen offset:128
    buffer_load_dwordx4 v[128:131], v77, s[92:95], s38 offen offset:256
    s_add_u32 s38, s38, 384
    s_cmp_eq_u32 s38, 1152
    s_cselect_b32 s38, 0, s38
    buffer_load_dwordx4 v[132:135], v77, s[92:95], s38 offen
    buffer_load_dwordx4 v[136:139], v77, s[92:95], s38 offen offset:128
    buffer_load_dwordx4 v[140:143], v77, s[92:95], s38 offen offset:256
LN_nold:
    s_mul_i32 s36, s36, 18432
    s_lshl_b32 s37, s37, 7
    s_add_u32 s36, s36, s37
    s_mul_i32 s37, s33, 6144
    s_add_u32 s96, s36, s37
    s_add_u32 s97, s96, 4096
    v_lshlrev_b32 v78, 8, v81
    v_lshl_add_u32 v78, v79, 4, v78
    s_lshl_b32 s6, s32, 5
    s_add_u32 s6, s6, s35
    s_lshl_b32 s6, s6, 2
    s_add_u32 s6, s6, s33
    s_lshl_b32 s6, s6, 2
    s_add_u32 s6, s6, 50352128
    v_mov_b32 v2, 0
    s_or_b32 s3, s2, s33
    s_cmp_lg_u32 s3, 0
    s_cbranch_scc1 KF_noep
    s_and_b32 s24, s24, 0xfffffffc
    s_max_u32 s24, s24, 4
    v_mov_b32 v3, s24
    global_store_dword v2, v3, s[28:29] sc1
KF_noep:
    s_lshl_b32 s66, s33, 10
    s_mul_i32 s62, s30, 3
    s_add_u32 s62, s62, s31
    s_lshl_b32 s62, s62, 7
    s_add_u32 s64, s30, 44
    s_lshl_b32 s64, s64, 6
    s_cmp_lt_u32 s31, 3
    s_cselect_b32 s63, 1, 0
    s_cmp_lt_u32 s30, 6
    s_cbranch_scc1 KF_qok
    s_lshl_b32 s62, s30, 1
    s_add_u32 s62, s62, s31
    s_add_u32 s64, s62, 36
    s_lshl_b32 s64, s64, 6
    s_add_u32 s62, s62, 6
    s_lshl_b32 s62, s62, 7
    s_cmp_lt_u32 s31, 2
    s_cselect_b32 s63, 1, 0
KF_qok:
    s_cmp_eq_u32 s63, 1
    s_cselect_b32 s62, s62, s64
    s_cselect_b32 s67, 3, 1
    s_mov_b32 s64, s63
    s_mov_b32 s65, 0
    s_mul_i32 s36, s30, 1152
    s_lshl_b32 s37, s31, 8
    s_add_u32 s37, s37, s36
    s_lshl_b32 s38, s31, 6
    s_add_u32 s38, s38, s36
    s_add_u32 s38, s38, 896
    s_add_u32 s16, s8, s37
    s_addc_u32 s17, s9, 0
    s_add_u32 s18, s10, s37
    s_addc_u32 s19, s11, 0
    v_bfe_u32 v225, v0, 1, 2
    v_bfe_u32 v226, v0, 4, 1
    v_xor_b32 v225, v225, v226
    v_and_b32 v226, 1, v0
    v_lshlrev_b32 v226, 4, v226
    v_lshrrev_b32 v224, 3, v0
    s_add_u32 s60, s4, s62
    s_addc_u32 s61, s5, 0
    v_add_u32 v152, 0, v224
    v_xor_b32 v153, 0, v225
    v_mul_u32_u24 v144, 9216, v152
    v_lshl_add_u32 v144, v153, 5, v144
    v_add_u32 v144, v144, v226
    v_and_b32 v153, s67, v153
    v_mul_u32_u24 v148, 3456, v152
    v_lshl_add_u32 v148, v153, 5, v148
    v_add_u32 v148, v148, v226
    v_add_u32 v152, 8, v224
    v_xor_b32 v153, 2, v225
    v_mul_u32_u24 v145, 9216, v152
    v_lshl_add_u32 v145, v153, 5, v145
    v_add_u32 v145, v145, v226
    v_and_b32 v153, s67, v153
    v_mul_u32_u24 v149, 3456, v152
    v_lshl_add_u32 v149, v153, 5, v149
    v_add_u32 v149, v149, v226
    v_add_u32 v152, 16, v224
    v_xor_b32 v153, 0, v225
    v_mul_u32_u24 v146, 9216, v152
    v_lshl_add_u32 v146, v153, 5, v146
    v_add_u32 v146, v146, v226
    v_and_b32 v153, s67, v153
    v_mul_u32_u24 v150, 3456, v152
    v_lshl_add_u32 v150, v153, 5, v150
    v_add_u32 v150, v150, v226
    v_add_u32 v152, 24, v224
    v_xor_b32 v153, 2, v225
    v_mul_u32_u24 v147, 9216, v152
    v_lshl_add_u32 v147, v153, 5, v147
    v_add_u32 v147, v147, v226
    v_and_b32 v153, s67, v153
    v_mul_u32_u24 v151, 3456, v152
    v_lshl_add_u32 v151, v153, 5, v151
    v_add_u32 v151, v151, v226
    s_cmp_eq_u32 s33, 3
    s_cbranch_scc0 KF_lnw
    s_mov_b32 s94, s60
    s_mov_b32 s95, s61
    s_mov_b32 s92, s16
    s_mov_b32 s93, s17
    s_mov_b32 s35, 0
    s_getpc_b64 s[24:25]
KF_pc:
    s_sub_u32 s24, s24, KF_pc-recurrent_scan__sliding_local_dilated__swiglu_ffn__prompt_kernel
    s_subb_u32 s25, s25, 0
    s_lshr_b32 s3, s2, 3
    s_lshl_b32 s3, s3, 4
    v_and_b32 v4, 15, v0
    v_add_u32 v4, s3, v4
    v_lshlrev_b32 v4, 7, v4
    v_min_u32 v4, KF_last-recurrent_scan__sliding_local_dilated__swiglu_ffn__prompt_kernel, v4
    v_mov_b32 v5, 0
    v_lshl_add_u64 v[4:5], v[4:5], 0, s[24:25]
    s_and_b32 s3, s32, 3
    s_mul_i32 s3, s3, 144
    v_add_u32 v72, s3, v0
    v_min_u32 v74, 15, v0
    v_add_u32 v74, s3, v74
    v_mul_u32_u24 v73, 9216, v72
    v_mul_u32_u24 v72, 3456, v72
    v_mul_u32_u24 v75, 9216, v74
    v_mul_u32_u24 v74, 3456, v74
    global_load_dword v12, v73, s[92:93]
    global_load_dword v12, v72, s[94:95]
    v_add_u32 v73, 589824, v73
    v_add_u32 v72, 221184, v72
    v_add_u32 v75, 1179648, v75
    v_add_u32 v74, 442368, v74
    global_load_dword v12, v73, s[92:93]
    global_load_dword v12, v72, s[94:95]
    global_load_dword v12, v75, s[92:93]
    global_load_dword v12, v74, s[94:95]
    global_load_dword v12, v[4:5], off
    s_waitcnt vmcnt(63)
KF_w3:
    s_add_u32 m0, s35, 0
    s_nop 0
    global_load_lds_dwordx4 v144, s[92:93]
    s_add_u32 m0, s35, 73728
    s_nop 0
    global_load_lds_dwordx4 v148, s[94:95]
    s_add_u32 m0, s35, 1024
    s_nop 0
    global_load_lds_dwordx4 v145, s[92:93]
    s_add_u32 m0, s35, 74752
    s_nop 0
    global_load_lds_dwordx4 v149, s[94:95]
    s_add_u32 m0, s35, 2048
    s_nop 0
    global_load_lds_dwordx4 v146, s[92:93]
    s_add_u32 m0, s35, 75776
    s_nop 0
    global_load_lds_dwordx4 v150, s[94:95]
    s_add_u32 m0, s35, 3072
    s_nop 0
    global_load_lds_dwordx4 v147, s[92:93]
    s_add_u32 m0, s35, 76800
    s_nop 0
    global_load_lds_dwordx4 v151, s[94:95]
    s_add_u32 s92, s92, 294912
    s_addc_u32 s93, s93, 0
    s_add_u32 s94, s94, 110592
    s_addc_u32 s95, s95, 0
    s_add_u32 s35, s35, 4096
    s_waitcnt vmcnt(40)
    s_cmp_lt_u32 s35, 24576
    s_cbranch_scc1 KF_w3
    s_mov_b32 s6, 2147479552
    s_branch KF_join
KF_lnw:
    v_mov_b32 v76, 0x3f803f80
    s_waitcnt vmcnt(6)
    v_dot2_f32_bf16 v82, v64, v76, 0
    v_dot2_f32_bf16 v83, v64, v64, 0
    v_dot2_f32_bf16 v84, v65, v76, 0
    v_dot2_f32_bf16 v85, v65, v65, 0
    v_dot2_f32_bf16 v82, v66, v76, v82
    v_dot2_f32_bf16 v83, v66, v66, v83
    v_dot2_f32_bf16 v84, v67, v76, v84
    v_dot2_f32_bf16 v85, v67, v67, v85
    v_dot2_f32_bf16 v82, v68, v76, v82
    v_dot2_f32_bf16 v83, v68, v68, v83
    v_dot2_f32_bf16 v84, v69, v76, v84
    v_dot2_f32_bf16 v85, v69, v69, v85
    v_dot2_f32_bf16 v82, v70, v76, v82
    v_dot2_f32_bf16 v83, v70, v70, v83
    v_dot2_f32_bf16 v84, v71, v76, v84
    v_dot2_f32_bf16 v85, v71, v71, v85
    v_dot2_f32_bf16 v82, v72, v76, v82
    v_dot2_f32_bf16 v83, v72, v72, v83
    v_dot2_f32_bf16 v84, v73, v76, v84
    v_dot2_f32_bf16 v85, v73, v73, v85
    v_dot2_f32_bf16 v82, v74, v76, v82
    v_dot2_f32_bf16 v83, v74, v74, v83
    v_dot2_f32_bf16 v84, v75, v76, v84
    v_dot2_f32_bf16 v85, v75, v75, v85
    v_lshlrev_b32 v96, 16, v64
    v_and_b32 v97, s41, v64
    v_lshlrev_b32 v98, 16, v65
    v_and_b32 v99, s41, v65
    v_lshlrev_b32 v100, 16, v66
    v_and_b32 v101, s41, v66
    v_lshlrev_b32 v102, 16, v67
    v_and_b32 v103, s41, v67
    v_lshlrev_b32 v104, 16, v68
    v_and_b32 v105, s41, v68
    v_lshlrev_b32 v106, 16, v69
    v_and_b32 v107, s41, v69
    v_lshlrev_b32 v108, 16, v70
    v_and_b32 v109, s41, v70
    v_lshlrev_b32 v110, 16, v71
    v_and_b32 v111, s41, v71
    v_lshlrev_b32 v112, 16, v72
    v_and_b32 v113, s41, v72
    v_lshlrev_b32 v114, 16, v73
    v_and_b32 v115, s41, v73
    v_lshlrev_b32 v116, 16, v74
    v_and_b32 v117, s41, v74
    v_lshlrev_b32 v118, 16, v75
    v_and_b32 v119, s41, v75
    s_waitcnt vmcnt(0)
    v_dot2_f32_bf16 v82, v120, v76, v82
    v_dot2_f32_bf16 v83, v120, v120, v83
    v_dot2_f32_bf16 v84, v121, v76, v84
    v_dot2_f32_bf16 v85, v121, v121, v85
    v_dot2_f32_bf16 v82, v122, v76, v82
    v_dot2_f32_bf16 v83, v122, v122, v83
    v_dot2_f32_bf16 v84, v123, v76, v84
    v_dot2_f32_bf16 v85, v123, v123, v85
    v_dot2_f32_bf16 v82, v124, v76, v82
    v_dot2_f32_bf16 v83, v124, v124, v83
    v_dot2_f32_bf16 v84, v125, v76, v84
    v_dot2_f32_bf16 v85, v125, v125, v85
    v_dot2_f32_bf16 v82, v126, v76, v82
    v_dot2_f32_bf16 v83, v126, v126, v83
    v_dot2_f32_bf16 v84, v127, v76, v84
    v_dot2_f32_bf16 v85, v127, v127, v85
    v_dot2_f32_bf16 v82, v128, v76, v82
    v_dot2_f32_bf16 v83, v128, v128, v83
    v_dot2_f32_bf16 v84, v129, v76, v84
    v_dot2_f32_bf16 v85, v129, v129, v85
    v_dot2_f32_bf16 v82, v130, v76, v82
    v_dot2_f32_bf16 v83, v130, v130, v83
    v_dot2_f32_bf16 v84, v131, v76, v84
    v_dot2_f32_bf16 v85, v131, v131, v85
    v_dot2_f32_bf16 v82, v132, v76, v82
    v_dot2_f32_bf16 v83, v132, v132, v83
    v_dot2_f32_bf16 v84, v133, v76, v84
    v_dot2_f32_bf16 v85, v133, v133, v85
    v_dot2_f32_bf16 v82, v134, v76, v82
    v_dot2_f32_bf16 v83, v134, v134, v83
    v_dot2_f32_bf16 v84, v135, v76, v84
    v_dot2_f32_bf16 v85, v135, v135, v85
    v_dot2_f32_bf16 v82, v136, v76, v82
    v_dot2_f32_bf16 v83, v136, v136, v83
    v_dot2_f32_bf16 v84, v137, v76, v84
    v_dot2_f32_bf16 v85, v137, v137, v85
    v_dot2_f32_bf16 v82, v138, v76, v82
    v_dot2_f32_bf16 v83, v138, v138, v83
    v_dot2_f32_bf16 v84, v139, v76, v84
    v_dot2_f32_bf16 v85, v139, v139, v85
    v_dot2_f32_bf16 v82, v140, v76, v82
    v_dot2_f32_bf16 v83, v140, v140, v83
    v_dot2_f32_bf16 v84, v141, v76, v84
    v_dot2_f32_bf16 v85, v141, v141, v85
    v_dot2_f32_bf16 v82, v142, v76, v82
    v_dot2_f32_bf16 v83, v142, v142, v83
    v_dot2_f32_bf16 v84, v143, v76, v84
    v_dot2_f32_bf16 v85, v143, v143, v85
    s_nop 2
    v_add_f32 v82, v82, v84
    v_add_f32 v83, v83, v85
    s_nop 1
    v_add_f32_dpp v82, v82, v82 row_ror:8 row_mask:0xf bank_mask:0xf
    v_add_f32_dpp v83, v83, v83 row_ror:8 row_mask:0xf bank_mask:0xf
    v_mov_b32 v84, v82
    v_mov_b32 v85, v83
    s_nop 1
    v_permlane16_swap_b32 v82, v84
    v_permlane16_swap_b32 v83, v85
    s_nop 1
    v_add_f32 v82, v82, v84
    v_add_f32 v83, v83, v85
    v_mov_b32 v84, v82
    v_mov_b32 v85, v83
    s_nop 1
    v_permlane32_swap_b32 v82, v84
    v_permlane32_swap_b32 v83, v85
    s_nop 1
    v_add_f32 v82, v82, v84
    v_add_f32 v83, v83, v85
    v_mul_f32 v82, 0x3ae38e39, v82
    v_mul_f32 v83, 0x3ae38e39, v83
    v_fma_f32 v83, -v82, v82, v83
    v_max_f32 v83, 0, v83
    v_cvt_pk_bf16_f32 v82, v82, v82
    v_lshlrev_b32 v82, 16, v82
    v_cvt_pk_bf16_f32 v83, v83, v83
    v_lshlrev_b32 v83, 16, v83
    v_add_f32 v83, 0x3727c5ac, v83
    v_cvt_pk_bf16_f32 v83, v83, v83
    v_lshlrev_b32 v83, 16, v83
    v_sqrt_f32 v83, v83
    s_nop 0
    v_cvt_pk_bf16_f32 v83, v83, v83
    v_lshlrev_b32 v83, 16, v83
    v_rcp_f32 v83, v83
    s_nop 0
    v_sub_f32 v96, v96, v82
    v_sub_f32 v97, v97, v82
    v_sub_f32 v98, v98, v82
    v_sub_f32 v99, v99, v82
    v_sub_f32 v100, v100, v82
    v_sub_f32 v101, v101, v82
    v_sub_f32 v102, v102, v82
    v_sub_f32 v103, v103, v82
    v_cvt_pk_bf16_f32 v96, v96, v97
    v_cvt_pk_bf16_f32 v98, v98, v99
    v_cvt_pk_bf16_f32 v100, v100, v101
    v_cvt_pk_bf16_f32 v102, v102, v103
    v_and_b32 v97, s41, v96
    v_lshlrev_b32 v96, 16, v96
    v_and_b32 v99, s41, v98
    v_lshlrev_b32 v98, 16, v98
    v_and_b32 v101, s41, v100
    v_lshlrev_b32 v100, 16, v100
    v_and_b32 v103, s41, v102
    v_lshlrev_b32 v102, 16, v102
    v_mul_f32 v96, v96, v83
    v_mul_f32 v97, v97, v83
    v_mul_f32 v98, v98, v83
    v_mul_f32 v99, v99, v83
    v_mul_f32 v100, v100, v83
    v_mul_f32 v101, v101, v83
    v_mul_f32 v102, v102, v83
    v_mul_f32 v103, v103, v83
    v_cvt_pk_bf16_f32 v64, v96, v97
    v_cvt_pk_bf16_f32 v65, v98, v99
    v_cvt_pk_bf16_f32 v66, v100, v101
    v_cvt_pk_bf16_f32 v67, v102, v103
    buffer_store_dwordx4 v[64:67], v78, s[20:23], s96 offen sc1
    v_sub_f32 v104, v104, v82
    v_sub_f32 v105, v105, v82
    v_sub_f32 v106, v106, v82
    v_sub_f32 v107, v107, v82
    v_sub_f32 v108, v108, v82
    v_sub_f32 v109, v109, v82
    v_sub_f32 v110, v110, v82
    v_sub_f32 v111, v111, v82
    v_cvt_pk_bf16_f32 v104, v104, v105
    v_cvt_pk_bf16_f32 v106, v106, v107
    v_cvt_pk_bf16_f32 v108, v108, v109
    v_cvt_pk_bf16_f32 v110, v110, v111
    v_and_b32 v105, s41, v104
    v_lshlrev_b32 v104, 16, v104
    v_and_b32 v107, s41, v106
    v_lshlrev_b32 v106, 16, v106
    v_and_b32 v109, s41, v108
    v_lshlrev_b32 v108, 16, v108
    v_and_b32 v111, s41, v110
    v_lshlrev_b32 v110, 16, v110
    v_mul_f32 v104, v104, v83
    v_mul_f32 v105, v105, v83
    v_mul_f32 v106, v106, v83
    v_mul_f32 v107, v107, v83
    v_mul_f32 v108, v108, v83
    v_mul_f32 v109, v109, v83
    v_mul_f32 v110, v110, v83
    v_mul_f32 v111, v111, v83
    v_cvt_pk_bf16_f32 v68, v104, v105
    v_cvt_pk_bf16_f32 v69, v106, v107
    v_cvt_pk_bf16_f32 v70, v108, v109
    v_cvt_pk_bf16_f32 v71, v110, v111
    buffer_store_dwordx4 v[68:71], v78, s[20:23], s96 offen offset:2048 sc1
    v_sub_f32 v112, v112, v82
    v_sub_f32 v113, v113, v82
    v_sub_f32 v114, v114, v82
    v_sub_f32 v115, v115, v82
    v_sub_f32 v116, v116, v82
    v_sub_f32 v117, v117, v82
    v_sub_f32 v118, v118, v82
    v_sub_f32 v119, v119, v82
    v_cvt_pk_bf16_f32 v112, v112, v113
    v_cvt_pk_bf16_f32 v114, v114, v115
    v_cvt_pk_bf16_f32 v116, v116, v117
    v_cvt_pk_bf16_f32 v118, v118, v119
    v_and_b32 v113, s41, v112
    v_lshlrev_b32 v112, 16, v112
    v_and_b32 v115, s41, v114
    v_lshlrev_b32 v114, 16, v114
    v_and_b32 v117, s41, v116
    v_lshlrev_b32 v116, 16, v116
    v_and_b32 v119, s41, v118
    v_lshlrev_b32 v118, 16, v118
    v_mul_f32 v112, v112, v83
    v_mul_f32 v113, v113, v83
    v_mul_f32 v114, v114, v83
    v_mul_f32 v115, v115, v83
    v_mul_f32 v116, v116, v83
    v_mul_f32 v117, v117, v83
    v_mul_f32 v118, v118, v83
    v_mul_f32 v119, v119, v83
    v_cvt_pk_bf16_f32 v72, v112, v113
    v_cvt_pk_bf16_f32 v73, v114, v115
    v_cvt_pk_bf16_f32 v74, v116, v117
    v_cvt_pk_bf16_f32 v75, v118, v119
    buffer_store_dwordx4 v[72:75], v78, s[20:23], s97 offen sc1
KF_join:
    v_mov_b32 v2, 0
    global_load_dword v3, v2, s[28:29] sc1
    s_lshl_b32 s35, s33, 3
    v_add_u32 v224, s35, v224
    s_and_b32 s35, s33, 1
    s_lshl_b32 s35, s35, 1
    v_xor_b32 v225, s35, v225
    v_mul_u32_u24 v228, 9216, v224
    v_add_u32 v228, v228, v226
    v_mov_b32 v229, 0
    v_lshl_add_u32 v232, v225, 5, v228
    v_mov_b32 v233, 0
    s_mov_b32 s100, 294912
    s_mov_b32 s101, 0
    s_add_u32 s12, s16, 128
    s_addc_u32 s13, s17, 0
    v_lshl_add_u64 v[10:11], v[232:233], 0, s[12:13]
    v_lshl_add_u64 v[248:249], v[232:233], 0, s[18:19]
    s_and_b32 s3, s32, 3
    s_lshl_b32 s3, s3, 2
    s_add_u32 s3, s3, s33
    s_mul_i32 s3, s3, 36
    v_min_u32 v13, 35, v0
    v_add_u32 v13, s3, v13
    v_mul_u32_u24 v13, 9216, v13
    s_lshl_b32 s34, s32, 4
    s_lshl_b32 s35, s33, 2
    s_add_u32 s34, s34, s35
    s_mul_i32 s35, s34, 18432
    v_lshlrev_b32 v224, 4, v0
    v_add_u32 v252, s35, v224
    v_add_u32 v253, 18432, v252
    v_add_u32 v254, 36864, v252
    v_add_u32 v255, 55296, v252
    s_mul_i32 s35, s34, 147456
    v_add_u32 v14, s35, v224
    s_sub_u32 s58, s10, s8
    s_subb_u32 s59, s11, s9
    s_sub_u32 s58, s58, 5308416
    s_subb_u32 s59, s59, 0
    s_add_u32 s12, s8, s38
    s_addc_u32 s13, s9, 0
    s_add_u32 s14, s10, s38
    s_addc_u32 s15, s11, 0
    v_and_b32 v227, 1, v225
    v_lshl_add_u32 v228, v227, 5, v228
    v_lshl_add_u64 v[244:245], v[228:229], 0, s[12:13]
    v_lshl_add_u64 v[236:237], v[228:229], 0, s[14:15]
    v_cmp_lt_u32 vcc, 1, v225
    s_nop 1
    v_cndmask_b32 v244, v244, v236, vcc
    v_cndmask_b32 v245, v245, v237, vcc
    s_mov_b32 s52, 0
    s_mov_b32 s53, 4096
    s_mov_b32 s54, 8192
    s_mov_b32 s55, 12288
    s_mov_b32 s56, 16384
    s_and_b32 s92, s2, 1
    s_bfe_u32 s69, s2, 0x20001
    s_bfe_u32 s93, s2, 0x20003
    s_bfe_u32 s94, s2, 0x10005
    s_lshr_b32 s95, s2, 6
    s_lshl_b32 s95, s95, 1
    s_add_u32 s95, s95, s94
    s_lshl_b32 s57, s92, 3
    s_add_u32 s57, s57, s95
    s_mov_b32 s68, 0
    s_mov_b32 s83, 0
    s_mov_b32 s7, 147456
    s_mul_i32 s73, s69, 1327104
    s_mul_i32 s74, s69, 36864
    s_add_u32 s74, s74, 11796480
    s_mov_b32 s86, 5310464
    s_mov_b32 s75, 170966443
    s_mov_b32 s76, 545503626
    s_mov_b32 s77, 1073741809
    s_mov_b32 s78, 378736704
    s_mov_b32 s82, 18
    s_cmp_lt_u32 s93, 3
    s_cbranch_scc1 C_rh
    s_lshl_b32 s57, s92, 2
    s_add_u32 s57, s57, s69
    s_lshl_b32 s83, s57, 3
    s_add_u32 s83, s83, s95
    s_lshl_b32 s57, s57, 1
    s_cmp_ge_u32 s95, 3
    s_cselect_b32 s94, 1, 0
    s_add_u32 s57, s57, s94
    s_mul_i32 s94, s94, 3
    s_sub_u32 s93, s95, s94
    s_cmp_lt_u32 s95, 6
    s_cselect_b32 s68, 1, 2
    s_cselect_b32 s93, s93, 0
    s_mov_b32 s69, 0
    s_mov_b32 s7, 18432
    s_mov_b32 s73, 0
    s_mov_b32 s74, 2359296
    s_mov_b32 s86, 665600
    s_mov_b32 s75, 1072962757
    s_mov_b32 s76, 1073741823
    s_mov_b32 s77, 1073741823
    s_mov_b32 s78, 172066848
    s_mov_b32 s82, 9
    s_mov_b32 s90, s88
    s_mov_b32 s91, s89
C_rh:
    s_sub_u32 s84, s90, 2048
    s_subb_u32 s85, s91, 0
    s_mov_b32 s87, 0x20000
    s_mul_i32 s70, s57, 3
    s_add_u32 s70, s70, s93
    s_mul_i32 s71, s93, 384
    s_add_u32 s73, s73, s71
    s_mul_i32 s72, s33, 3072
    s_mov_b32 s3, 0
KF_ep:
    s_waitcnt vmcnt(0)
    v_readfirstlane_b32 s67, v3
    s_add_u32 s3, s3, 1
    s_cmp_gt_u32 s3, 1000000
    s_cbranch_scc1 KF_epok
    s_cmp_lg_u32 s67, 0
    s_cbranch_scc1 KF_epok
    global_load_dword v3, v2, s[28:29] sc1
    s_branch KF_ep
KF_epok:
    s_add_u32 s39, s67, 1
    v_mov_b32 v3, s39
    buffer_store_dword v3, off, s[20:23], s6 sc1
    s_cmp_eq_u32 s33, 3
    s_cbranch_scc1 KF_now
    s_mul_i32 s3, s33, 4
    s_add_u32 s3, s3, 6
    s_lshl_b32 s35, s3, 12
    s_add_u32 s36, s35, 16384
    s_mul_i32 s37, s3, 294912
    s_add_u32 s92, s16, s37
    s_addc_u32 s93, s17, 0
    s_mul_i32 s37, s3, 110592
    s_add_u32 s94, s60, s37
    s_addc_u32 s95, s61, 0
KF_wl:
    s_add_u32 m0, s35, 0
    s_nop 0
    global_load_lds_dwordx4 v144, s[92:93]
    s_add_u32 m0, s35, 73728
    s_nop 0
    global_load_lds_dwordx4 v148, s[94:95]
    s_add_u32 m0, s35, 1024
    s_nop 0
    global_load_lds_dwordx4 v145, s[92:93]
    s_add_u32 m0, s35, 74752
    s_nop 0
    global_load_lds_dwordx4 v149, s[94:95]
    s_add_u32 m0, s35, 2048
    s_nop 0
    global_load_lds_dwordx4 v146, s[92:93]
    s_add_u32 m0, s35, 75776
    s_nop 0
    global_load_lds_dwordx4 v150, s[94:95]
    s_add_u32 m0, s35, 3072
    s_nop 0
    global_load_lds_dwordx4 v147, s[92:93]
    s_add_u32 m0, s35, 76800
    s_nop 0
    global_load_lds_dwordx4 v151, s[94:95]
    s_add_u32 s92, s92, 294912
    s_addc_u32 s93, s93, 0
    s_add_u32 s94, s94, 110592
    s_addc_u32 s95, s95, 0
    s_add_u32 s35, s35, 4096
    s_waitcnt vmcnt(40)
    s_cmp_lt_u32 s35, s36
    s_cbranch_scc1 KF_wl
KF_now:
    v_lshrrev_b32 v224, 4, v0
    v_bfe_u32 v225, v0, 2, 2
    v_lshl_add_u32 v226, v224, 3, v225
    v_lshlrev_b32 v226, 7, v226
    v_lshrrev_b32 v225, 1, v225
    v_and_b32 v224, 1, v224
    v_lshl_or_b32 v225, v224, 1, v225
    v_and_b32 v227, 3, v0
    v_xor_b32 v228, 0, v225
    v_lshl_add_u32 v228, v228, 5, v226
    v_lshl_add_u32 v240, v227, 3, v228
    v_mov_b32 v2, v240
    v_xor_b32 v228, 1, v225
    v_lshl_add_u32 v228, v228, 5, v226
    v_lshl_add_u32 v241, v227, 3, v228
    v_mov_b32 v3, v241
    v_xor_b32 v228, 2, v225
    v_lshl_add_u32 v228, v228, 5, v226
    v_lshl_add_u32 v242, v227, 3, v228
    v_mov_b32 v4, v242
    v_xor_b32 v228, 3, v225
    v_lshl_add_u32 v228, v228, 5, v226
    v_lshl_add_u32 v243, v227, 3, v228
    v_mov_b32 v5, v243
    v_lshrrev_b32 v228, 1, v227
    v_add_u32 v228, 0, v228
    v_xor_b32 v228, v228, v225
    v_lshl_add_u32 v228, v228, 5, v226
    v_and_b32 v229, 1, v227
    v_lshl_add_u32 v228, v229, 4, v228
    v_add_u32 v6, 73728, v228
    v_add_u32 v7, 73736, v228
    v_lshrrev_b32 v228, 1, v227
    v_add_u32 v228, 2, v228
    v_xor_b32 v228, v228, v225
    v_lshl_add_u32 v228, v228, 5, v226
    v_and_b32 v229, 1, v227
    v_lshl_add_u32 v228, v229, 4, v228
    v_add_u32 v8, 73728, v228
    v_add_u32 v9, 73736, v228
    v_and_b32 v224, 7, v0
    s_lshl_b32 s35, s34, 3
    v_add_u32 v224, s35, v224
    v_bfe_u32 v225, v0, 3, 1
    v_lshl_add_u32 v224, v225, 10, v224
    v_mul_u32_u24 v224, 3456, v224
    v_lshrrev_b32 v225, 4, v0
    v_lshl_add_u32 v15, v225, 4, v224
    s_mul_i32 s35, s30, 18
    s_lshl_b32 s42, s31, 2
    s_add_u32 s35, s35, s42
    s_lshl_b32 s35, s35, 10
    s_add_u32 s44, s35, 11796480
    s_add_u32 s45, s44, 147456
    s_add_u32 s46, s44, 294912
    s_add_u32 s47, s44, 442368
    s_add_u32 s48, s62, 4718592
    s_add_u32 s49, s48, 27648
    s_add_u32 s50, s48, 55296
    s_add_u32 s51, s48, 82944
    s_lshl_b32 s24, s32, 5
    s_lshl_b32 s3, s30, 2
    s_add_u32 s24, s24, s3
    s_add_u32 s24, s24, s31
    s_lshl_b32 s24, s24, 2
    s_add_u32 s24, s24, 50348032
    s_cmp_eq_u32 s33, 0
    s_cselect_b32 s24, s24, 2147479552
    s_lshl_b32 s25, s32, 2
    s_add_u32 s25, s25, s33
    s_lshl_b32 s25, s25, 5
    s_add_u32 s25, s25, s3
    s_add_u32 s25, s25, s31
    s_lshl_b32 s25, s25, 2
    s_add_u32 s25, s25, 50343936
    s_and_b32 s26, s57, 1
    s_lshl_b32 s26, s26, 1
    s_lshr_b32 s3, s33, 1
    s_add_u32 s26, s26, s3
    s_lshl_b32 s3, s32, 2
    s_add_u32 s26, s26, s3
    s_lshl_b32 s26, s26, 7
    s_lshl_b32 s3, s69, 5
    s_add_u32 s26, s26, s3
    s_add_u32 s26, s26, 50343936
    s_cmp_eq_u32 s68, 0
    s_cselect_b32 s27, 2, 0
    s_and_b32 s28, s57, 7
    s_mul_i32 s28, s28, 3
    s_add_u32 s28, s28, s31
    s_lshl_b32 s28, s28, 2
    s_add_u32 s28, s28, s33
    s_mul_i32 s28, s28, 13824
    s_mul_i32 s3, s69, 1327104
    s_add_u32 s28, s28, s3
    s_and_b32 s3, s83, 7
    s_lshl_b32 s3, s3, 2
    s_add_u32 s3, s3, s33
    s_mul_i32 s3, s3, 20736
    s_cmp_eq_u32 s68, 0
    s_cselect_b32 s28, s28, s3
    s_add_u32 s28, s28, 2048
    s_add_u32 s29, s28, 16384
    s_cmp_eq_u32 s68, 0
    s_cselect_b32 s29, 2147479552, s29
    s_lshl_b32 s6, s32, 2
    s_add_u32 s6, s6, s33
    s_lshl_b32 s6, s6, 7
    s_add_u32 s6, s6, 50352128
    v_and_b32 v224, 3, v0
    v_min_u32 v224, 2, v224
    v_and_b32 v225, 28, v0
    v_add_u32 v224, v224, v225
    v_lshlrev_b32 v224, 2, v224
    v_lshrrev_b32 v226, 4, v0
    v_mul_u32_u24 v226, 18432, v226
    v_and_b32 v227, 15, v0
    v_lshl_add_u32 v226, v227, 7, v226
    s_bfe_u32 s3, s2, 0x30003
    s_lshl_b32 s3, s3, 11
    s_mul_i32 s35, s34, 18432
    s_add_u32 s3, s3, s35
    s_add_u32 s3, s3, 2048
    v_add_u32 v226, s3, v226
    s_load_dwordx2 s[88:89], s[0:1], 0
    s_load_dwordx2 s[90:91], s[0:1], 56
    s_mul_i32 s92, s70, 245760
    s_add_u32 s92, s92, s72
    s_add_u32 s92, s92, 30670848
    s_mul_i32 s97, s69, 61440
    s_add_u32 s97, s97, s92
    s_lshl_b32 s62, s70, 2
    s_add_u32 s62, s62, s33
    s_lshl_b32 s62, s62, 5
    s_add_u32 s62, s62, 50331648
    s_lshl_b32 s63, s69, 2
    s_add_u32 s63, s63, s62
    s_xor_b32 s94, s69, 1
    s_mul_i32 s94, s94, 61440
    s_add_u32 s94, s94, 12288
    s_add_u32 s94, s94, s92
    s_xor_b32 s95, s69, 2
    s_mul_i32 s95, s95, 61440
    s_add_u32 s95, s95, 24576
    s_add_u32 s95, s95, s92
    s_xor_b32 s96, s69, 3
    s_mul_i32 s96, s96, 61440
    s_add_u32 s96, s96, 36864
    s_add_u32 s96, s96, s92
    s_waitcnt lgkmcnt(0)
    s_add_u32 s60, s16, 128
    s_addc_u32 s61, s17, 0
    s_add_u32 s4, s18, 128
    s_addc_u32 s5, s19, 0
    s_cmp_eq_u32 s68, 0
    s_cselect_b64 s[60:61], s[60:61], s[12:13]
    s_cselect_b64 s[4:5], s[4:5], s[14:15]
    s_mov_b32 s3, 0
P_xn:
    s_add_u32 s3, s3, 1
    s_cmp_gt_u32 s3, 1000000
    s_cbranch_scc1 P_xn_ok
    buffer_load_dword v225, v224, s[20:23], s6 offen sc1
    s_waitcnt vmcnt(0)
P_xn_t:
    v_cmp_ne_u32 vcc, s39, v225
    s_nop 1
    s_cmp_eq_u64 vcc, 0
    s_cbranch_scc1 P_xn_ok
    s_branch P_xn
P_xn_ok:
    buffer_load_dwordx4 a[0:3], v252, s[20:23], s52 offen offset:0 sc1
    buffer_load_dwordx4 a[4:7], v253, s[20:23], s52 offen offset:0 sc1
    buffer_load_dwordx4 a[8:11], v254, s[20:23], s52 offen offset:0 sc1
    buffer_load_dwordx4 a[12:15], v255, s[20:23], s52 offen offset:0 sc1
    buffer_load_dwordx4 a[16:19], v252, s[20:23], s52 offen offset:1024 sc1
    buffer_load_dwordx4 a[20:23], v253, s[20:23], s52 offen offset:1024 sc1
    buffer_load_dwordx4 a[24:27], v254, s[20:23], s52 offen offset:1024 sc1
    buffer_load_dwordx4 a[28:31], v255, s[20:23], s52 offen offset:1024 sc1
    buffer_load_dwordx4 a[32:35], v252, s[20:23], s52 offen offset:2048 sc1
    buffer_load_dwordx4 a[36:39], v253, s[20:23], s52 offen offset:2048 sc1
    buffer_load_dwordx4 a[40:43], v254, s[20:23], s52 offen offset:2048 sc1
    buffer_load_dwordx4 a[44:47], v255, s[20:23], s52 offen offset:2048 sc1
    buffer_load_dword v12, v226, s[20:23], 0 offen sc1
    s_mov_b64 vcc, s[64:65]
    s_barrier
    ds_read_b64_tr_b16 v[32:33], v6 offset:0
    ds_read_b64_tr_b16 v[34:35], v6 offset:512
    ds_read_b64_tr_b16 v[36:37], v7 offset:0
    ds_read_b64_tr_b16 v[38:39], v7 offset:512
    ds_read_b64_tr_b16 v[40:41], v8 offset:0
    ds_read_b64_tr_b16 v[42:43], v8 offset:512
    ds_read_b64_tr_b16 v[44:45], v9 offset:0
    ds_read_b64_tr_b16 v[46:47], v9 offset:512
    ds_read_b64_tr_b16 v[16:17], v2 offset:0
    ds_read_b64_tr_b16 v[18:19], v2 offset:512
    ds_read_b64_tr_b16 v[20:21], v3 offset:0
    ds_read_b64_tr_b16 v[22:23], v3 offset:512
    ds_read_b64_tr_b16 v[24:25], v4 offset:0
    ds_read_b64_tr_b16 v[26:27], v4 offset:512
    ds_read_b64_tr_b16 v[28:29], v5 offset:0
    ds_read_b64_tr_b16 v[30:31], v5 offset:512
    s_waitcnt vmcnt(9)
    s_waitcnt lgkmcnt(8)
    v_mfma_f32_16x16x32_bf16 v[128:131], v[32:35], a[0:3], 0
    v_mfma_f32_16x16x32_bf16 v[132:135], v[32:35], a[4:7], 0
    v_mfma_f32_16x16x32_bf16 v[136:139], v[32:35], a[8:11], 0
    buffer_load_dwordx4 a[48:51], v252, s[20:23], s52 offen offset:3072 sc1
    v_mfma_f32_16x16x32_bf16 v[140:143], v[32:35], a[12:15], 0
    ds_read_b64_tr_b16 v[32:33], v6 offset:4096
    v_mfma_f32_16x16x32_bf16 v[144:147], v[36:39], a[0:3], 0
    buffer_load_dwordx4 a[52:55], v253, s[20:23], s52 offen offset:3072 sc1
    ds_read_b64_tr_b16 v[34:35], v6 offset:4608
    v_mfma_f32_16x16x32_bf16 v[148:151], v[36:39], a[4:7], 0
    buffer_load_dwordx4 a[56:59], v254, s[20:23], s52 offen offset:3072 sc1
    v_mfma_f32_16x16x32_bf16 v[152:155], v[36:39], a[8:11], 0
    buffer_load_dwordx4 a[60:63], v255, s[20:23], s52 offen offset:3072 sc1
    v_mfma_f32_16x16x32_bf16 v[156:159], v[36:39], a[12:15], 0
    ds_read_b64_tr_b16 v[36:37], v7 offset:4096
    ds_read_b64_tr_b16 v[38:39], v7 offset:4608
    s_cbranch_vccz KF_s0
    s_waitcnt lgkmcnt(8)
    v_mfma_f32_16x16x32_bf16 v[160:163], v[40:43], a[0:3], 0
    v_mfma_f32_16x16x32_bf16 v[164:167], v[40:43], a[4:7], 0
    v_mfma_f32_16x16x32_bf16 v[168:171], v[40:43], a[8:11], 0
    v_mfma_f32_16x16x32_bf16 v[172:175], v[40:43], a[12:15], 0
    ds_read_b64_tr_b16 v[40:41], v8 offset:4096
    v_mfma_f32_16x16x32_bf16 v[176:179], v[44:47], a[0:3], 0
    ds_read_b64_tr_b16 v[42:43], v8 offset:4608
    v_mfma_f32_16x16x32_bf16 v[180:183], v[44:47], a[4:7], 0
    v_mfma_f32_16x16x32_bf16 v[184:187], v[44:47], a[8:11], 0
    v_mfma_f32_16x16x32_bf16 v[188:191], v[44:47], a[12:15], 0
    ds_read_b64_tr_b16 v[44:45], v9 offset:4096
    ds_read_b64_tr_b16 v[46:47], v9 offset:4608
KF_s0:
    s_waitcnt lgkmcnt(8)
    v_mfma_f32_16x16x32_bf16 v[64:67], v[16:19], a[0:3], 0
    buffer_load_dwordx4 a[64:67], v252, s[20:23], s53 offen offset:0 sc1
    v_mfma_f32_16x16x32_bf16 v[68:71], v[16:19], a[4:7], 0
    buffer_load_dwordx4 a[68:71], v253, s[20:23], s53 offen offset:0 sc1
    v_mfma_f32_16x16x32_bf16 v[72:75], v[16:19], a[8:11], 0
    buffer_load_dwordx4 a[72:75], v254, s[20:23], s53 offen offset:0 sc1
    v_mfma_f32_16x16x32_bf16 v[76:79], v[16:19], a[12:15], 0
    ds_read_b64_tr_b16 v[16:17], v2 offset:4096
    v_mfma_f32_16x16x32_bf16 v[80:83], v[20:23], a[0:3], 0
    buffer_load_dwordx4 a[76:79], v255, s[20:23], s53 offen offset:0 sc1
    ds_read_b64_tr_b16 v[18:19], v2 offset:4608
    v_mfma_f32_16x16x32_bf16 v[84:87], v[20:23], a[4:7], 0
    global_load_dword v12, v13, s[18:19]
    v_mfma_f32_16x16x32_bf16 v[88:91], v[20:23], a[8:11], 0
    v_mfma_f32_16x16x32_bf16 v[92:95], v[20:23], a[12:15], 0
    s_waitcnt lgkmcnt(6)
    ds_read_b64_tr_b16 v[20:21], v3 offset:4096
    v_mfma_f32_16x16x32_bf16 v[96:99], v[24:27], a[0:3], 0
    ds_read_b64_tr_b16 v[22:23], v3 offset:4608
    v_mfma_f32_16x16x32_bf16 v[100:103], v[24:27], a[4:7], 0
    v_mfma_f32_16x16x32_bf16 v[104:107], v[24:27], a[8:11], 0
    v_mfma_f32_16x16x32_bf16 v[108:111], v[24:27], a[12:15], 0
    ds_read_b64_tr_b16 v[24:25], v4 offset:4096
    v_mfma_f32_16x16x32_bf16 v[112:115], v[28:31], a[0:3], 0
    ds_read_b64_tr_b16 v[26:27], v4 offset:4608
    v_mfma_f32_16x16x32_bf16 v[116:119], v[28:31], a[4:7], 0
    v_mfma_f32_16x16x32_bf16 v[120:123], v[28:31], a[8:11], 0
    s_waitcnt vmcnt(14)
    v_mfma_f32_16x16x32_bf16 v[124:127], v[28:31], a[12:15], 0
    s_waitcnt lgkmcnt(6)
    ds_read_b64_tr_b16 v[28:29], v5 offset:4096
    v_mfma_f32_16x16x32_bf16 v[128:131], v[32:35], a[16:19], v[128:131]
    ds_read_b64_tr_b16 v[30:31], v5 offset:4608
    v_mfma_f32_16x16x32_bf16 v[132:135], v[32:35], a[20:23], v[132:135]
    v_mfma_f32_16x16x32_bf16 v[136:139], v[32:35], a[24:27], v[136:139]
    buffer_load_dwordx4 a[80:83], v252, s[20:23], s53 offen offset:1024 sc1
    v_mfma_f32_16x16x32_bf16 v[140:143], v[32:35], a[28:31], v[140:143]
    ds_read_b64_tr_b16 v[32:33], v6 offset:8192
    v_mfma_f32_16x16x32_bf16 v[144:147], v[36:39], a[16:19], v[144:147]
    buffer_load_dwordx4 a[84:87], v253, s[20:23], s53 offen offset:1024 sc1
    ds_read_b64_tr_b16 v[34:35], v6 offset:8704
    v_mfma_f32_16x16x32_bf16 v[148:151], v[36:39], a[20:23], v[148:151]
    buffer_load_dwordx4 a[88:91], v254, s[20:23], s53 offen offset:1024 sc1
    v_mfma_f32_16x16x32_bf16 v[152:155], v[36:39], a[24:27], v[152:155]
    buffer_load_dwordx4 a[92:95], v255, s[20:23], s53 offen offset:1024 sc1
    v_mfma_f32_16x16x32_bf16 v[156:159], v[36:39], a[28:31], v[156:159]
    ds_read_b64_tr_b16 v[36:37], v7 offset:8192
    ds_read_b64_tr_b16 v[38:39], v7 offset:8704
    s_cbranch_vccz KF_s1
    s_waitcnt lgkmcnt(8)
    v_mfma_f32_16x16x32_bf16 v[160:163], v[40:43], a[16:19], v[160:163]
    v_mfma_f32_16x16x32_bf16 v[164:167], v[40:43], a[20:23], v[164:167]
    v_mfma_f32_16x16x32_bf16 v[168:171], v[40:43], a[24:27], v[168:171]
    v_mfma_f32_16x16x32_bf16 v[172:175], v[40:43], a[28:31], v[172:175]
    ds_read_b64_tr_b16 v[40:41], v8 offset:8192
    v_mfma_f32_16x16x32_bf16 v[176:179], v[44:47], a[16:19], v[176:179]
    ds_read_b64_tr_b16 v[42:43], v8 offset:8704
    v_mfma_f32_16x16x32_bf16 v[180:183], v[44:47], a[20:23], v[180:183]
    v_mfma_f32_16x16x32_bf16 v[184:187], v[44:47], a[24:27], v[184:187]
    v_mfma_f32_16x16x32_bf16 v[188:191], v[44:47], a[28:31], v[188:191]
    ds_read_b64_tr_b16 v[44:45], v9 offset:8192
    ds_read_b64_tr_b16 v[46:47], v9 offset:8704
KF_s1:
    s_waitcnt lgkmcnt(8)
    v_mfma_f32_16x16x32_bf16 v[64:67], v[16:19], a[16:19], v[64:67]
    buffer_load_dwordx4 a[96:99], v252, s[20:23], s53 offen offset:2048 sc1
    v_mfma_f32_16x16x32_bf16 v[68:71], v[16:19], a[20:23], v[68:71]
    buffer_load_dwordx4 a[100:103], v253, s[20:23], s53 offen offset:2048 sc1
    v_mfma_f32_16x16x32_bf16 v[72:75], v[16:19], a[24:27], v[72:75]
    buffer_load_dwordx4 a[104:107], v254, s[20:23], s53 offen offset:2048 sc1
    v_mfma_f32_16x16x32_bf16 v[76:79], v[16:19], a[28:31], v[76:79]
    ds_read_b64_tr_b16 v[16:17], v2 offset:8192
    v_mfma_f32_16x16x32_bf16 v[80:83], v[20:23], a[16:19], v[80:83]
    buffer_load_dwordx4 a[108:111], v255, s[20:23], s53 offen offset:2048 sc1
    ds_read_b64_tr_b16 v[18:19], v2 offset:8704
    v_mfma_f32_16x16x32_bf16 v[84:87], v[20:23], a[20:23], v[84:87]
    v_mfma_f32_16x16x32_bf16 v[88:91], v[20:23], a[24:27], v[88:91]
    v_mfma_f32_16x16x32_bf16 v[92:95], v[20:23], a[28:31], v[92:95]
    s_waitcnt lgkmcnt(6)
    ds_read_b64_tr_b16 v[20:21], v3 offset:8192
    v_mfma_f32_16x16x32_bf16 v[96:99], v[24:27], a[16:19], v[96:99]
    ds_read_b64_tr_b16 v[22:23], v3 offset:8704
    v_mfma_f32_16x16x32_bf16 v[100:103], v[24:27], a[20:23], v[100:103]
    v_mfma_f32_16x16x32_bf16 v[104:107], v[24:27], a[24:27], v[104:107]
    v_mfma_f32_16x16x32_bf16 v[108:111], v[24:27], a[28:31], v[108:111]
    ds_read_b64_tr_b16 v[24:25], v4 offset:8192
    v_mfma_f32_16x16x32_bf16 v[112:115], v[28:31], a[16:19], v[112:115]
    ds_read_b64_tr_b16 v[26:27], v4 offset:8704
    v_mfma_f32_16x16x32_bf16 v[116:119], v[28:31], a[20:23], v[116:119]
    v_mfma_f32_16x16x32_bf16 v[120:123], v[28:31], a[24:27], v[120:123]
    s_waitcnt vmcnt(18)
    v_mfma_f32_16x16x32_bf16 v[124:127], v[28:31], a[28:31], v[124:127]
    s_waitcnt lgkmcnt(6)
    ds_read_b64_tr_b16 v[28:29], v5 offset:8192
    v_mfma_f32_16x16x32_bf16 v[128:131], v[32:35], a[32:35], v[128:131]
    ds_read_b64_tr_b16 v[30:31], v5 offset:8704
    v_mfma_f32_16x16x32_bf16 v[132:135], v[32:35], a[36:39], v[132:135]
    v_mfma_f32_16x16x32_bf16 v[136:139], v[32:35], a[40:43], v[136:139]
    buffer_load_dwordx4 a[112:115], v252, s[20:23], s53 offen offset:3072 sc1
    v_mfma_f32_16x16x32_bf16 v[140:143], v[32:35], a[44:47], v[140:143]
    ds_read_b64_tr_b16 v[32:33], v6 offset:12288
    v_mfma_f32_16x16x32_bf16 v[144:147], v[36:39], a[32:35], v[144:147]
    buffer_load_dwordx4 a[116:119], v253, s[20:23], s53 offen offset:3072 sc1
    ds_read_b64_tr_b16 v[34:35], v6 offset:12800
    v_mfma_f32_16x16x32_bf16 v[148:151], v[36:39], a[36:39], v[148:151]
    buffer_load_dwordx4 a[120:123], v254, s[20:23], s53 offen offset:3072 sc1
    v_mfma_f32_16x16x32_bf16 v[152:155], v[36:39], a[40:43], v[152:155]
    buffer_load_dwordx4 a[124:127], v255, s[20:23], s53 offen offset:3072 sc1
    v_mfma_f32_16x16x32_bf16 v[156:159], v[36:39], a[44:47], v[156:159]
    ds_read_b64_tr_b16 v[36:37], v7 offset:12288
    ds_read_b64_tr_b16 v[38:39], v7 offset:12800
    s_cbranch_vccz KF_s2
    s_waitcnt lgkmcnt(8)
    v_mfma_f32_16x16x32_bf16 v[160:163], v[40:43], a[32:35], v[160:163]
    v_mfma_f32_16x16x32_bf16 v[164:167], v[40:43], a[36:39], v[164:167]
    v_mfma_f32_16x16x32_bf16 v[168:171], v[40:43], a[40:43], v[168:171]
    v_mfma_f32_16x16x32_bf16 v[172:175], v[40:43], a[44:47], v[172:175]
    ds_read_b64_tr_b16 v[40:41], v8 offset:12288
    v_mfma_f32_16x16x32_bf16 v[176:179], v[44:47], a[32:35], v[176:179]
    ds_read_b64_tr_b16 v[42:43], v8 offset:12800
    v_mfma_f32_16x16x32_bf16 v[180:183], v[44:47], a[36:39], v[180:183]
    v_mfma_f32_16x16x32_bf16 v[184:187], v[44:47], a[40:43], v[184:187]
    v_mfma_f32_16x16x32_bf16 v[188:191], v[44:47], a[44:47], v[188:191]
    ds_read_b64_tr_b16 v[44:45], v9 offset:12288
    ds_read_b64_tr_b16 v[46:47], v9 offset:12800
KF_s2:
    s_waitcnt lgkmcnt(8)
    v_mfma_f32_16x16x32_bf16 v[64:67], v[16:19], a[32:35], v[64:67]
    buffer_load_dwordx4 a[128:131], v252, s[20:23], s54 offen offset:0 sc1
    v_mfma_f32_16x16x32_bf16 v[68:71], v[16:19], a[36:39], v[68:71]
    buffer_load_dwordx4 a[132:135], v253, s[20:23], s54 offen offset:0 sc1
    v_mfma_f32_16x16x32_bf16 v[72:75], v[16:19], a[40:43], v[72:75]
    buffer_load_dwordx4 a[136:139], v254, s[20:23], s54 offen offset:0 sc1
    v_mfma_f32_16x16x32_bf16 v[76:79], v[16:19], a[44:47], v[76:79]
    ds_read_b64_tr_b16 v[16:17], v2 offset:12288
    v_mfma_f32_16x16x32_bf16 v[80:83], v[20:23], a[32:35], v[80:83]
    buffer_load_dwordx4 a[140:143], v255, s[20:23], s54 offen offset:0 sc1
    ds_read_b64_tr_b16 v[18:19], v2 offset:12800
    v_mfma_f32_16x16x32_bf16 v[84:87], v[20:23], a[36:39], v[84:87]
    v_mfma_f32_16x16x32_bf16 v[88:91], v[20:23], a[40:43], v[88:91]
    v_mfma_f32_16x16x32_bf16 v[92:95], v[20:23], a[44:47], v[92:95]
    s_waitcnt lgkmcnt(6)
    ds_read_b64_tr_b16 v[20:21], v3 offset:12288
    v_mfma_f32_16x16x32_bf16 v[96:99], v[24:27], a[32:35], v[96:99]
    ds_read_b64_tr_b16 v[22:23], v3 offset:12800
    v_mfma_f32_16x16x32_bf16 v[100:103], v[24:27], a[36:39], v[100:103]
    v_mfma_f32_16x16x32_bf16 v[104:107], v[24:27], a[40:43], v[104:107]
    v_mfma_f32_16x16x32_bf16 v[108:111], v[24:27], a[44:47], v[108:111]
    ds_read_b64_tr_b16 v[24:25], v4 offset:12288
    v_mfma_f32_16x16x32_bf16 v[112:115], v[28:31], a[32:35], v[112:115]
    ds_read_b64_tr_b16 v[26:27], v4 offset:12800
    v_mfma_f32_16x16x32_bf16 v[116:119], v[28:31], a[36:39], v[116:119]
    v_mfma_f32_16x16x32_bf16 v[120:123], v[28:31], a[40:43], v[120:123]
    s_waitcnt vmcnt(21)
    v_mfma_f32_16x16x32_bf16 v[124:127], v[28:31], a[44:47], v[124:127]
    s_waitcnt lgkmcnt(6)
    ds_read_b64_tr_b16 v[28:29], v5 offset:12288
    v_mfma_f32_16x16x32_bf16 v[128:131], v[32:35], a[48:51], v[128:131]
    ds_read_b64_tr_b16 v[30:31], v5 offset:12800
    v_mfma_f32_16x16x32_bf16 v[132:135], v[32:35], a[52:55], v[132:135]
    s_barrier
    v_mfma_f32_16x16x32_bf16 v[136:139], v[32:35], a[56:59], v[136:139]
    buffer_load_dwordx4 a[144:147], v252, s[20:23], s54 offen offset:1024 sc1
    v_mfma_f32_16x16x32_bf16 v[140:143], v[32:35], a[60:63], v[140:143]
    ds_read_b64_tr_b16 v[32:33], v6 offset:16384
    v_mfma_f32_16x16x32_bf16 v[144:147], v[36:39], a[48:51], v[144:147]
    buffer_load_dwordx4 a[148:151], v253, s[20:23], s54 offen offset:1024 sc1
    ds_read_b64_tr_b16 v[34:35], v6 offset:16896
    v_mfma_f32_16x16x32_bf16 v[148:151], v[36:39], a[52:55], v[148:151]
    s_add_u32 m0, s66, 73728
    v_mfma_f32_16x16x32_bf16 v[152:155], v[36:39], a[56:59], v[152:155]
    global_load_lds_dwordx4 v[248:249], off
    v_mfma_f32_16x16x32_bf16 v[156:159], v[36:39], a[60:63], v[156:159]
    ds_read_b64_tr_b16 v[36:37], v7 offset:16384
    ds_read_b64_tr_b16 v[38:39], v7 offset:16896
    s_cbranch_vccz KF_s3
    s_waitcnt lgkmcnt(8)
    v_mfma_f32_16x16x32_bf16 v[160:163], v[40:43], a[48:51], v[160:163]
    v_mfma_f32_16x16x32_bf16 v[164:167], v[40:43], a[52:55], v[164:167]
    v_mfma_f32_16x16x32_bf16 v[168:171], v[40:43], a[56:59], v[168:171]
    v_mfma_f32_16x16x32_bf16 v[172:175], v[40:43], a[60:63], v[172:175]
    ds_read_b64_tr_b16 v[40:41], v8 offset:16384
    v_mfma_f32_16x16x32_bf16 v[176:179], v[44:47], a[48:51], v[176:179]
    ds_read_b64_tr_b16 v[42:43], v8 offset:16896
    v_mfma_f32_16x16x32_bf16 v[180:183], v[44:47], a[52:55], v[180:183]
    v_mfma_f32_16x16x32_bf16 v[184:187], v[44:47], a[56:59], v[184:187]
    v_mfma_f32_16x16x32_bf16 v[188:191], v[44:47], a[60:63], v[188:191]
    ds_read_b64_tr_b16 v[44:45], v9 offset:16384
    ds_read_b64_tr_b16 v[46:47], v9 offset:16896
KF_s3:
    s_waitcnt lgkmcnt(8)
    v_mfma_f32_16x16x32_bf16 v[64:67], v[16:19], a[48:51], v[64:67]
    v_lshl_add_u64 v[248:249], v[248:249], 0, s[100:101]
    v_mfma_f32_16x16x32_bf16 v[68:71], v[16:19], a[52:55], v[68:71]
    buffer_load_dwordx4 a[152:155], v254, s[20:23], s54 offen offset:1024 sc1
    v_mfma_f32_16x16x32_bf16 v[72:75], v[16:19], a[56:59], v[72:75]
    buffer_load_dwordx4 a[156:159], v255, s[20:23], s54 offen offset:1024 sc1
    v_mfma_f32_16x16x32_bf16 v[76:79], v[16:19], a[60:63], v[76:79]
    ds_read_b64_tr_b16 v[16:17], v2 offset:16384
    v_mfma_f32_16x16x32_bf16 v[80:83], v[20:23], a[48:51], v[80:83]
    buffer_load_dwordx4 a[160:163], v252, s[20:23], s54 offen offset:2048 sc1
    ds_read_b64_tr_b16 v[18:19], v2 offset:16896
    v_mfma_f32_16x16x32_bf16 v[84:87], v[20:23], a[52:55], v[84:87]
    buffer_load_dwordx4 a[164:167], v253, s[20:23], s54 offen offset:2048 sc1
    v_mfma_f32_16x16x32_bf16 v[88:91], v[20:23], a[56:59], v[88:91]
    buffer_load_dwordx4 a[168:171], v254, s[20:23], s54 offen offset:2048 sc1
    v_mfma_f32_16x16x32_bf16 v[92:95], v[20:23], a[60:63], v[92:95]
    s_waitcnt lgkmcnt(6)
    ds_read_b64_tr_b16 v[20:21], v3 offset:16384
    v_mfma_f32_16x16x32_bf16 v[96:99], v[24:27], a[48:51], v[96:99]
    buffer_load_dwordx4 a[172:175], v255, s[20:23], s54 offen offset:2048 sc1
    ds_read_b64_tr_b16 v[22:23], v3 offset:16896
    v_mfma_f32_16x16x32_bf16 v[100:103], v[24:27], a[52:55], v[100:103]
    v_mfma_f32_16x16x32_bf16 v[104:107], v[24:27], a[56:59], v[104:107]
    v_mfma_f32_16x16x32_bf16 v[108:111], v[24:27], a[60:63], v[108:111]
    ds_read_b64_tr_b16 v[24:25], v4 offset:16384
    v_mfma_f32_16x16x32_bf16 v[112:115], v[28:31], a[48:51], v[112:115]
    ds_read_b64_tr_b16 v[26:27], v4 offset:16896
    v_mfma_f32_16x16x32_bf16 v[116:119], v[28:31], a[52:55], v[116:119]
    v_mfma_f32_16x16x32_bf16 v[120:123], v[28:31], a[56:59], v[120:123]
    s_waitcnt vmcnt(26)
    v_mfma_f32_16x16x32_bf16 v[124:127], v[28:31], a[60:63], v[124:127]
    s_waitcnt lgkmcnt(6)
    ds_read_b64_tr_b16 v[28:29], v5 offset:16384
    v_mfma_f32_16x16x32_bf16 v[128:131], v[32:35], a[64:67], v[128:131]
    ds_read_b64_tr_b16 v[30:31], v5 offset:16896
    v_mfma_f32_16x16x32_bf16 v[132:135], v[32:35], a[68:71], v[132:135]
    v_mfma_f32_16x16x32_bf16 v[136:139], v[32:35], a[72:75], v[136:139]
    buffer_load_dwordx4 a[176:179], v252, s[20:23], s54 offen offset:3072 sc1
    v_mfma_f32_16x16x32_bf16 v[140:143], v[32:35], a[76:79], v[140:143]
    ds_read_b64_tr_b16 v[32:33], v6 offset:20480
    v_mfma_f32_16x16x32_bf16 v[144:147], v[36:39], a[64:67], v[144:147]
    ds_read_b64_tr_b16 v[34:35], v6 offset:20992
    v_mfma_f32_16x16x32_bf16 v[148:151], v[36:39], a[68:71], v[148:151]
    buffer_load_dwordx4 a[180:183], v253, s[20:23], s54 offen offset:3072 sc1
    v_mfma_f32_16x16x32_bf16 v[152:155], v[36:39], a[72:75], v[152:155]
    v_mfma_f32_16x16x32_bf16 v[156:159], v[36:39], a[76:79], v[156:159]
    ds_read_b64_tr_b16 v[36:37], v7 offset:20480
    ds_read_b64_tr_b16 v[38:39], v7 offset:20992
    s_cbranch_vccz KF_s4
    s_waitcnt lgkmcnt(8)
    v_mfma_f32_16x16x32_bf16 v[160:163], v[40:43], a[64:67], v[160:163]
    v_mfma_f32_16x16x32_bf16 v[164:167], v[40:43], a[68:71], v[164:167]
    v_mfma_f32_16x16x32_bf16 v[168:171], v[40:43], a[72:75], v[168:171]
    v_mfma_f32_16x16x32_bf16 v[172:175], v[40:43], a[76:79], v[172:175]
    ds_read_b64_tr_b16 v[40:41], v8 offset:20480
    v_mfma_f32_16x16x32_bf16 v[176:179], v[44:47], a[64:67], v[176:179]
    ds_read_b64_tr_b16 v[42:43], v8 offset:20992
    v_mfma_f32_16x16x32_bf16 v[180:183], v[44:47], a[68:71], v[180:183]
    v_mfma_f32_16x16x32_bf16 v[184:187], v[44:47], a[72:75], v[184:187]
    v_mfma_f32_16x16x32_bf16 v[188:191], v[44:47], a[76:79], v[188:191]
    ds_read_b64_tr_b16 v[44:45], v9 offset:20480
    ds_read_b64_tr_b16 v[46:47], v9 offset:20992
KF_s4:
    s_waitcnt lgkmcnt(8)
    v_mfma_f32_16x16x32_bf16 v[64:67], v[16:19], a[64:67], v[64:67]
    s_add_u32 m0, s66, 77824
    v_mfma_f32_16x16x32_bf16 v[68:71], v[16:19], a[68:71], v[68:71]
    v_mfma_f32_16x16x32_bf16 v[72:75], v[16:19], a[72:75], v[72:75]
    global_load_lds_dwordx4 v[248:249], off
    v_mfma_f32_16x16x32_bf16 v[76:79], v[16:19], a[76:79], v[76:79]
    ds_read_b64_tr_b16 v[16:17], v2 offset:20480
    v_mfma_f32_16x16x32_bf16 v[80:83], v[20:23], a[64:67], v[80:83]
    ds_read_b64_tr_b16 v[18:19], v2 offset:20992
    v_lshl_add_u64 v[248:249], v[248:249], 0, s[100:101]
    v_mfma_f32_16x16x32_bf16 v[84:87], v[20:23], a[68:71], v[84:87]
    v_mfma_f32_16x16x32_bf16 v[88:91], v[20:23], a[72:75], v[88:91]
    buffer_load_dwordx4 a[184:187], v254, s[20:23], s54 offen offset:3072 sc1
    v_mfma_f32_16x16x32_bf16 v[92:95], v[20:23], a[76:79], v[92:95]
    s_waitcnt lgkmcnt(6)
    ds_read_b64_tr_b16 v[20:21], v3 offset:20480
    v_mfma_f32_16x16x32_bf16 v[96:99], v[24:27], a[64:67], v[96:99]
    buffer_load_dwordx4 a[188:191], v255, s[20:23], s54 offen offset:3072 sc1
    ds_read_b64_tr_b16 v[22:23], v3 offset:20992
    v_mfma_f32_16x16x32_bf16 v[100:103], v[24:27], a[68:71], v[100:103]
    v_mfma_f32_16x16x32_bf16 v[104:107], v[24:27], a[72:75], v[104:107]
    v_mfma_f32_16x16x32_bf16 v[108:111], v[24:27], a[76:79], v[108:111]
    ds_read_b64_tr_b16 v[24:25], v4 offset:20480
    v_mfma_f32_16x16x32_bf16 v[112:115], v[28:31], a[64:67], v[112:115]
    ds_read_b64_tr_b16 v[26:27], v4 offset:20992
    v_mfma_f32_16x16x32_bf16 v[116:119], v[28:31], a[68:71], v[116:119]
    v_mfma_f32_16x16x32_bf16 v[120:123], v[28:31], a[72:75], v[120:123]
    s_waitcnt vmcnt(26)
    v_mfma_f32_16x16x32_bf16 v[124:127], v[28:31], a[76:79], v[124:127]
    s_waitcnt lgkmcnt(6)
    ds_read_b64_tr_b16 v[28:29], v5 offset:20480
    v_mfma_f32_16x16x32_bf16 v[128:131], v[32:35], a[80:83], v[128:131]
    ds_read_b64_tr_b16 v[30:31], v5 offset:20992
    v_mfma_f32_16x16x32_bf16 v[132:135], v[32:35], a[84:87], v[132:135]
    v_mfma_f32_16x16x32_bf16 v[136:139], v[32:35], a[88:91], v[136:139]
    buffer_load_dwordx4 a[192:195], v252, s[20:23], s55 offen offset:0 sc1
    v_mfma_f32_16x16x32_bf16 v[140:143], v[32:35], a[92:95], v[140:143]
    ds_read_b64_tr_b16 v[32:33], v6 offset:24576
    v_mfma_f32_16x16x32_bf16 v[144:147], v[36:39], a[80:83], v[144:147]
    ds_read_b64_tr_b16 v[34:35], v6 offset:25088
    v_mfma_f32_16x16x32_bf16 v[148:151], v[36:39], a[84:87], v[148:151]
    buffer_load_dwordx4 a[196:199], v253, s[20:23], s55 offen offset:0 sc1
    v_mfma_f32_16x16x32_bf16 v[152:155], v[36:39], a[88:91], v[152:155]
    v_mfma_f32_16x16x32_bf16 v[156:159], v[36:39], a[92:95], v[156:159]
    ds_read_b64_tr_b16 v[36:37], v7 offset:24576
    ds_read_b64_tr_b16 v[38:39], v7 offset:25088
    s_cbranch_vccz KF_s5
    s_waitcnt lgkmcnt(8)
    v_mfma_f32_16x16x32_bf16 v[160:163], v[40:43], a[80:83], v[160:163]
    v_mfma_f32_16x16x32_bf16 v[164:167], v[40:43], a[84:87], v[164:167]
    v_mfma_f32_16x16x32_bf16 v[168:171], v[40:43], a[88:91], v[168:171]
    v_mfma_f32_16x16x32_bf16 v[172:175], v[40:43], a[92:95], v[172:175]
    ds_read_b64_tr_b16 v[40:41], v8 offset:24576
    v_mfma_f32_16x16x32_bf16 v[176:179], v[44:47], a[80:83], v[176:179]
    ds_read_b64_tr_b16 v[42:43], v8 offset:25088
    v_mfma_f32_16x16x32_bf16 v[180:183], v[44:47], a[84:87], v[180:183]
    v_mfma_f32_16x16x32_bf16 v[184:187], v[44:47], a[88:91], v[184:187]
    v_mfma_f32_16x16x32_bf16 v[188:191], v[44:47], a[92:95], v[188:191]
    ds_read_b64_tr_b16 v[44:45], v9 offset:24576
    ds_read_b64_tr_b16 v[46:47], v9 offset:25088
KF_s5:
    s_waitcnt lgkmcnt(8)
    v_mfma_f32_16x16x32_bf16 v[64:67], v[16:19], a[80:83], v[64:67]
    s_add_u32 m0, s66, 81920
    v_mfma_f32_16x16x32_bf16 v[68:71], v[16:19], a[84:87], v[68:71]
    v_mfma_f32_16x16x32_bf16 v[72:75], v[16:19], a[88:91], v[72:75]
    global_load_lds_dwordx4 v[248:249], off
    v_mfma_f32_16x16x32_bf16 v[76:79], v[16:19], a[92:95], v[76:79]
    ds_read_b64_tr_b16 v[16:17], v2 offset:24576
    v_mfma_f32_16x16x32_bf16 v[80:83], v[20:23], a[80:83], v[80:83]
    ds_read_b64_tr_b16 v[18:19], v2 offset:25088
    v_lshl_add_u64 v[248:249], v[248:249], 0, s[100:101]
    v_mfma_f32_16x16x32_bf16 v[84:87], v[20:23], a[84:87], v[84:87]
    v_mfma_f32_16x16x32_bf16 v[88:91], v[20:23], a[88:91], v[88:91]
    buffer_load_dwordx4 a[200:203], v254, s[20:23], s55 offen offset:0 sc1
    v_mfma_f32_16x16x32_bf16 v[92:95], v[20:23], a[92:95], v[92:95]
    s_waitcnt lgkmcnt(6)
    ds_read_b64_tr_b16 v[20:21], v3 offset:24576
    v_mfma_f32_16x16x32_bf16 v[96:99], v[24:27], a[80:83], v[96:99]
    buffer_load_dwordx4 a[204:207], v255, s[20:23], s55 offen offset:0 sc1
    ds_read_b64_tr_b16 v[22:23], v3 offset:25088
    v_mfma_f32_16x16x32_bf16 v[100:103], v[24:27], a[84:87], v[100:103]
    v_mfma_f32_16x16x32_bf16 v[104:107], v[24:27], a[88:91], v[104:107]
    global_load_dword v12, v13, s[60:61]
    v_mfma_f32_16x16x32_bf16 v[108:111], v[24:27], a[92:95], v[108:111]
    ds_read_b64_tr_b16 v[24:25], v4 offset:24576
    v_mfma_f32_16x16x32_bf16 v[112:115], v[28:31], a[80:83], v[112:115]
    ds_read_b64_tr_b16 v[26:27], v4 offset:25088
    v_mfma_f32_16x16x32_bf16 v[116:119], v[28:31], a[84:87], v[116:119]
    v_mfma_f32_16x16x32_bf16 v[120:123], v[28:31], a[88:91], v[120:123]
    s_waitcnt vmcnt(28)
    v_mfma_f32_16x16x32_bf16 v[124:127], v[28:31], a[92:95], v[124:127]
    s_waitcnt lgkmcnt(6)
    ds_read_b64_tr_b16 v[28:29], v5 offset:24576
    v_mfma_f32_16x16x32_bf16 v[128:131], v[32:35], a[96:99], v[128:131]
    ds_read_b64_tr_b16 v[30:31], v5 offset:25088
    v_mfma_f32_16x16x32_bf16 v[132:135], v[32:35], a[100:103], v[132:135]
    s_barrier
    v_mfma_f32_16x16x32_bf16 v[136:139], v[32:35], a[104:107], v[136:139]
    buffer_load_dwordx4 a[208:211], v252, s[20:23], s55 offen offset:1024 sc1
    v_mfma_f32_16x16x32_bf16 v[140:143], v[32:35], a[108:111], v[140:143]
    ds_read_b64_tr_b16 v[32:33], v6 offset:28672
    v_mfma_f32_16x16x32_bf16 v[144:147], v[36:39], a[96:99], v[144:147]
    ds_read_b64_tr_b16 v[34:35], v6 offset:29184
    v_mfma_f32_16x16x32_bf16 v[148:151], v[36:39], a[100:103], v[148:151]
    buffer_load_dwordx4 a[212:215], v253, s[20:23], s55 offen offset:1024 sc1
    v_mfma_f32_16x16x32_bf16 v[152:155], v[36:39], a[104:107], v[152:155]
    v_mfma_f32_16x16x32_bf16 v[156:159], v[36:39], a[108:111], v[156:159]
    ds_read_b64_tr_b16 v[36:37], v7 offset:28672
    ds_read_b64_tr_b16 v[38:39], v7 offset:29184
    s_cbranch_vccz KF_s6
    s_waitcnt lgkmcnt(8)
    v_mfma_f32_16x16x32_bf16 v[160:163], v[40:43], a[96:99], v[160:163]
    v_mfma_f32_16x16x32_bf16 v[164:167], v[40:43], a[100:103], v[164:167]
    v_mfma_f32_16x16x32_bf16 v[168:171], v[40:43], a[104:107], v[168:171]
    v_mfma_f32_16x16x32_bf16 v[172:175], v[40:43], a[108:111], v[172:175]
    ds_read_b64_tr_b16 v[40:41], v8 offset:28672
    v_mfma_f32_16x16x32_bf16 v[176:179], v[44:47], a[96:99], v[176:179]
    ds_read_b64_tr_b16 v[42:43], v8 offset:29184
    v_mfma_f32_16x16x32_bf16 v[180:183], v[44:47], a[100:103], v[180:183]
    v_mfma_f32_16x16x32_bf16 v[184:187], v[44:47], a[104:107], v[184:187]
    v_mfma_f32_16x16x32_bf16 v[188:191], v[44:47], a[108:111], v[188:191]
    ds_read_b64_tr_b16 v[44:45], v9 offset:28672
    ds_read_b64_tr_b16 v[46:47], v9 offset:29184
KF_s6:
    s_waitcnt lgkmcnt(8)
    v_mfma_f32_16x16x32_bf16 v[64:67], v[16:19], a[96:99], v[64:67]
    s_add_u32 m0, s66, 86016
    v_mfma_f32_16x16x32_bf16 v[68:71], v[16:19], a[100:103], v[68:71]
    v_mfma_f32_16x16x32_bf16 v[72:75], v[16:19], a[104:107], v[72:75]
    global_load_lds_dwordx4 v[248:249], off
    v_mfma_f32_16x16x32_bf16 v[76:79], v[16:19], a[108:111], v[76:79]
    ds_read_b64_tr_b16 v[16:17], v2 offset:28672
    v_mfma_f32_16x16x32_bf16 v[80:83], v[20:23], a[96:99], v[80:83]
    ds_read_b64_tr_b16 v[18:19], v2 offset:29184
    v_lshl_add_u64 v[248:249], v[248:249], 0, s[100:101]
    v_mfma_f32_16x16x32_bf16 v[84:87], v[20:23], a[100:103], v[84:87]
    v_mfma_f32_16x16x32_bf16 v[88:91], v[20:23], a[104:107], v[88:91]
    buffer_load_dwordx4 a[216:219], v254, s[20:23], s55 offen offset:1024 sc1
    v_mfma_f32_16x16x32_bf16 v[92:95], v[20:23], a[108:111], v[92:95]
    s_waitcnt lgkmcnt(6)
    ds_read_b64_tr_b16 v[20:21], v3 offset:28672
    v_mfma_f32_16x16x32_bf16 v[96:99], v[24:27], a[96:99], v[96:99]
    buffer_load_dwordx4 a[220:223], v255, s[20:23], s55 offen offset:1024 sc1
    ds_read_b64_tr_b16 v[22:23], v3 offset:29184
    v_mfma_f32_16x16x32_bf16 v[100:103], v[24:27], a[100:103], v[100:103]
    v_mfma_f32_16x16x32_bf16 v[104:107], v[24:27], a[104:107], v[104:107]
    v_mfma_f32_16x16x32_bf16 v[108:111], v[24:27], a[108:111], v[108:111]
    ds_read_b64_tr_b16 v[24:25], v4 offset:28672
    v_mfma_f32_16x16x32_bf16 v[112:115], v[28:31], a[96:99], v[112:115]
    ds_read_b64_tr_b16 v[26:27], v4 offset:29184
    v_mfma_f32_16x16x32_bf16 v[116:119], v[28:31], a[100:103], v[116:119]
    v_mfma_f32_16x16x32_bf16 v[120:123], v[28:31], a[104:107], v[120:123]
    s_waitcnt vmcnt(29)
    v_mfma_f32_16x16x32_bf16 v[124:127], v[28:31], a[108:111], v[124:127]
    s_waitcnt lgkmcnt(6)
    ds_read_b64_tr_b16 v[28:29], v5 offset:28672
    v_mfma_f32_16x16x32_bf16 v[128:131], v[32:35], a[112:115], v[128:131]
    ds_read_b64_tr_b16 v[30:31], v5 offset:29184
    v_mfma_f32_16x16x32_bf16 v[132:135], v[32:35], a[116:119], v[132:135]
    v_mfma_f32_16x16x32_bf16 v[136:139], v[32:35], a[120:123], v[136:139]
    buffer_load_dwordx4 a[224:227], v252, s[20:23], s55 offen offset:2048 sc1
    v_mfma_f32_16x16x32_bf16 v[140:143], v[32:35], a[124:127], v[140:143]
    ds_read_b64_tr_b16 v[32:33], v6 offset:32768
    v_mfma_f32_16x16x32_bf16 v[144:147], v[36:39], a[112:115], v[144:147]
    ds_read_b64_tr_b16 v[34:35], v6 offset:33280
    v_mfma_f32_16x16x32_bf16 v[148:151], v[36:39], a[116:119], v[148:151]
    buffer_load_dwordx4 a[228:231], v253, s[20:23], s55 offen offset:2048 sc1
    v_mfma_f32_16x16x32_bf16 v[152:155], v[36:39], a[120:123], v[152:155]
    v_mfma_f32_16x16x32_bf16 v[156:159], v[36:39], a[124:127], v[156:159]
    ds_read_b64_tr_b16 v[36:37], v7 offset:32768
    ds_read_b64_tr_b16 v[38:39], v7 offset:33280
    s_cbranch_vccz KF_s7
    s_waitcnt lgkmcnt(8)
    v_mfma_f32_16x16x32_bf16 v[160:163], v[40:43], a[112:115], v[160:163]
    v_mfma_f32_16x16x32_bf16 v[164:167], v[40:43], a[116:119], v[164:167]
    v_mfma_f32_16x16x32_bf16 v[168:171], v[40:43], a[120:123], v[168:171]
    v_mfma_f32_16x16x32_bf16 v[172:175], v[40:43], a[124:127], v[172:175]
    ds_read_b64_tr_b16 v[40:41], v8 offset:32768
    v_mfma_f32_16x16x32_bf16 v[176:179], v[44:47], a[112:115], v[176:179]
    ds_read_b64_tr_b16 v[42:43], v8 offset:33280
    v_mfma_f32_16x16x32_bf16 v[180:183], v[44:47], a[116:119], v[180:183]
    v_mfma_f32_16x16x32_bf16 v[184:187], v[44:47], a[120:123], v[184:187]
    v_mfma_f32_16x16x32_bf16 v[188:191], v[44:47], a[124:127], v[188:191]
    ds_read_b64_tr_b16 v[44:45], v9 offset:32768
    ds_read_b64_tr_b16 v[46:47], v9 offset:33280
KF_s7:
    s_waitcnt lgkmcnt(8)
    v_mfma_f32_16x16x32_bf16 v[64:67], v[16:19], a[112:115], v[64:67]
    s_add_u32 m0, s66, 90112
    v_mfma_f32_16x16x32_bf16 v[68:71], v[16:19], a[116:119], v[68:71]
    v_mfma_f32_16x16x32_bf16 v[72:75], v[16:19], a[120:123], v[72:75]
    global_load_lds_dwordx4 v[248:249], off
    v_mfma_f32_16x16x32_bf16 v[76:79], v[16:19], a[124:127], v[76:79]
    ds_read_b64_tr_b16 v[16:17], v2 offset:32768
    v_mfma_f32_16x16x32_bf16 v[80:83], v[20:23], a[112:115], v[80:83]
    ds_read_b64_tr_b16 v[18:19], v2 offset:33280
    v_lshl_add_u64 v[248:249], v[248:249], 0, s[100:101]
    v_mfma_f32_16x16x32_bf16 v[84:87], v[20:23], a[116:119], v[84:87]
    v_mfma_f32_16x16x32_bf16 v[88:91], v[20:23], a[120:123], v[88:91]
    buffer_load_dwordx4 a[232:235], v254, s[20:23], s55 offen offset:2048 sc1
    v_mfma_f32_16x16x32_bf16 v[92:95], v[20:23], a[124:127], v[92:95]
    s_waitcnt lgkmcnt(6)
    ds_read_b64_tr_b16 v[20:21], v3 offset:32768
    v_mfma_f32_16x16x32_bf16 v[96:99], v[24:27], a[112:115], v[96:99]
    buffer_load_dwordx4 a[236:239], v255, s[20:23], s55 offen offset:2048 sc1
    ds_read_b64_tr_b16 v[22:23], v3 offset:33280
    v_mfma_f32_16x16x32_bf16 v[100:103], v[24:27], a[116:119], v[100:103]
    v_mfma_f32_16x16x32_bf16 v[104:107], v[24:27], a[120:123], v[104:107]
    v_mfma_f32_16x16x32_bf16 v[108:111], v[24:27], a[124:127], v[108:111]
    ds_read_b64_tr_b16 v[24:25], v4 offset:32768
    v_mfma_f32_16x16x32_bf16 v[112:115], v[28:31], a[112:115], v[112:115]
    ds_read_b64_tr_b16 v[26:27], v4 offset:33280
    v_mfma_f32_16x16x32_bf16 v[116:119], v[28:31], a[116:119], v[116:119]
    v_mfma_f32_16x16x32_bf16 v[120:123], v[28:31], a[120:123], v[120:123]
    s_waitcnt vmcnt(30)
    v_mfma_f32_16x16x32_bf16 v[124:127], v[28:31], a[124:127], v[124:127]
    s_waitcnt lgkmcnt(6)
    ds_read_b64_tr_b16 v[28:29], v5 offset:32768
    v_mfma_f32_16x16x32_bf16 v[128:131], v[32:35], a[128:131], v[128:131]
    ds_read_b64_tr_b16 v[30:31], v5 offset:33280
    v_mfma_f32_16x16x32_bf16 v[132:135], v[32:35], a[132:135], v[132:135]
    v_add_u32 v6, 36864, v6
    v_mfma_f32_16x16x32_bf16 v[136:139], v[32:35], a[136:139], v[136:139]
    buffer_load_dwordx4 a[240:243], v252, s[20:23], s55 offen offset:3072 sc1
    v_mfma_f32_16x16x32_bf16 v[140:143], v[32:35], a[140:143], v[140:143]
    ds_read_b64_tr_b16 v[32:33], v6 offset:0
    v_mfma_f32_16x16x32_bf16 v[144:147], v[36:39], a[128:131], v[144:147]
    ds_read_b64_tr_b16 v[34:35], v6 offset:512
    v_mfma_f32_16x16x32_bf16 v[148:151], v[36:39], a[132:135], v[148:151]
    buffer_load_dwordx4 a[244:247], v253, s[20:23], s55 offen offset:3072 sc1
    v_add_u32 v7, 36864, v7
    v_mfma_f32_16x16x32_bf16 v[152:155], v[36:39], a[136:139], v[152:155]
    v_mfma_f32_16x16x32_bf16 v[156:159], v[36:39], a[140:143], v[156:159]
    ds_read_b64_tr_b16 v[36:37], v7 offset:0
    ds_read_b64_tr_b16 v[38:39], v7 offset:512
    s_cbranch_vccz KF_s8
    s_waitcnt lgkmcnt(8)
    v_mfma_f32_16x16x32_bf16 v[160:163], v[40:43], a[128:131], v[160:163]
    v_mfma_f32_16x16x32_bf16 v[164:167], v[40:43], a[132:135], v[164:167]
    v_add_u32 v8, 36864, v8
    v_mfma_f32_16x16x32_bf16 v[168:171], v[40:43], a[136:139], v[168:171]
    v_mfma_f32_16x16x32_bf16 v[172:175], v[40:43], a[140:143], v[172:175]
    ds_read_b64_tr_b16 v[40:41], v8 offset:0
    v_mfma_f32_16x16x32_bf16 v[176:179], v[44:47], a[128:131], v[176:179]
    ds_read_b64_tr_b16 v[42:43], v8 offset:512
    v_mfma_f32_16x16x32_bf16 v[180:183], v[44:47], a[132:135], v[180:183]
    v_add_u32 v9, 36864, v9
    v_mfma_f32_16x16x32_bf16 v[184:187], v[44:47], a[136:139], v[184:187]
    v_mfma_f32_16x16x32_bf16 v[188:191], v[44:47], a[140:143], v[188:191]
    ds_read_b64_tr_b16 v[44:45], v9 offset:0
    ds_read_b64_tr_b16 v[46:47], v9 offset:512
KF_s8:
    s_waitcnt lgkmcnt(8)
    v_mfma_f32_16x16x32_bf16 v[64:67], v[16:19], a[128:131], v[64:67]
    s_add_u32 m0, s66, 94208
    v_mfma_f32_16x16x32_bf16 v[68:71], v[16:19], a[132:135], v[68:71]
    v_add_u32 v2, 36864, v2
    v_mfma_f32_16x16x32_bf16 v[72:75], v[16:19], a[136:139], v[72:75]
    global_load_lds_dwordx4 v[248:249], off
    v_mfma_f32_16x16x32_bf16 v[76:79], v[16:19], a[140:143], v[76:79]
    ds_read_b64_tr_b16 v[16:17], v2 offset:0
    v_mfma_f32_16x16x32_bf16 v[80:83], v[20:23], a[128:131], v[80:83]
    ds_read_b64_tr_b16 v[18:19], v2 offset:512
    v_lshl_add_u64 v[248:249], v[248:249], 0, s[100:101]
    v_mfma_f32_16x16x32_bf16 v[84:87], v[20:23], a[132:135], v[84:87]
    v_add_u32 v3, 36864, v3
    v_mfma_f32_16x16x32_bf16 v[88:91], v[20:23], a[136:139], v[88:91]
    buffer_load_dwordx4 a[248:251], v254, s[20:23], s55 offen offset:3072 sc1
    v_mfma_f32_16x16x32_bf16 v[92:95], v[20:23], a[140:143], v[92:95]
    s_waitcnt lgkmcnt(6)
    ds_read_b64_tr_b16 v[20:21], v3 offset:0
    v_mfma_f32_16x16x32_bf16 v[96:99], v[24:27], a[128:131], v[96:99]
    buffer_load_dwordx4 a[252:255], v255, s[20:23], s55 offen offset:3072 sc1
    ds_read_b64_tr_b16 v[22:23], v3 offset:512
    v_mfma_f32_16x16x32_bf16 v[100:103], v[24:27], a[132:135], v[100:103]
    v_add_u32 v4, 36864, v4
    v_mfma_f32_16x16x32_bf16 v[104:107], v[24:27], a[136:139], v[104:107]
    v_mfma_f32_16x16x32_bf16 v[108:111], v[24:27], a[140:143], v[108:111]
    ds_read_b64_tr_b16 v[24:25], v4 offset:0
    v_mfma_f32_16x16x32_bf16 v[112:115], v[28:31], a[128:131], v[112:115]
    ds_read_b64_tr_b16 v[26:27], v4 offset:512
    v_mfma_f32_16x16x32_bf16 v[116:119], v[28:31], a[132:135], v[116:119]
    v_add_u32 v5, 36864, v5
    v_mfma_f32_16x16x32_bf16 v[120:123], v[28:31], a[136:139], v[120:123]
    s_waitcnt vmcnt(30)
    v_mfma_f32_16x16x32_bf16 v[124:127], v[28:31], a[140:143], v[124:127]
    s_waitcnt lgkmcnt(6)
    ds_read_b64_tr_b16 v[28:29], v5 offset:0
    v_mfma_f32_16x16x32_bf16 v[128:131], v[32:35], a[144:147], v[128:131]
    ds_read_b64_tr_b16 v[30:31], v5 offset:512
    v_mfma_f32_16x16x32_bf16 v[132:135], v[32:35], a[148:151], v[132:135]
    s_barrier
    v_mfma_f32_16x16x32_bf16 v[136:139], v[32:35], a[152:155], v[136:139]
    buffer_load_dwordx4 v[192:195], v252, s[20:23], s56 offen offset:0 sc1
    v_mfma_f32_16x16x32_bf16 v[140:143], v[32:35], a[156:159], v[140:143]
    ds_read_b64_tr_b16 v[32:33], v6 offset:4096
    v_mfma_f32_16x16x32_bf16 v[144:147], v[36:39], a[144:147], v[144:147]
    ds_read_b64_tr_b16 v[34:35], v6 offset:4608
    v_mfma_f32_16x16x32_bf16 v[148:151], v[36:39], a[148:151], v[148:151]
    buffer_load_dwordx4 v[196:199], v253, s[20:23], s56 offen offset:0 sc1
    v_mfma_f32_16x16x32_bf16 v[152:155], v[36:39], a[152:155], v[152:155]
    v_mfma_f32_16x16x32_bf16 v[156:159], v[36:39], a[156:159], v[156:159]
    ds_read_b64_tr_b16 v[36:37], v7 offset:4096
    ds_read_b64_tr_b16 v[38:39], v7 offset:4608
    s_cbranch_vccz KF_s9
    s_waitcnt lgkmcnt(8)
    v_mfma_f32_16x16x32_bf16 v[160:163], v[40:43], a[144:147], v[160:163]
    v_mfma_f32_16x16x32_bf16 v[164:167], v[40:43], a[148:151], v[164:167]
    v_mfma_f32_16x16x32_bf16 v[168:171], v[40:43], a[152:155], v[168:171]
    v_mfma_f32_16x16x32_bf16 v[172:175], v[40:43], a[156:159], v[172:175]
    ds_read_b64_tr_b16 v[40:41], v8 offset:4096
    v_mfma_f32_16x16x32_bf16 v[176:179], v[44:47], a[144:147], v[176:179]
    ds_read_b64_tr_b16 v[42:43], v8 offset:4608
    v_mfma_f32_16x16x32_bf16 v[180:183], v[44:47], a[148:151], v[180:183]
    v_mfma_f32_16x16x32_bf16 v[184:187], v[44:47], a[152:155], v[184:187]
    v_mfma_f32_16x16x32_bf16 v[188:191], v[44:47], a[156:159], v[188:191]
    ds_read_b64_tr_b16 v[44:45], v9 offset:4096
    ds_read_b64_tr_b16 v[46:47], v9 offset:4608
KF_s9:
    s_waitcnt lgkmcnt(8)
    v_mfma_f32_16x16x32_bf16 v[64:67], v[16:19], a[144:147], v[64:67]
    s_add_u32 m0, s66, 98304
    v_mfma_f32_16x16x32_bf16 v[68:71], v[16:19], a[148:151], v[68:71]
    v_mfma_f32_16x16x32_bf16 v[72:75], v[16:19], a[152:155], v[72:75]
    global_load_lds_dwordx4 v[248:249], off
    v_mfma_f32_16x16x32_bf16 v[76:79], v[16:19], a[156:159], v[76:79]
    ds_read_b64_tr_b16 v[16:17], v2 offset:4096
    v_mfma_f32_16x16x32_bf16 v[80:83], v[20:23], a[144:147], v[80:83]
    ds_read_b64_tr_b16 v[18:19], v2 offset:4608
    v_lshl_add_u64 v[248:249], v[248:249], 0, s[100:101]
    v_mfma_f32_16x16x32_bf16 v[84:87], v[20:23], a[148:151], v[84:87]
    v_mfma_f32_16x16x32_bf16 v[88:91], v[20:23], a[152:155], v[88:91]
    buffer_load_dwordx4 v[200:203], v254, s[20:23], s56 offen offset:0 sc1
    v_mfma_f32_16x16x32_bf16 v[92:95], v[20:23], a[156:159], v[92:95]
    s_waitcnt lgkmcnt(6)
    ds_read_b64_tr_b16 v[20:21], v3 offset:4096
    v_mfma_f32_16x16x32_bf16 v[96:99], v[24:27], a[144:147], v[96:99]
    buffer_load_dwordx4 v[204:207], v255, s[20:23], s56 offen offset:0 sc1
    ds_read_b64_tr_b16 v[22:23], v3 offset:4608
    v_mfma_f32_16x16x32_bf16 v[100:103], v[24:27], a[148:151], v[100:103]
    v_mfma_f32_16x16x32_bf16 v[104:107], v[24:27], a[152:155], v[104:107]
    v_mfma_f32_16x16x32_bf16 v[108:111], v[24:27], a[156:159], v[108:111]
    ds_read_b64_tr_b16 v[24:25], v4 offset:4096
    v_mfma_f32_16x16x32_bf16 v[112:115], v[28:31], a[144:147], v[112:115]
    ds_read_b64_tr_b16 v[26:27], v4 offset:4608
    v_mfma_f32_16x16x32_bf16 v[116:119], v[28:31], a[148:151], v[116:119]
    v_mfma_f32_16x16x32_bf16 v[120:123], v[28:31], a[152:155], v[120:123]
    s_waitcnt vmcnt(31)
    v_mfma_f32_16x16x32_bf16 v[124:127], v[28:31], a[156:159], v[124:127]
    s_waitcnt lgkmcnt(6)
    ds_read_b64_tr_b16 v[28:29], v5 offset:4096
    v_mfma_f32_16x16x32_bf16 v[128:131], v[32:35], a[160:163], v[128:131]
    ds_read_b64_tr_b16 v[30:31], v5 offset:4608
    v_mfma_f32_16x16x32_bf16 v[132:135], v[32:35], a[164:167], v[132:135]
    v_mfma_f32_16x16x32_bf16 v[136:139], v[32:35], a[168:171], v[136:139]
    buffer_load_dwordx4 v[208:211], v252, s[20:23], s56 offen offset:1024 sc1
    v_mfma_f32_16x16x32_bf16 v[140:143], v[32:35], a[172:175], v[140:143]
    ds_read_b64_tr_b16 v[32:33], v6 offset:8192
    v_mfma_f32_16x16x32_bf16 v[144:147], v[36:39], a[160:163], v[144:147]
    ds_read_b64_tr_b16 v[34:35], v6 offset:8704
    v_mfma_f32_16x16x32_bf16 v[148:151], v[36:39], a[164:167], v[148:151]
    buffer_load_dwordx4 v[212:215], v253, s[20:23], s56 offen offset:1024 sc1
    v_mfma_f32_16x16x32_bf16 v[152:155], v[36:39], a[168:171], v[152:155]
    v_mfma_f32_16x16x32_bf16 v[156:159], v[36:39], a[172:175], v[156:159]
    ds_read_b64_tr_b16 v[36:37], v7 offset:8192
    ds_read_b64_tr_b16 v[38:39], v7 offset:8704
    s_cbranch_vccz KF_s10
    s_waitcnt lgkmcnt(8)
    v_mfma_f32_16x16x32_bf16 v[160:163], v[40:43], a[160:163], v[160:163]
    v_mfma_f32_16x16x32_bf16 v[164:167], v[40:43], a[164:167], v[164:167]
    v_mfma_f32_16x16x32_bf16 v[168:171], v[40:43], a[168:171], v[168:171]
    v_mfma_f32_16x16x32_bf16 v[172:175], v[40:43], a[172:175], v[172:175]
    ds_read_b64_tr_b16 v[40:41], v8 offset:8192
    v_mfma_f32_16x16x32_bf16 v[176:179], v[44:47], a[160:163], v[176:179]
    ds_read_b64_tr_b16 v[42:43], v8 offset:8704
    v_mfma_f32_16x16x32_bf16 v[180:183], v[44:47], a[164:167], v[180:183]
    v_mfma_f32_16x16x32_bf16 v[184:187], v[44:47], a[168:171], v[184:187]
    v_mfma_f32_16x16x32_bf16 v[188:191], v[44:47], a[172:175], v[188:191]
    ds_read_b64_tr_b16 v[44:45], v9 offset:8192
    ds_read_b64_tr_b16 v[46:47], v9 offset:8704
KF_s10:
    s_waitcnt lgkmcnt(8)
    v_mfma_f32_16x16x32_bf16 v[64:67], v[16:19], a[160:163], v[64:67]
    s_add_u32 m0, s66, 102400
    v_mfma_f32_16x16x32_bf16 v[68:71], v[16:19], a[164:167], v[68:71]
    v_mfma_f32_16x16x32_bf16 v[72:75], v[16:19], a[168:171], v[72:75]
    global_load_lds_dwordx4 v[248:249], off
    v_mfma_f32_16x16x32_bf16 v[76:79], v[16:19], a[172:175], v[76:79]
    ds_read_b64_tr_b16 v[16:17], v2 offset:8192
    v_mfma_f32_16x16x32_bf16 v[80:83], v[20:23], a[160:163], v[80:83]
    ds_read_b64_tr_b16 v[18:19], v2 offset:8704
    v_lshl_add_u64 v[248:249], v[248:249], 0, s[100:101]
    v_mfma_f32_16x16x32_bf16 v[84:87], v[20:23], a[164:167], v[84:87]
    v_mfma_f32_16x16x32_bf16 v[88:91], v[20:23], a[168:171], v[88:91]
    buffer_load_dwordx4 v[216:219], v254, s[20:23], s56 offen offset:1024 sc1
    v_mfma_f32_16x16x32_bf16 v[92:95], v[20:23], a[172:175], v[92:95]
    s_waitcnt lgkmcnt(6)
    ds_read_b64_tr_b16 v[20:21], v3 offset:8192
    v_mfma_f32_16x16x32_bf16 v[96:99], v[24:27], a[160:163], v[96:99]
    buffer_load_dwordx4 v[220:223], v255, s[20:23], s56 offen offset:1024 sc1
    ds_read_b64_tr_b16 v[22:23], v3 offset:8704
    v_mfma_f32_16x16x32_bf16 v[100:103], v[24:27], a[164:167], v[100:103]
    v_mfma_f32_16x16x32_bf16 v[104:107], v[24:27], a[168:171], v[104:107]
    global_load_dword v12, v13, s[4:5]
    v_mfma_f32_16x16x32_bf16 v[108:111], v[24:27], a[172:175], v[108:111]
    ds_read_b64_tr_b16 v[24:25], v4 offset:8192
    v_mfma_f32_16x16x32_bf16 v[112:115], v[28:31], a[160:163], v[112:115]
    ds_read_b64_tr_b16 v[26:27], v4 offset:8704
    v_mfma_f32_16x16x32_bf16 v[116:119], v[28:31], a[164:167], v[116:119]
    v_mfma_f32_16x16x32_bf16 v[120:123], v[28:31], a[168:171], v[120:123]
    s_waitcnt vmcnt(32)
    v_mfma_f32_16x16x32_bf16 v[124:127], v[28:31], a[172:175], v[124:127]
    s_waitcnt lgkmcnt(6)
    ds_read_b64_tr_b16 v[28:29], v5 offset:8192
    v_mfma_f32_16x16x32_bf16 v[128:131], v[32:35], a[176:179], v[128:131]
    ds_read_b64_tr_b16 v[30:31], v5 offset:8704
    v_mfma_f32_16x16x32_bf16 v[132:135], v[32:35], a[180:183], v[132:135]
    v_mfma_f32_16x16x32_bf16 v[136:139], v[32:35], a[184:187], v[136:139]
    s_add_u32 m0, s66, 106496
    v_mfma_f32_16x16x32_bf16 v[140:143], v[32:35], a[188:191], v[140:143]
    ds_read_b64_tr_b16 v[32:33], v6 offset:12288
    v_mfma_f32_16x16x32_bf16 v[144:147], v[36:39], a[176:179], v[144:147]
    ds_read_b64_tr_b16 v[34:35], v6 offset:12800
    v_mfma_f32_16x16x32_bf16 v[148:151], v[36:39], a[180:183], v[148:151]
    global_load_lds_dwordx4 v[248:249], off
    v_mfma_f32_16x16x32_bf16 v[152:155], v[36:39], a[184:187], v[152:155]
    v_mfma_f32_16x16x32_bf16 v[156:159], v[36:39], a[188:191], v[156:159]
    ds_read_b64_tr_b16 v[36:37], v7 offset:12288
    ds_read_b64_tr_b16 v[38:39], v7 offset:12800
    s_cbranch_vccz KF_s11
    s_waitcnt lgkmcnt(8)
    v_mfma_f32_16x16x32_bf16 v[160:163], v[40:43], a[176:179], v[160:163]
    v_mfma_f32_16x16x32_bf16 v[164:167], v[40:43], a[180:183], v[164:167]
    v_mfma_f32_16x16x32_bf16 v[168:171], v[40:43], a[184:187], v[168:171]
    v_mfma_f32_16x16x32_bf16 v[172:175], v[40:43], a[188:191], v[172:175]
    ds_read_b64_tr_b16 v[40:41], v8 offset:12288
    v_mfma_f32_16x16x32_bf16 v[176:179], v[44:47], a[176:179], v[176:179]
    ds_read_b64_tr_b16 v[42:43], v8 offset:12800
    v_mfma_f32_16x16x32_bf16 v[180:183], v[44:47], a[180:183], v[180:183]
    v_mfma_f32_16x16x32_bf16 v[184:187], v[44:47], a[184:187], v[184:187]
    v_mfma_f32_16x16x32_bf16 v[188:191], v[44:47], a[188:191], v[188:191]
    ds_read_b64_tr_b16 v[44:45], v9 offset:12288
    ds_read_b64_tr_b16 v[46:47], v9 offset:12800
KF_s11:
    s_waitcnt lgkmcnt(8)
    v_mfma_f32_16x16x32_bf16 v[64:67], v[16:19], a[176:179], v[64:67]
    v_lshl_add_u64 v[248:249], v[248:249], 0, s[100:101]
    v_mfma_f32_16x16x32_bf16 v[68:71], v[16:19], a[180:183], v[68:71]
    v_mfma_f32_16x16x32_bf16 v[72:75], v[16:19], a[184:187], v[72:75]
    v_mfma_f32_16x16x32_bf16 v[76:79], v[16:19], a[188:191], v[76:79]
    ds_read_b64_tr_b16 v[16:17], v2 offset:12288
    v_mfma_f32_16x16x32_bf16 v[80:83], v[20:23], a[176:179], v[80:83]
    ds_read_b64_tr_b16 v[18:19], v2 offset:12800
    v_mfma_f32_16x16x32_bf16 v[84:87], v[20:23], a[180:183], v[84:87]
    v_mfma_f32_16x16x32_bf16 v[88:91], v[20:23], a[184:187], v[88:91]
    v_mfma_f32_16x16x32_bf16 v[92:95], v[20:23], a[188:191], v[92:95]
    s_waitcnt lgkmcnt(6)
    ds_read_b64_tr_b16 v[20:21], v3 offset:12288
    v_mfma_f32_16x16x32_bf16 v[96:99], v[24:27], a[176:179], v[96:99]
    ds_read_b64_tr_b16 v[22:23], v3 offset:12800
    v_mfma_f32_16x16x32_bf16 v[100:103], v[24:27], a[180:183], v[100:103]
    v_mfma_f32_16x16x32_bf16 v[104:107], v[24:27], a[184:187], v[104:107]
    v_mfma_f32_16x16x32_bf16 v[108:111], v[24:27], a[188:191], v[108:111]
    ds_read_b64_tr_b16 v[24:25], v4 offset:12288
    v_mfma_f32_16x16x32_bf16 v[112:115], v[28:31], a[176:179], v[112:115]
    ds_read_b64_tr_b16 v[26:27], v4 offset:12800
    v_mfma_f32_16x16x32_bf16 v[116:119], v[28:31], a[180:183], v[116:119]
    v_mfma_f32_16x16x32_bf16 v[120:123], v[28:31], a[184:187], v[120:123]
    s_waitcnt vmcnt(28)
    v_mfma_f32_16x16x32_bf16 v[124:127], v[28:31], a[188:191], v[124:127]
    s_waitcnt lgkmcnt(6)
    ds_read_b64_tr_b16 v[28:29], v5 offset:12288
    v_mfma_f32_16x16x32_bf16 v[128:131], v[32:35], a[192:195], v[128:131]
    ds_read_b64_tr_b16 v[30:31], v5 offset:12800
    v_mfma_f32_16x16x32_bf16 v[132:135], v[32:35], a[196:199], v[132:135]
    s_barrier
    v_mfma_f32_16x16x32_bf16 v[136:139], v[32:35], a[200:203], v[136:139]
    s_add_u32 m0, s66, 110592
    v_mfma_f32_16x16x32_bf16 v[140:143], v[32:35], a[204:207], v[140:143]
    ds_read_b64_tr_b16 v[32:33], v6 offset:16384
    v_mfma_f32_16x16x32_bf16 v[144:147], v[36:39], a[192:195], v[144:147]
    ds_read_b64_tr_b16 v[34:35], v6 offset:16896
    v_mfma_f32_16x16x32_bf16 v[148:151], v[36:39], a[196:199], v[148:151]
    global_load_lds_dwordx4 v[248:249], off
    v_mfma_f32_16x16x32_bf16 v[152:155], v[36:39], a[200:203], v[152:155]
    v_mfma_f32_16x16x32_bf16 v[156:159], v[36:39], a[204:207], v[156:159]
    ds_read_b64_tr_b16 v[36:37], v7 offset:16384
    ds_read_b64_tr_b16 v[38:39], v7 offset:16896
    s_cbranch_vccz KF_s12
    s_waitcnt lgkmcnt(8)
    v_mfma_f32_16x16x32_bf16 v[160:163], v[40:43], a[192:195], v[160:163]
    v_mfma_f32_16x16x32_bf16 v[164:167], v[40:43], a[196:199], v[164:167]
    v_mfma_f32_16x16x32_bf16 v[168:171], v[40:43], a[200:203], v[168:171]
    v_mfma_f32_16x16x32_bf16 v[172:175], v[40:43], a[204:207], v[172:175]
    ds_read_b64_tr_b16 v[40:41], v8 offset:16384
    v_mfma_f32_16x16x32_bf16 v[176:179], v[44:47], a[192:195], v[176:179]
    ds_read_b64_tr_b16 v[42:43], v8 offset:16896
    v_mfma_f32_16x16x32_bf16 v[180:183], v[44:47], a[196:199], v[180:183]
    v_mfma_f32_16x16x32_bf16 v[184:187], v[44:47], a[200:203], v[184:187]
    v_mfma_f32_16x16x32_bf16 v[188:191], v[44:47], a[204:207], v[188:191]
    ds_read_b64_tr_b16 v[44:45], v9 offset:16384
    ds_read_b64_tr_b16 v[46:47], v9 offset:16896
KF_s12:
    s_waitcnt lgkmcnt(8)
    v_mfma_f32_16x16x32_bf16 v[64:67], v[16:19], a[192:195], v[64:67]
    v_lshl_add_u64 v[248:249], v[248:249], 0, s[100:101]
    v_mfma_f32_16x16x32_bf16 v[68:71], v[16:19], a[196:199], v[68:71]
    v_mfma_f32_16x16x32_bf16 v[72:75], v[16:19], a[200:203], v[72:75]
    v_mfma_f32_16x16x32_bf16 v[76:79], v[16:19], a[204:207], v[76:79]
    ds_read_b64_tr_b16 v[16:17], v2 offset:16384
    v_mfma_f32_16x16x32_bf16 v[80:83], v[20:23], a[192:195], v[80:83]
    ds_read_b64_tr_b16 v[18:19], v2 offset:16896
    v_mfma_f32_16x16x32_bf16 v[84:87], v[20:23], a[196:199], v[84:87]
    v_mfma_f32_16x16x32_bf16 v[88:91], v[20:23], a[200:203], v[88:91]
    v_mfma_f32_16x16x32_bf16 v[92:95], v[20:23], a[204:207], v[92:95]
    s_waitcnt lgkmcnt(6)
    ds_read_b64_tr_b16 v[20:21], v3 offset:16384
    v_mfma_f32_16x16x32_bf16 v[96:99], v[24:27], a[192:195], v[96:99]
    ds_read_b64_tr_b16 v[22:23], v3 offset:16896
    v_mfma_f32_16x16x32_bf16 v[100:103], v[24:27], a[196:199], v[100:103]
    v_mfma_f32_16x16x32_bf16 v[104:107], v[24:27], a[200:203], v[104:107]
    v_mfma_f32_16x16x32_bf16 v[108:111], v[24:27], a[204:207], v[108:111]
    ds_read_b64_tr_b16 v[24:25], v4 offset:16384
    v_mfma_f32_16x16x32_bf16 v[112:115], v[28:31], a[192:195], v[112:115]
    ds_read_b64_tr_b16 v[26:27], v4 offset:16896
    v_mfma_f32_16x16x32_bf16 v[116:119], v[28:31], a[196:199], v[116:119]
    v_mfma_f32_16x16x32_bf16 v[120:123], v[28:31], a[200:203], v[120:123]
    s_waitcnt vmcnt(23)
    v_mfma_f32_16x16x32_bf16 v[124:127], v[28:31], a[204:207], v[124:127]
    s_waitcnt lgkmcnt(6)
    ds_read_b64_tr_b16 v[28:29], v5 offset:16384
    v_mfma_f32_16x16x32_bf16 v[128:131], v[32:35], a[208:211], v[128:131]
    ds_read_b64_tr_b16 v[30:31], v5 offset:16896
    v_mfma_f32_16x16x32_bf16 v[132:135], v[32:35], a[212:215], v[132:135]
    v_mfma_f32_16x16x32_bf16 v[136:139], v[32:35], a[216:219], v[136:139]
    s_add_u32 m0, s66, 114688
    v_mfma_f32_16x16x32_bf16 v[140:143], v[32:35], a[220:223], v[140:143]
    ds_read_b64_tr_b16 v[32:33], v6 offset:20480
    v_mfma_f32_16x16x32_bf16 v[144:147], v[36:39], a[208:211], v[144:147]
    ds_read_b64_tr_b16 v[34:35], v6 offset:20992
    v_mfma_f32_16x16x32_bf16 v[148:151], v[36:39], a[212:215], v[148:151]
    global_load_lds_dwordx4 v[248:249], off
    v_mfma_f32_16x16x32_bf16 v[152:155], v[36:39], a[216:219], v[152:155]
    v_mfma_f32_16x16x32_bf16 v[156:159], v[36:39], a[220:223], v[156:159]
    ds_read_b64_tr_b16 v[36:37], v7 offset:20480
    ds_read_b64_tr_b16 v[38:39], v7 offset:20992
    s_cbranch_vccz KF_s13
    s_waitcnt lgkmcnt(8)
    v_mfma_f32_16x16x32_bf16 v[160:163], v[40:43], a[208:211], v[160:163]
    v_mfma_f32_16x16x32_bf16 v[164:167], v[40:43], a[212:215], v[164:167]
    v_mfma_f32_16x16x32_bf16 v[168:171], v[40:43], a[216:219], v[168:171]
    v_mfma_f32_16x16x32_bf16 v[172:175], v[40:43], a[220:223], v[172:175]
    ds_read_b64_tr_b16 v[40:41], v8 offset:20480
    v_mfma_f32_16x16x32_bf16 v[176:179], v[44:47], a[208:211], v[176:179]
    ds_read_b64_tr_b16 v[42:43], v8 offset:20992
    v_mfma_f32_16x16x32_bf16 v[180:183], v[44:47], a[212:215], v[180:183]
    v_mfma_f32_16x16x32_bf16 v[184:187], v[44:47], a[216:219], v[184:187]
    v_mfma_f32_16x16x32_bf16 v[188:191], v[44:47], a[220:223], v[188:191]
    ds_read_b64_tr_b16 v[44:45], v9 offset:20480
    ds_read_b64_tr_b16 v[46:47], v9 offset:20992
KF_s13:
    s_waitcnt lgkmcnt(8)
    v_mfma_f32_16x16x32_bf16 v[64:67], v[16:19], a[208:211], v[64:67]
    v_lshl_add_u64 v[248:249], v[248:249], 0, s[100:101]
    v_mfma_f32_16x16x32_bf16 v[68:71], v[16:19], a[212:215], v[68:71]
    v_mfma_f32_16x16x32_bf16 v[72:75], v[16:19], a[216:219], v[72:75]
    v_mfma_f32_16x16x32_bf16 v[76:79], v[16:19], a[220:223], v[76:79]
    ds_read_b64_tr_b16 v[16:17], v2 offset:20480
    v_mfma_f32_16x16x32_bf16 v[80:83], v[20:23], a[208:211], v[80:83]
    ds_read_b64_tr_b16 v[18:19], v2 offset:20992
    v_mfma_f32_16x16x32_bf16 v[84:87], v[20:23], a[212:215], v[84:87]
    v_mfma_f32_16x16x32_bf16 v[88:91], v[20:23], a[216:219], v[88:91]
    v_mfma_f32_16x16x32_bf16 v[92:95], v[20:23], a[220:223], v[92:95]
    s_waitcnt lgkmcnt(6)
    ds_read_b64_tr_b16 v[20:21], v3 offset:20480
    v_mfma_f32_16x16x32_bf16 v[96:99], v[24:27], a[208:211], v[96:99]
    ds_read_b64_tr_b16 v[22:23], v3 offset:20992
    v_mfma_f32_16x16x32_bf16 v[100:103], v[24:27], a[212:215], v[100:103]
    v_mfma_f32_16x16x32_bf16 v[104:107], v[24:27], a[216:219], v[104:107]
    v_mfma_f32_16x16x32_bf16 v[108:111], v[24:27], a[220:223], v[108:111]
    ds_read_b64_tr_b16 v[24:25], v4 offset:20480
    v_mfma_f32_16x16x32_bf16 v[112:115], v[28:31], a[208:211], v[112:115]
    ds_read_b64_tr_b16 v[26:27], v4 offset:20992
    v_mfma_f32_16x16x32_bf16 v[116:119], v[28:31], a[212:215], v[116:119]
    v_mfma_f32_16x16x32_bf16 v[120:123], v[28:31], a[216:219], v[120:123]
    s_waitcnt vmcnt(19)
    v_mfma_f32_16x16x32_bf16 v[124:127], v[28:31], a[220:223], v[124:127]
    s_waitcnt lgkmcnt(6)
    ds_read_b64_tr_b16 v[28:29], v5 offset:20480
    v_mfma_f32_16x16x32_bf16 v[128:131], v[32:35], a[224:227], v[128:131]
    ds_read_b64_tr_b16 v[30:31], v5 offset:20992
    v_mfma_f32_16x16x32_bf16 v[132:135], v[32:35], a[228:231], v[132:135]
    v_mfma_f32_16x16x32_bf16 v[136:139], v[32:35], a[232:235], v[136:139]
    s_add_u32 m0, s66, 118784
    v_mfma_f32_16x16x32_bf16 v[140:143], v[32:35], a[236:239], v[140:143]
    ds_read_b64_tr_b16 v[32:33], v6 offset:24576
    v_mfma_f32_16x16x32_bf16 v[144:147], v[36:39], a[224:227], v[144:147]
    ds_read_b64_tr_b16 v[34:35], v6 offset:25088
    v_mfma_f32_16x16x32_bf16 v[148:151], v[36:39], a[228:231], v[148:151]
    global_load_lds_dwordx4 v[248:249], off
    v_mfma_f32_16x16x32_bf16 v[152:155], v[36:39], a[232:235], v[152:155]
    v_mfma_f32_16x16x32_bf16 v[156:159], v[36:39], a[236:239], v[156:159]
    ds_read_b64_tr_b16 v[36:37], v7 offset:24576
    ds_read_b64_tr_b16 v[38:39], v7 offset:25088
    s_cbranch_vccz KF_s14
    s_waitcnt lgkmcnt(8)
    v_mfma_f32_16x16x32_bf16 v[160:163], v[40:43], a[224:227], v[160:163]
    v_mfma_f32_16x16x32_bf16 v[164:167], v[40:43], a[228:231], v[164:167]
    v_mfma_f32_16x16x32_bf16 v[168:171], v[40:43], a[232:235], v[168:171]
    v_mfma_f32_16x16x32_bf16 v[172:175], v[40:43], a[236:239], v[172:175]
    ds_read_b64_tr_b16 v[40:41], v8 offset:24576
    v_mfma_f32_16x16x32_bf16 v[176:179], v[44:47], a[224:227], v[176:179]
    ds_read_b64_tr_b16 v[42:43], v8 offset:25088
    v_mfma_f32_16x16x32_bf16 v[180:183], v[44:47], a[228:231], v[180:183]
    v_mfma_f32_16x16x32_bf16 v[184:187], v[44:47], a[232:235], v[184:187]
    v_mfma_f32_16x16x32_bf16 v[188:191], v[44:47], a[236:239], v[188:191]
    ds_read_b64_tr_b16 v[44:45], v9 offset:24576
    ds_read_b64_tr_b16 v[46:47], v9 offset:25088
KF_s14:
    s_waitcnt lgkmcnt(8)
    v_mfma_f32_16x16x32_bf16 v[64:67], v[16:19], a[224:227], v[64:67]
    v_lshl_add_u64 v[248:249], v[248:249], 0, s[100:101]
    v_mfma_f32_16x16x32_bf16 v[68:71], v[16:19], a[228:231], v[68:71]
    v_mfma_f32_16x16x32_bf16 v[72:75], v[16:19], a[232:235], v[72:75]
    v_mfma_f32_16x16x32_bf16 v[76:79], v[16:19], a[236:239], v[76:79]
    ds_read_b64_tr_b16 v[16:17], v2 offset:24576
    v_mfma_f32_16x16x32_bf16 v[80:83], v[20:23], a[224:227], v[80:83]
    ds_read_b64_tr_b16 v[18:19], v2 offset:25088
    v_mfma_f32_16x16x32_bf16 v[84:87], v[20:23], a[228:231], v[84:87]
    v_mfma_f32_16x16x32_bf16 v[88:91], v[20:23], a[232:235], v[88:91]
    v_mfma_f32_16x16x32_bf16 v[92:95], v[20:23], a[236:239], v[92:95]
    s_waitcnt lgkmcnt(6)
    ds_read_b64_tr_b16 v[20:21], v3 offset:24576
    v_mfma_f32_16x16x32_bf16 v[96:99], v[24:27], a[224:227], v[96:99]
    ds_read_b64_tr_b16 v[22:23], v3 offset:25088
    v_mfma_f32_16x16x32_bf16 v[100:103], v[24:27], a[228:231], v[100:103]
    v_mfma_f32_16x16x32_bf16 v[104:107], v[24:27], a[232:235], v[104:107]
    v_mfma_f32_16x16x32_bf16 v[108:111], v[24:27], a[236:239], v[108:111]
    ds_read_b64_tr_b16 v[24:25], v4 offset:24576
    v_mfma_f32_16x16x32_bf16 v[112:115], v[28:31], a[224:227], v[112:115]
    ds_read_b64_tr_b16 v[26:27], v4 offset:25088
    v_mfma_f32_16x16x32_bf16 v[116:119], v[28:31], a[228:231], v[116:119]
    v_mfma_f32_16x16x32_bf16 v[120:123], v[28:31], a[232:235], v[120:123]
    s_waitcnt vmcnt(15)
    v_mfma_f32_16x16x32_bf16 v[124:127], v[28:31], a[236:239], v[124:127]
    s_waitcnt lgkmcnt(6)
    ds_read_b64_tr_b16 v[28:29], v5 offset:24576
    v_mfma_f32_16x16x32_bf16 v[128:131], v[32:35], a[240:243], v[128:131]
    ds_read_b64_tr_b16 v[30:31], v5 offset:25088
    v_mfma_f32_16x16x32_bf16 v[132:135], v[32:35], a[244:247], v[132:135]
    s_barrier
    v_mfma_f32_16x16x32_bf16 v[136:139], v[32:35], a[248:251], v[136:139]
    s_add_u32 m0, s66, 122880
    v_mfma_f32_16x16x32_bf16 v[140:143], v[32:35], a[252:255], v[140:143]
    ds_read_b64_tr_b16 v[32:33], v6 offset:28672
    v_mfma_f32_16x16x32_bf16 v[144:147], v[36:39], a[240:243], v[144:147]
    ds_read_b64_tr_b16 v[34:35], v6 offset:29184
    v_mfma_f32_16x16x32_bf16 v[148:151], v[36:39], a[244:247], v[148:151]
    global_load_lds_dwordx4 v[248:249], off
    v_mfma_f32_16x16x32_bf16 v[152:155], v[36:39], a[248:251], v[152:155]
    v_mfma_f32_16x16x32_bf16 v[156:159], v[36:39], a[252:255], v[156:159]
    ds_read_b64_tr_b16 v[36:37], v7 offset:28672
    ds_read_b64_tr_b16 v[38:39], v7 offset:29184
    s_cbranch_vccz KF_s15
    s_waitcnt lgkmcnt(8)
    v_mfma_f32_16x16x32_bf16 v[160:163], v[40:43], a[240:243], v[160:163]
    v_mfma_f32_16x16x32_bf16 v[164:167], v[40:43], a[244:247], v[164:167]
    v_mfma_f32_16x16x32_bf16 v[168:171], v[40:43], a[248:251], v[168:171]
    v_mfma_f32_16x16x32_bf16 v[172:175], v[40:43], a[252:255], v[172:175]
    ds_read_b64_tr_b16 v[40:41], v8 offset:28672
    v_mfma_f32_16x16x32_bf16 v[176:179], v[44:47], a[240:243], v[176:179]
    ds_read_b64_tr_b16 v[42:43], v8 offset:29184
    v_mfma_f32_16x16x32_bf16 v[180:183], v[44:47], a[244:247], v[180:183]
    v_mfma_f32_16x16x32_bf16 v[184:187], v[44:47], a[248:251], v[184:187]
    v_mfma_f32_16x16x32_bf16 v[188:191], v[44:47], a[252:255], v[188:191]
    ds_read_b64_tr_b16 v[44:45], v9 offset:28672
    ds_read_b64_tr_b16 v[46:47], v9 offset:29184
KF_s15:
    s_waitcnt lgkmcnt(8)
    v_mfma_f32_16x16x32_bf16 v[64:67], v[16:19], a[240:243], v[64:67]
    v_lshl_add_u64 v[248:249], v[248:249], 0, s[100:101]
    v_mfma_f32_16x16x32_bf16 v[68:71], v[16:19], a[244:247], v[68:71]
    v_mfma_f32_16x16x32_bf16 v[72:75], v[16:19], a[248:251], v[72:75]
    v_mfma_f32_16x16x32_bf16 v[76:79], v[16:19], a[252:255], v[76:79]
    ds_read_b64_tr_b16 v[16:17], v2 offset:28672
    v_mfma_f32_16x16x32_bf16 v[80:83], v[20:23], a[240:243], v[80:83]
    ds_read_b64_tr_b16 v[18:19], v2 offset:29184
    v_mfma_f32_16x16x32_bf16 v[84:87], v[20:23], a[244:247], v[84:87]
    v_mfma_f32_16x16x32_bf16 v[88:91], v[20:23], a[248:251], v[88:91]
    v_mfma_f32_16x16x32_bf16 v[92:95], v[20:23], a[252:255], v[92:95]
    s_waitcnt lgkmcnt(6)
    ds_read_b64_tr_b16 v[20:21], v3 offset:28672
    v_mfma_f32_16x16x32_bf16 v[96:99], v[24:27], a[240:243], v[96:99]
    ds_read_b64_tr_b16 v[22:23], v3 offset:29184
    v_mfma_f32_16x16x32_bf16 v[100:103], v[24:27], a[244:247], v[100:103]
    v_mfma_f32_16x16x32_bf16 v[104:107], v[24:27], a[248:251], v[104:107]
    v_mfma_f32_16x16x32_bf16 v[108:111], v[24:27], a[252:255], v[108:111]
    ds_read_b64_tr_b16 v[24:25], v4 offset:28672
    v_mfma_f32_16x16x32_bf16 v[112:115], v[28:31], a[240:243], v[112:115]
    ds_read_b64_tr_b16 v[26:27], v4 offset:29184
    v_mfma_f32_16x16x32_bf16 v[116:119], v[28:31], a[244:247], v[116:119]
    v_mfma_f32_16x16x32_bf16 v[120:123], v[28:31], a[248:251], v[120:123]
    s_waitcnt vmcnt(11)
    v_mfma_f32_16x16x32_bf16 v[124:127], v[28:31], a[252:255], v[124:127]
    s_waitcnt lgkmcnt(6)
    ds_read_b64_tr_b16 v[28:29], v5 offset:28672
    v_mfma_f32_16x16x32_bf16 v[128:131], v[32:35], v[192:195], v[128:131]
    ds_read_b64_tr_b16 v[30:31], v5 offset:29184
    v_mfma_f32_16x16x32_bf16 v[132:135], v[32:35], v[196:199], v[132:135]
    v_mfma_f32_16x16x32_bf16 v[136:139], v[32:35], v[200:203], v[136:139]
    s_add_u32 m0, s66, 126976
    v_mfma_f32_16x16x32_bf16 v[140:143], v[32:35], v[204:207], v[140:143]
    ds_read_b64_tr_b16 v[32:33], v6 offset:32768
    v_mfma_f32_16x16x32_bf16 v[144:147], v[36:39], v[192:195], v[144:147]
    ds_read_b64_tr_b16 v[34:35], v6 offset:33280
    v_mfma_f32_16x16x32_bf16 v[148:151], v[36:39], v[196:199], v[148:151]
    global_load_lds_dwordx4 v[248:249], off
    v_mfma_f32_16x16x32_bf16 v[152:155], v[36:39], v[200:203], v[152:155]
    v_mfma_f32_16x16x32_bf16 v[156:159], v[36:39], v[204:207], v[156:159]
    ds_read_b64_tr_b16 v[36:37], v7 offset:32768
    ds_read_b64_tr_b16 v[38:39], v7 offset:33280
    s_cbranch_vccz KF_s16
    s_waitcnt lgkmcnt(8)
    v_mfma_f32_16x16x32_bf16 v[160:163], v[40:43], v[192:195], v[160:163]
    v_mfma_f32_16x16x32_bf16 v[164:167], v[40:43], v[196:199], v[164:167]
    v_mfma_f32_16x16x32_bf16 v[168:171], v[40:43], v[200:203], v[168:171]
    v_mfma_f32_16x16x32_bf16 v[172:175], v[40:43], v[204:207], v[172:175]
    ds_read_b64_tr_b16 v[40:41], v8 offset:32768
    v_mfma_f32_16x16x32_bf16 v[176:179], v[44:47], v[192:195], v[176:179]
    ds_read_b64_tr_b16 v[42:43], v8 offset:33280
    v_mfma_f32_16x16x32_bf16 v[180:183], v[44:47], v[196:199], v[180:183]
    v_mfma_f32_16x16x32_bf16 v[184:187], v[44:47], v[200:203], v[184:187]
    v_mfma_f32_16x16x32_bf16 v[188:191], v[44:47], v[204:207], v[188:191]
    ds_read_b64_tr_b16 v[44:45], v9 offset:32768
    ds_read_b64_tr_b16 v[46:47], v9 offset:33280
KF_s16:
    s_waitcnt lgkmcnt(8)
    v_mfma_f32_16x16x32_bf16 v[64:67], v[16:19], v[192:195], v[64:67]
    v_lshl_add_u64 v[248:249], v[248:249], 0, s[100:101]
    v_mfma_f32_16x16x32_bf16 v[68:71], v[16:19], v[196:199], v[68:71]
    v_mfma_f32_16x16x32_bf16 v[72:75], v[16:19], v[200:203], v[72:75]
    v_mfma_f32_16x16x32_bf16 v[76:79], v[16:19], v[204:207], v[76:79]
    ds_read_b64_tr_b16 v[16:17], v2 offset:32768
    v_mfma_f32_16x16x32_bf16 v[80:83], v[20:23], v[192:195], v[80:83]
    ds_read_b64_tr_b16 v[18:19], v2 offset:33280
    v_mfma_f32_16x16x32_bf16 v[84:87], v[20:23], v[196:199], v[84:87]
    v_mfma_f32_16x16x32_bf16 v[88:91], v[20:23], v[200:203], v[88:91]
    v_mfma_f32_16x16x32_bf16 v[92:95], v[20:23], v[204:207], v[92:95]
    s_waitcnt lgkmcnt(6)
    ds_read_b64_tr_b16 v[20:21], v3 offset:32768
    v_mfma_f32_16x16x32_bf16 v[96:99], v[24:27], v[192:195], v[96:99]
    ds_read_b64_tr_b16 v[22:23], v3 offset:33280
    v_mfma_f32_16x16x32_bf16 v[100:103], v[24:27], v[196:199], v[100:103]
    v_mfma_f32_16x16x32_bf16 v[104:107], v[24:27], v[200:203], v[104:107]
    v_mfma_f32_16x16x32_bf16 v[108:111], v[24:27], v[204:207], v[108:111]
    ds_read_b64_tr_b16 v[24:25], v4 offset:32768
    v_mfma_f32_16x16x32_bf16 v[112:115], v[28:31], v[192:195], v[112:115]
    ds_read_b64_tr_b16 v[26:27], v4 offset:33280
    v_mfma_f32_16x16x32_bf16 v[116:119], v[28:31], v[196:199], v[116:119]
    v_mfma_f32_16x16x32_bf16 v[120:123], v[28:31], v[200:203], v[120:123]
    s_waitcnt vmcnt(7)
    v_mfma_f32_16x16x32_bf16 v[124:127], v[28:31], v[204:207], v[124:127]
    s_waitcnt lgkmcnt(6)
    ds_read_b64_tr_b16 v[28:29], v5 offset:32768
    v_mfma_f32_16x16x32_bf16 v[128:131], v[32:35], v[208:211], v[128:131]
    ds_read_b64_tr_b16 v[30:31], v5 offset:33280
    v_mfma_f32_16x16x32_bf16 v[132:135], v[32:35], v[212:215], v[132:135]
    v_mfma_f32_16x16x32_bf16 v[136:139], v[32:35], v[216:219], v[136:139]
    s_add_u32 m0, s66, 131072
    v_mfma_f32_16x16x32_bf16 v[140:143], v[32:35], v[220:223], v[140:143]
    global_load_lds_dwordx4 v[248:249], off
    v_mfma_f32_16x16x32_bf16 v[144:147], v[36:39], v[208:211], v[144:147]
    v_lshl_add_u64 v[248:249], v[248:249], 0, s[100:101]
    v_mfma_f32_16x16x32_bf16 v[148:151], v[36:39], v[212:215], v[148:151]
    v_mfma_f32_16x16x32_bf16 v[152:155], v[36:39], v[216:219], v[152:155]
    v_mfma_f32_16x16x32_bf16 v[156:159], v[36:39], v[220:223], v[156:159]
    s_cbranch_vccz KF_s17
    s_waitcnt lgkmcnt(4)
    v_mfma_f32_16x16x32_bf16 v[160:163], v[40:43], v[208:211], v[160:163]
    v_mfma_f32_16x16x32_bf16 v[164:167], v[40:43], v[212:215], v[164:167]
    v_mfma_f32_16x16x32_bf16 v[168:171], v[40:43], v[216:219], v[168:171]
    v_mfma_f32_16x16x32_bf16 v[172:175], v[40:43], v[220:223], v[172:175]
    v_mfma_f32_16x16x32_bf16 v[176:179], v[44:47], v[208:211], v[176:179]
    v_mfma_f32_16x16x32_bf16 v[180:183], v[44:47], v[212:215], v[180:183]
    v_mfma_f32_16x16x32_bf16 v[184:187], v[44:47], v[216:219], v[184:187]
    v_mfma_f32_16x16x32_bf16 v[188:191], v[44:47], v[220:223], v[188:191]
KF_s17:
    s_waitcnt lgkmcnt(0)
    v_mfma_f32_16x16x32_bf16 v[64:67], v[16:19], v[208:211], v[64:67]
    v_mfma_f32_16x16x32_bf16 v[68:71], v[16:19], v[212:215], v[68:71]
    v_add_u32 v2, 73728, v240
    v_mfma_f32_16x16x32_bf16 v[72:75], v[16:19], v[216:219], v[72:75]
    s_waitcnt vmcnt(3)
    s_barrier
    v_cvt_pk_bf16_f32 v224, v128, v129
    v_mfma_f32_16x16x32_bf16 v[76:79], v[16:19], v[220:223], v[76:79]
    ds_read_b64_tr_b16 v[16:17], v2 offset:0
    v_cvt_pk_bf16_f32 v225, v130, v131
    v_cvt_pk_bf16_f32 v226, v144, v145
    v_mfma_f32_16x16x32_bf16 v[80:83], v[20:23], v[208:211], v[80:83]
    s_add_u32 m0, s66, 135168
    ds_read_b64_tr_b16 v[18:19], v2 offset:512
    v_cvt_pk_bf16_f32 v227, v146, v147
    v_mfma_f32_16x16x32_bf16 v[84:87], v[20:23], v[212:215], v[84:87]
    global_load_lds_dwordx4 v[248:249], off
    v_cvt_pk_bf16_f32 v228, v132, v133
    v_add_u32 v3, 73728, v241
    v_mfma_f32_16x16x32_bf16 v[88:91], v[20:23], v[216:219], v[88:91]
    buffer_store_dwordx4 v[224:227], v15, s[20:23], s48 offen offset:0 sc1
    v_lshl_add_u64 v[248:249], v[248:249], 0, s[100:101]
    v_mfma_f32_16x16x32_bf16 v[92:95], v[20:23], v[220:223], v[92:95]
    s_waitcnt lgkmcnt(0)
    s_add_u32 m0, s66, 139264
    ds_read_b64_tr_b16 v[20:21], v3 offset:0
    v_mfma_f32_16x16x32_bf16 v[96:99], v[24:27], v[208:211], v[96:99]
    global_load_lds_dwordx4 v[248:249], off
    ds_read_b64_tr_b16 v[22:23], v3 offset:512
    v_cvt_pk_bf16_f32 v229, v134, v135
    v_mfma_f32_16x16x32_bf16 v[100:103], v[24:27], v[212:215], v[100:103]
    v_lshl_add_u64 v[248:249], v[248:249], 0, s[100:101]
    v_cvt_pk_bf16_f32 v230, v148, v149
    v_add_u32 v4, 73728, v242
    v_mfma_f32_16x16x32_bf16 v[104:107], v[24:27], v[216:219], v[104:107]
    s_add_u32 m0, s66, 143360
    v_cvt_pk_bf16_f32 v231, v150, v151
    v_cvt_pk_bf16_f32 v232, v136, v137
    v_mfma_f32_16x16x32_bf16 v[108:111], v[24:27], v[220:223], v[108:111]
    global_load_lds_dwordx4 v[248:249], off
    ds_read_b64_tr_b16 v[24:25], v4 offset:0
    v_cvt_pk_bf16_f32 v233, v138, v139
    v_mfma_f32_16x16x32_bf16 v[112:115], v[28:31], v[208:211], v[112:115]
    ds_read_b64_tr_b16 v[26:27], v4 offset:512
    v_lshl_add_u64 v[248:249], v[248:249], 0, s[100:101]
    v_cvt_pk_bf16_f32 v234, v152, v153
    v_mfma_f32_16x16x32_bf16 v[116:119], v[28:31], v[212:215], v[116:119]
    buffer_store_dwordx4 v[228:231], v15, s[20:23], s49 offen offset:0 sc1
    v_add_u32 v5, 73728, v243
    v_mfma_f32_16x16x32_bf16 v[120:123], v[28:31], v[216:219], v[120:123]
    v_cvt_pk_bf16_f32 v235, v154, v155
    v_cvt_pk_bf16_f32 v236, v140, v141
    v_cvt_pk_bf16_f32 v237, v142, v143
    v_mfma_f32_16x16x32_bf16 v[124:127], v[28:31], v[220:223], v[124:127]
    ds_read_b64_tr_b16 v[28:29], v5 offset:0
    ds_read_b64_tr_b16 v[30:31], v5 offset:512
    v_cvt_pk_bf16_f32 v238, v156, v157
    buffer_store_dwordx4 v[232:235], v15, s[20:23], s50 offen offset:0 sc1
    v_cvt_pk_bf16_f32 v239, v158, v159
    buffer_store_dwordx4 v[236:239], v15, s[20:23], s51 offen offset:0 sc1
    s_cbranch_vccz KF_noq2
    s_nop 1
    v_cvt_pk_bf16_f32 v224, v160, v161
    v_cvt_pk_bf16_f32 v225, v162, v163
    v_cvt_pk_bf16_f32 v226, v176, v177
    v_cvt_pk_bf16_f32 v227, v178, v179
    v_cvt_pk_bf16_f32 v228, v164, v165
    v_cvt_pk_bf16_f32 v229, v166, v167
    v_cvt_pk_bf16_f32 v230, v180, v181
    v_cvt_pk_bf16_f32 v231, v182, v183
    v_cvt_pk_bf16_f32 v232, v168, v169
    v_cvt_pk_bf16_f32 v233, v170, v171
    v_cvt_pk_bf16_f32 v234, v184, v185
    v_cvt_pk_bf16_f32 v235, v186, v187
    v_cvt_pk_bf16_f32 v236, v172, v173
    v_cvt_pk_bf16_f32 v237, v174, v175
    v_cvt_pk_bf16_f32 v238, v188, v189
    v_cvt_pk_bf16_f32 v239, v190, v191
    buffer_store_dwordx4 v[224:227], v15, s[20:23], s48 offen offset:64 sc1
    buffer_store_dwordx4 v[228:231], v15, s[20:23], s49 offen offset:64 sc1
    buffer_store_dwordx4 v[232:235], v15, s[20:23], s50 offen offset:64 sc1
    buffer_store_dwordx4 v[236:239], v15, s[20:23], s51 offen offset:64 sc1
KF_noq2:
    s_mov_b32 s43, 0
    v_mov_b32 v254, s39
    v_min_u32 v15, 35, v0
    v_lshlrev_b32 v15, 7, v15
    v_mov_b32 v6, v240
    v_mov_b32 v7, v241
    v_mov_b32 v8, v242
    v_mov_b32 v9, v243
    s_cmp_eq_u32 s68, 0
    s_cbranch_scc1 KF_loop
    s_mov_b32 s43, 1
    v_mov_b32 v10, v244
    v_mov_b32 v11, v245
    v_mov_b32 v6, v240
    v_mov_b32 v7, v241
    v_add_u32 v8, 4096, v240
    v_add_u32 v9, 4096, v241
KF_loop:
    s_sub_u32 m0, s66, 4096
    s_waitcnt lgkmcnt(4)
    v_mfma_f32_16x16x32_bf16 v[128:131], v[16:19], a[0:3], 0
    v_mfma_f32_16x16x32_bf16 v[132:135], v[16:19], a[4:7], 0
    s_add_u32 m0, m0, 4096
    v_mul_f32 v224, s40, v64
    v_mfma_f32_16x16x32_bf16 v[136:139], v[16:19], a[8:11], 0
    global_load_lds_dwordx4 v[10:11], off
    v_lshl_add_u64 v[10:11], v[10:11], 0, s[100:101]
    v_mul_f32 v225, s40, v65
    v_mfma_f32_16x16x32_bf16 v[140:143], v[16:19], a[12:15], 0
    ds_read_b64_tr_b16 v[16:17], v2 offset:4096
    v_mul_f32 v226, s40, v66
    v_mfma_f32_16x16x32_bf16 v[144:147], v[20:23], a[0:3], 0
    ds_read_b64_tr_b16 v[18:19], v2 offset:4608
    v_mul_f32 v227, s40, v67
    v_mul_f32 v228, s40, v68
    v_mfma_f32_16x16x32_bf16 v[148:151], v[20:23], a[4:7], 0
    v_exp_f32 v224, v224
    v_mfma_f32_16x16x32_bf16 v[152:155], v[20:23], a[8:11], 0
    s_add_u32 m0, m0, 4096
    v_exp_f32 v225, v225
    v_mfma_f32_16x16x32_bf16 v[156:159], v[20:23], a[12:15], 0
    s_waitcnt lgkmcnt(2)
    global_load_lds_dwordx4 v[10:11], off
    ds_read_b64_tr_b16 v[20:21], v3 offset:4096
    v_lshl_add_u64 v[10:11], v[10:11], 0, s[100:101]
    v_mfma_f32_16x16x32_bf16 v[160:163], v[24:27], a[0:3], 0
    ds_read_b64_tr_b16 v[22:23], v3 offset:4608
    v_exp_f32 v226, v226
    v_mfma_f32_16x16x32_bf16 v[164:167], v[24:27], a[4:7], 0
    v_exp_f32 v227, v227
    v_mfma_f32_16x16x32_bf16 v[168:171], v[24:27], a[8:11], 0
    v_add_f32 v224, 1.0, v224
    v_add_f32 v225, 1.0, v225
    v_add_f32 v226, 1.0, v226
    v_mfma_f32_16x16x32_bf16 v[172:175], v[24:27], a[12:15], 0
    s_add_u32 m0, m0, 4096
    ds_read_b64_tr_b16 v[24:25], v4 offset:4096
    v_mfma_f32_16x16x32_bf16 v[176:179], v[28:31], a[0:3], 0
    global_load_lds_dwordx4 v[10:11], off
    ds_read_b64_tr_b16 v[26:27], v4 offset:4608
    v_lshl_add_u64 v[10:11], v[10:11], 0, s[100:101]
    v_mfma_f32_16x16x32_bf16 v[180:183], v[28:31], a[4:7], 0
    v_add_f32 v227, 1.0, v227
    v_mul_f32 v229, s40, v69
    v_mfma_f32_16x16x32_bf16 v[184:187], v[28:31], a[8:11], 0
    v_rcp_f32 v224, v224
    v_mul_f32 v230, s40, v70
    v_mfma_f32_16x16x32_bf16 v[188:191], v[28:31], a[12:15], 0
    s_waitcnt lgkmcnt(2)
    ds_read_b64_tr_b16 v[28:29], v5 offset:4096
    v_mul_f32 v231, s40, v71
    v_mfma_f32_16x16x32_bf16 v[128:131], v[16:19], a[16:19], v[128:131]
    ds_read_b64_tr_b16 v[30:31], v5 offset:4608
    v_mul_f32 v232, s40, v72
    v_mfma_f32_16x16x32_bf16 v[132:135], v[16:19], a[20:23], v[132:135]
    s_add_u32 m0, m0, 4096
    v_rcp_f32 v225, v225
    v_mfma_f32_16x16x32_bf16 v[136:139], v[16:19], a[24:27], v[136:139]
    global_load_lds_dwordx4 v[10:11], off
    v_lshl_add_u64 v[10:11], v[10:11], 0, s[100:101]
    v_mfma_f32_16x16x32_bf16 v[140:143], v[16:19], a[28:31], v[140:143]
    ds_read_b64_tr_b16 v[16:17], v2 offset:8192
    v_rcp_f32 v226, v226
    v_mfma_f32_16x16x32_bf16 v[144:147], v[20:23], a[16:19], v[144:147]
    ds_read_b64_tr_b16 v[18:19], v2 offset:8704
    v_mul_f32 v233, s40, v73
    v_mfma_f32_16x16x32_bf16 v[148:151], v[20:23], a[20:23], v[148:151]
    v_rcp_f32 v227, v227
    v_mul_f32 v234, s40, v74
    v_mfma_f32_16x16x32_bf16 v[152:155], v[20:23], a[24:27], v[152:155]
    s_add_u32 m0, m0, 4096
    v_mul_f32 v224, v224, v64
    v_mfma_f32_16x16x32_bf16 v[156:159], v[20:23], a[28:31], v[156:159]
    s_waitcnt lgkmcnt(2)
    global_load_lds_dwordx4 v[10:11], off
    ds_read_b64_tr_b16 v[20:21], v3 offset:8192
    v_lshl_add_u64 v[10:11], v[10:11], 0, s[100:101]
    v_mfma_f32_16x16x32_bf16 v[160:163], v[24:27], a[16:19], v[160:163]
    ds_read_b64_tr_b16 v[22:23], v3 offset:8704
    v_mul_f32 v225, v225, v65
    v_mfma_f32_16x16x32_bf16 v[164:167], v[24:27], a[20:23], v[164:167]
    v_exp_f32 v228, v228
    v_mul_f32 v226, v226, v66
    v_mfma_f32_16x16x32_bf16 v[168:171], v[24:27], a[24:27], v[168:171]
    v_exp_f32 v229, v229
    v_mfma_f32_16x16x32_bf16 v[172:175], v[24:27], a[28:31], v[172:175]
    s_add_u32 m0, m0, 4096
    ds_read_b64_tr_b16 v[24:25], v4 offset:8192
    v_mul_f32 v227, v227, v67
    v_mfma_f32_16x16x32_bf16 v[176:179], v[28:31], a[16:19], v[176:179]
    global_load_lds_dwordx4 v[10:11], off
    ds_read_b64_tr_b16 v[26:27], v4 offset:8704
    v_lshl_add_u64 v[10:11], v[10:11], 0, s[100:101]
    v_mfma_f32_16x16x32_bf16 v[180:183], v[28:31], a[20:23], v[180:183]
    v_exp_f32 v230, v230
    v_mfma_f32_16x16x32_bf16 v[184:187], v[28:31], a[24:27], v[184:187]
    v_exp_f32 v231, v231
    v_cvt_pk_bf16_f32 v32, v224, v225
    v_mfma_f32_16x16x32_bf16 v[188:191], v[28:31], a[28:31], v[188:191]
    s_waitcnt lgkmcnt(2)
    ds_read_b64_tr_b16 v[28:29], v5 offset:8192
    v_mfma_f32_16x16x32_bf16 v[128:131], v[16:19], a[32:35], v[128:131]
    ds_read_b64_tr_b16 v[30:31], v5 offset:8704
    v_cvt_pk_bf16_f32 v33, v226, v227
    v_add_f32 v228, 1.0, v228
    v_mfma_f32_16x16x32_bf16 v[132:135], v[16:19], a[36:39], v[132:135]
    s_add_u32 m0, m0, 4096
    v_add_f32 v229, 1.0, v229
    v_mfma_f32_16x16x32_bf16 v[136:139], v[16:19], a[40:43], v[136:139]
    global_load_lds_dwordx4 v[10:11], off
    v_lshl_add_u64 v[10:11], v[10:11], 0, s[100:101]
    v_add_f32 v230, 1.0, v230
    v_mfma_f32_16x16x32_bf16 v[140:143], v[16:19], a[44:47], v[140:143]
    ds_read_b64_tr_b16 v[16:17], v2 offset:12288
    v_add_f32 v231, 1.0, v231
    v_mfma_f32_16x16x32_bf16 v[144:147], v[20:23], a[32:35], v[144:147]
    ds_read_b64_tr_b16 v[18:19], v2 offset:12800
    v_rcp_f32 v228, v228
    v_mfma_f32_16x16x32_bf16 v[148:151], v[20:23], a[36:39], v[148:151]
    v_rcp_f32 v229, v229
    v_mfma_f32_16x16x32_bf16 v[152:155], v[20:23], a[40:43], v[152:155]
    s_add_u32 m0, m0, 4096
    v_rcp_f32 v230, v230
    v_mfma_f32_16x16x32_bf16 v[156:159], v[20:23], a[44:47], v[156:159]
    s_waitcnt lgkmcnt(2)
    global_load_lds_dwordx4 v[10:11], off
    ds_read_b64_tr_b16 v[20:21], v3 offset:12288
    v_lshl_add_u64 v[10:11], v[10:11], 0, s[100:101]
    v_mfma_f32_16x16x32_bf16 v[160:163], v[24:27], a[32:35], v[160:163]
    ds_read_b64_tr_b16 v[22:23], v3 offset:12800
    v_rcp_f32 v231, v231
    v_mfma_f32_16x16x32_bf16 v[164:167], v[24:27], a[36:39], v[164:167]
    v_mul_f32 v228, v228, v68
    v_mul_f32 v229, v229, v69
    v_mul_f32 v230, v230, v70
    v_mfma_f32_16x16x32_bf16 v[168:171], v[24:27], a[40:43], v[168:171]
    v_mul_f32 v231, v231, v71
    v_mul_f32 v235, s40, v75
    v_mfma_f32_16x16x32_bf16 v[172:175], v[24:27], a[44:47], v[172:175]
    s_add_u32 m0, m0, 4096
    ds_read_b64_tr_b16 v[24:25], v4 offset:12288
    v_cvt_pk_bf16_f32 v34, v228, v229
    v_mfma_f32_16x16x32_bf16 v[176:179], v[28:31], a[32:35], v[176:179]
    global_load_lds_dwordx4 v[10:11], off
    ds_read_b64_tr_b16 v[26:27], v4 offset:12800
    v_lshl_add_u64 v[10:11], v[10:11], 0, s[100:101]
    v_mfma_f32_16x16x32_bf16 v[180:183], v[28:31], a[36:39], v[180:183]
    v_exp_f32 v232, v232
    v_cvt_pk_bf16_f32 v35, v230, v231
    v_mfma_f32_16x16x32_bf16 v[184:187], v[28:31], a[40:43], v[184:187]
    v_exp_f32 v233, v233
    v_mfma_f32_16x16x32_bf16 v[188:191], v[28:31], a[44:47], v[188:191]
    s_waitcnt lgkmcnt(2)
    ds_read_b64_tr_b16 v[28:29], v5 offset:12288
    v_mul_f32 v236, s40, v76
    v_mfma_f32_16x16x32_bf16 v[128:131], v[16:19], a[48:51], v[128:131]
    ds_read_b64_tr_b16 v[30:31], v5 offset:12800
    v_mul_f32 v237, s40, v77
    v_mfma_f32_16x16x32_bf16 v[132:135], v[16:19], a[52:55], v[132:135]
    s_add_u32 m0, m0, 4096
    v_exp_f32 v234, v234
    v_mfma_f32_16x16x32_bf16 v[136:139], v[16:19], a[56:59], v[136:139]
    global_load_lds_dwordx4 v[10:11], off
    v_lshl_add_u64 v[10:11], v[10:11], 0, s[100:101]
    v_mfma_f32_16x16x32_bf16 v[140:143], v[16:19], a[60:63], v[140:143]
    ds_read_b64_tr_b16 v[16:17], v2 offset:16384
    v_exp_f32 v235, v235
    v_mfma_f32_16x16x32_bf16 v[144:147], v[20:23], a[48:51], v[144:147]
    ds_read_b64_tr_b16 v[18:19], v2 offset:16896
    v_add_f32 v232, 1.0, v232
    v_mfma_f32_16x16x32_bf16 v[148:151], v[20:23], a[52:55], v[148:151]
    v_add_f32 v233, 1.0, v233
    v_add_f32 v234, 1.0, v234
    v_add_f32 v235, 1.0, v235
    v_mfma_f32_16x16x32_bf16 v[152:155], v[20:23], a[56:59], v[152:155]
    s_add_u32 m0, m0, 4096
    v_rcp_f32 v232, v232
    v_mfma_f32_16x16x32_bf16 v[156:159], v[20:23], a[60:63], v[156:159]
    s_waitcnt lgkmcnt(2)
    global_load_lds_dwordx4 v[10:11], off
    ds_read_b64_tr_b16 v[20:21], v3 offset:16384
    v_lshl_add_u64 v[10:11], v[10:11], 0, s[100:101]
    v_mfma_f32_16x16x32_bf16 v[160:163], v[24:27], a[48:51], v[160:163]
    ds_read_b64_tr_b16 v[22:23], v3 offset:16896
    v_rcp_f32 v233, v233
    v_mfma_f32_16x16x32_bf16 v[164:167], v[24:27], a[52:55], v[164:167]
    v_rcp_f32 v234, v234
    v_mfma_f32_16x16x32_bf16 v[168:171], v[24:27], a[56:59], v[168:171]
    v_rcp_f32 v235, v235
    v_mul_f32 v238, s40, v78
    v_mfma_f32_16x16x32_bf16 v[172:175], v[24:27], a[60:63], v[172:175]
    s_add_u32 m0, m0, 4096
    ds_read_b64_tr_b16 v[24:25], v4 offset:16384
    v_mfma_f32_16x16x32_bf16 v[176:179], v[28:31], a[48:51], v[176:179]
    global_load_lds_dwordx4 v[10:11], off
    ds_read_b64_tr_b16 v[26:27], v4 offset:16896
    v_lshl_add_u64 v[10:11], v[10:11], 0, s[100:101]
    v_mfma_f32_16x16x32_bf16 v[180:183], v[28:31], a[52:55], v[180:183]
    v_mul_f32 v232, v232, v72
    v_mul_f32 v233, v233, v73
    v_mfma_f32_16x16x32_bf16 v[184:187], v[28:31], a[56:59], v[184:187]
    v_mul_f32 v234, v234, v74
    v_mul_f32 v235, v235, v75
    v_mul_f32 v239, s40, v79
    v_mfma_f32_16x16x32_bf16 v[188:191], v[28:31], a[60:63], v[188:191]
    s_waitcnt lgkmcnt(2)
    ds_read_b64_tr_b16 v[28:29], v5 offset:16384
    v_mfma_f32_16x16x32_bf16 v[128:131], v[16:19], a[64:67], v[128:131]
    ds_read_b64_tr_b16 v[30:31], v5 offset:16896
    v_exp_f32 v236, v236
    v_mfma_f32_16x16x32_bf16 v[132:135], v[16:19], a[68:71], v[132:135]
    s_add_u32 m0, m0, 4096
    v_cvt_pk_bf16_f32 v36, v232, v233
    v_mfma_f32_16x16x32_bf16 v[136:139], v[16:19], a[72:75], v[136:139]
    global_load_lds_dwordx4 v[10:11], off
    v_lshl_add_u64 v[10:11], v[10:11], 0, s[100:101]
    v_cvt_pk_bf16_f32 v37, v234, v235
    v_mfma_f32_16x16x32_bf16 v[140:143], v[16:19], a[76:79], v[140:143]
    ds_read_b64_tr_b16 v[16:17], v2 offset:20480
    v_exp_f32 v237, v237
    v_mfma_f32_16x16x32_bf16 v[144:147], v[20:23], a[64:67], v[144:147]
    ds_read_b64_tr_b16 v[18:19], v2 offset:20992
    v_mul_f32 v224, s40, v80
    v_mfma_f32_16x16x32_bf16 v[148:151], v[20:23], a[68:71], v[148:151]
    v_exp_f32 v238, v238
    v_mul_f32 v225, s40, v81
    v_mfma_f32_16x16x32_bf16 v[152:155], v[20:23], a[72:75], v[152:155]
    s_add_u32 m0, m0, 4096
    v_mul_f32 v226, s40, v82
    v_mfma_f32_16x16x32_bf16 v[156:159], v[20:23], a[76:79], v[156:159]
    s_waitcnt lgkmcnt(2)
    global_load_lds_dwordx4 v[10:11], off
    ds_read_b64_tr_b16 v[20:21], v3 offset:20480
    v_lshl_add_u64 v[10:11], v[10:11], 0, s[100:101]
    v_mfma_f32_16x16x32_bf16 v[160:163], v[24:27], a[64:67], v[160:163]
    ds_read_b64_tr_b16 v[22:23], v3 offset:20992
    v_mul_f32 v227, s40, v83
    v_mfma_f32_16x16x32_bf16 v[164:167], v[24:27], a[68:71], v[164:167]
    v_exp_f32 v239, v239
    v_mul_f32 v228, s40, v84
    v_mfma_f32_16x16x32_bf16 v[168:171], v[24:27], a[72:75], v[168:171]
    v_exp_f32 v224, v224
    v_mfma_f32_16x16x32_bf16 v[172:175], v[24:27], a[76:79], v[172:175]
    s_add_u32 m0, m0, 4096
    ds_read_b64_tr_b16 v[24:25], v4 offset:20480
    v_add_f32 v236, 1.0, v236
    v_mfma_f32_16x16x32_bf16 v[176:179], v[28:31], a[64:67], v[176:179]
    global_load_lds_dwordx4 v[10:11], off
    ds_read_b64_tr_b16 v[26:27], v4 offset:20992
    v_lshl_add_u64 v[10:11], v[10:11], 0, s[100:101]
    v_mfma_f32_16x16x32_bf16 v[180:183], v[28:31], a[68:71], v[180:183]
    v_exp_f32 v225, v225
    v_add_f32 v237, 1.0, v237
    v_mfma_f32_16x16x32_bf16 v[184:187], v[28:31], a[72:75], v[184:187]
    v_exp_f32 v226, v226
    v_mfma_f32_16x16x32_bf16 v[188:191], v[28:31], a[76:79], v[188:191]
    s_waitcnt lgkmcnt(2)
    ds_read_b64_tr_b16 v[28:29], v5 offset:20480
    v_add_f32 v238, 1.0, v238
    v_mfma_f32_16x16x32_bf16 v[128:131], v[16:19], a[80:83], v[128:131]
    ds_read_b64_tr_b16 v[30:31], v5 offset:20992
    v_add_f32 v239, 1.0, v239
    v_mfma_f32_16x16x32_bf16 v[132:135], v[16:19], a[84:87], v[132:135]
    s_add_u32 m0, m0, 4096
    v_rcp_f32 v236, v236
    v_mfma_f32_16x16x32_bf16 v[136:139], v[16:19], a[88:91], v[136:139]
    global_load_lds_dwordx4 v[10:11], off
    v_lshl_add_u64 v[10:11], v[10:11], 0, s[100:101]
    v_mul_f32 v229, s40, v85
    v_mfma_f32_16x16x32_bf16 v[140:143], v[16:19], a[92:95], v[140:143]
    ds_read_b64_tr_b16 v[16:17], v2 offset:24576
    v_mul_f32 v230, s40, v86
    v_mfma_f32_16x16x32_bf16 v[144:147], v[20:23], a[80:83], v[144:147]
    ds_read_b64_tr_b16 v[18:19], v2 offset:25088
    v_rcp_f32 v237, v237
    v_mfma_f32_16x16x32_bf16 v[148:151], v[20:23], a[84:87], v[148:151]
    v_rcp_f32 v238, v238
    v_mfma_f32_16x16x32_bf16 v[152:155], v[20:23], a[88:91], v[152:155]
    s_add_u32 m0, m0, 4096
    v_rcp_f32 v239, v239
    v_mfma_f32_16x16x32_bf16 v[156:159], v[20:23], a[92:95], v[156:159]
    s_waitcnt lgkmcnt(2)
    global_load_lds_dwordx4 v[10:11], off
    ds_read_b64_tr_b16 v[20:21], v3 offset:24576
    v_lshl_add_u64 v[10:11], v[10:11], 0, s[100:101]
    v_mfma_f32_16x16x32_bf16 v[160:163], v[24:27], a[80:83], v[160:163]
    ds_read_b64_tr_b16 v[22:23], v3 offset:25088
    v_exp_f32 v227, v227
    v_mfma_f32_16x16x32_bf16 v[164:167], v[24:27], a[84:87], v[164:167]
    v_mul_f32 v236, v236, v76
    v_mul_f32 v237, v237, v77
    v_mfma_f32_16x16x32_bf16 v[168:171], v[24:27], a[88:91], v[168:171]
    v_mul_f32 v238, v238, v78
    v_mul_f32 v239, v239, v79
    v_add_f32 v224, 1.0, v224
    v_mfma_f32_16x16x32_bf16 v[172:175], v[24:27], a[92:95], v[172:175]
    s_add_u32 m0, m0, 4096
    ds_read_b64_tr_b16 v[24:25], v4 offset:24576
    v_mfma_f32_16x16x32_bf16 v[176:179], v[28:31], a[80:83], v[176:179]
    global_load_lds_dwordx4 v[10:11], off
    ds_read_b64_tr_b16 v[26:27], v4 offset:25088
    v_lshl_add_u64 v[10:11], v[10:11], 0, s[100:101]
    v_mfma_f32_16x16x32_bf16 v[180:183], v[28:31], a[84:87], v[180:183]
    v_cvt_pk_bf16_f32 v38, v236, v237
    v_cvt_pk_bf16_f32 v39, v238, v239
    v_mfma_f32_16x16x32_bf16 v[184:187], v[28:31], a[88:91], v[184:187]
    v_add_f32 v225, 1.0, v225
    v_add_f32 v226, 1.0, v226
    v_add_f32 v227, 1.0, v227
    v_mfma_f32_16x16x32_bf16 v[188:191], v[28:31], a[92:95], v[188:191]
    s_waitcnt lgkmcnt(2)
    ds_read_b64_tr_b16 v[28:29], v5 offset:24576
    v_mul_f32 v231, s40, v87
    v_mfma_f32_16x16x32_bf16 v[128:131], v[16:19], a[96:99], v[128:131]
    ds_read_b64_tr_b16 v[30:31], v5 offset:25088
    v_mul_f32 v232, s40, v88
    v_mfma_f32_16x16x32_bf16 v[132:135], v[16:19], a[100:103], v[132:135]
    v_rcp_f32 v224, v224
    v_mul_f32 v233, s40, v89
    v_mfma_f32_16x16x32_bf16 v[136:139], v[16:19], a[104:107], v[136:139]
    v_rcp_f32 v225, v225
    v_mfma_f32_16x16x32_bf16 v[140:143], v[16:19], a[108:111], v[140:143]
    ds_read_b64_tr_b16 v[16:17], v2 offset:28672
    v_rcp_f32 v226, v226
    v_mfma_f32_16x16x32_bf16 v[144:147], v[20:23], a[96:99], v[144:147]
    global_load_dword v12, v13, s[12:13]
    ds_read_b64_tr_b16 v[18:19], v2 offset:29184
    v_mul_f32 v234, s40, v90
    v_mfma_f32_16x16x32_bf16 v[148:151], v[20:23], a[100:103], v[148:151]
    v_rcp_f32 v227, v227
    v_mul_f32 v235, s40, v91
    v_mfma_f32_16x16x32_bf16 v[152:155], v[20:23], a[104:107], v[152:155]
    v_exp_f32 v228, v228
    v_mfma_f32_16x16x32_bf16 v[156:159], v[20:23], a[108:111], v[156:159]
    s_waitcnt lgkmcnt(2)
    ds_read_b64_tr_b16 v[20:21], v3 offset:28672
    v_mul_f32 v224, v224, v80
    v_mfma_f32_16x16x32_bf16 v[160:163], v[24:27], a[96:99], v[160:163]
    ds_read_b64_tr_b16 v[22:23], v3 offset:29184
    v_mul_f32 v225, v225, v81
    v_mfma_f32_16x16x32_bf16 v[164:167], v[24:27], a[100:103], v[164:167]
    v_exp_f32 v229, v229
    v_mul_f32 v226, v226, v82
    v_mfma_f32_16x16x32_bf16 v[168:171], v[24:27], a[104:107], v[168:171]
    v_exp_f32 v230, v230
    v_mfma_f32_16x16x32_bf16 v[172:175], v[24:27], a[108:111], v[172:175]
    ds_read_b64_tr_b16 v[24:25], v4 offset:28672
    v_exp_f32 v231, v231
    v_mfma_f32_16x16x32_bf16 v[176:179], v[28:31], a[96:99], v[176:179]
    ds_read_b64_tr_b16 v[26:27], v4 offset:29184
    v_exp_f32 v232, v232
    v_mfma_f32_16x16x32_bf16 v[180:183], v[28:31], a[100:103], v[180:183]
    v_exp_f32 v233, v233
    v_mfma_f32_16x16x32_bf16 v[184:187], v[28:31], a[104:107], v[184:187]
    v_exp_f32 v234, v234
    v_mul_f32 v227, v227, v83
    v_mfma_f32_16x16x32_bf16 v[188:191], v[28:31], a[108:111], v[188:191]
    s_waitcnt lgkmcnt(2)
    global_load_dword v12, v13, s[14:15]
    ds_read_b64_tr_b16 v[28:29], v5 offset:28672
    v_mfma_f32_16x16x32_bf16 v[128:131], v[16:19], a[112:115], v[128:131]
    ds_read_b64_tr_b16 v[30:31], v5 offset:29184
    v_exp_f32 v235, v235
    v_mfma_f32_16x16x32_bf16 v[132:135], v[16:19], a[116:119], v[132:135]
    v_cvt_pk_bf16_f32 v40, v224, v225
    v_cvt_pk_bf16_f32 v41, v226, v227
    v_mfma_f32_16x16x32_bf16 v[136:139], v[16:19], a[120:123], v[136:139]
    v_add_f32 v228, 1.0, v228
    v_add_f32 v229, 1.0, v229
    v_add_f32 v230, 1.0, v230
    v_mfma_f32_16x16x32_bf16 v[140:143], v[16:19], a[124:127], v[140:143]
    ds_read_b64_tr_b16 v[16:17], v2 offset:32768
    v_add_f32 v231, 1.0, v231
    v_mfma_f32_16x16x32_bf16 v[144:147], v[20:23], a[112:115], v[144:147]
    ds_read_b64_tr_b16 v[18:19], v2 offset:33280
    v_rcp_f32 v228, v228
    v_mfma_f32_16x16x32_bf16 v[148:151], v[20:23], a[116:119], v[148:151]
    v_rcp_f32 v229, v229
    v_mfma_f32_16x16x32_bf16 v[152:155], v[20:23], a[120:123], v[152:155]
    v_rcp_f32 v230, v230
    v_add_f32 v232, 1.0, v232
    v_mfma_f32_16x16x32_bf16 v[156:159], v[20:23], a[124:127], v[156:159]
    s_waitcnt lgkmcnt(2)
    ds_read_b64_tr_b16 v[20:21], v3 offset:32768
    v_mfma_f32_16x16x32_bf16 v[160:163], v[24:27], a[112:115], v[160:163]
    ds_read_b64_tr_b16 v[22:23], v3 offset:33280
    v_rcp_f32 v231, v231
    v_mfma_f32_16x16x32_bf16 v[164:167], v[24:27], a[116:119], v[164:167]
    v_mul_f32 v228, v228, v84
    v_mul_f32 v229, v229, v85
    v_mul_f32 v230, v230, v86
    v_mfma_f32_16x16x32_bf16 v[168:171], v[24:27], a[120:123], v[168:171]
    v_mul_f32 v231, v231, v87
    v_add_f32 v233, 1.0, v233
    v_mfma_f32_16x16x32_bf16 v[172:175], v[24:27], a[124:127], v[172:175]
    ds_read_b64_tr_b16 v[24:25], v4 offset:32768
    v_cvt_pk_bf16_f32 v42, v228, v229
    v_cvt_pk_bf16_f32 v43, v230, v231
    v_mfma_f32_16x16x32_bf16 v[176:179], v[28:31], a[112:115], v[176:179]
    ds_read_b64_tr_b16 v[26:27], v4 offset:33280
    v_add_f32 v234, 1.0, v234
    v_mfma_f32_16x16x32_bf16 v[180:183], v[28:31], a[116:119], v[180:183]
    v_add_f32 v235, 1.0, v235
    v_mul_f32 v236, s40, v92
    v_mul_f32 v237, s40, v93
    v_mfma_f32_16x16x32_bf16 v[184:187], v[28:31], a[120:123], v[184:187]
    v_rcp_f32 v232, v232
    v_mfma_f32_16x16x32_bf16 v[188:191], v[28:31], a[124:127], v[188:191]
    s_waitcnt lgkmcnt(2)
    ds_read_b64_tr_b16 v[28:29], v5 offset:32768
    v_mul_f32 v238, s40, v94
    v_mfma_f32_16x16x32_bf16 v[128:131], v[16:19], a[128:131], v[128:131]
    ds_read_b64_tr_b16 v[30:31], v5 offset:33280
    v_mul_f32 v239, s40, v95
    v_mfma_f32_16x16x32_bf16 v[132:135], v[16:19], a[132:135], v[132:135]
    v_rcp_f32 v233, v233
    v_add_u32 v2, 36864, v2
    v_mfma_f32_16x16x32_bf16 v[136:139], v[16:19], a[136:139], v[136:139]
    v_rcp_f32 v234, v234
    v_mfma_f32_16x16x32_bf16 v[140:143], v[16:19], a[140:143], v[140:143]
    ds_read_b64_tr_b16 v[16:17], v2 offset:0
    v_rcp_f32 v235, v235
    v_mfma_f32_16x16x32_bf16 v[144:147], v[20:23], a[128:131], v[144:147]
    ds_read_b64_tr_b16 v[18:19], v2 offset:512
    v_mul_f32 v232, v232, v88
    v_mfma_f32_16x16x32_bf16 v[148:151], v[20:23], a[132:135], v[148:151]
    v_exp_f32 v236, v236
    v_add_u32 v3, 36864, v3
    v_mfma_f32_16x16x32_bf16 v[152:155], v[20:23], a[136:139], v[152:155]
    v_exp_f32 v237, v237
    v_mul_f32 v233, v233, v89
    v_mfma_f32_16x16x32_bf16 v[156:159], v[20:23], a[140:143], v[156:159]
    s_waitcnt lgkmcnt(2)
    ds_read_b64_tr_b16 v[20:21], v3 offset:0
    v_mfma_f32_16x16x32_bf16 v[160:163], v[24:27], a[128:131], v[160:163]
    ds_read_b64_tr_b16 v[22:23], v3 offset:512
    v_exp_f32 v238, v238
    v_mfma_f32_16x16x32_bf16 v[164:167], v[24:27], a[132:135], v[164:167]
    v_mul_f32 v234, v234, v90
    v_add_u32 v4, 36864, v4
    v_mfma_f32_16x16x32_bf16 v[168:171], v[24:27], a[136:139], v[168:171]
    v_exp_f32 v239, v239
    v_mul_f32 v235, v235, v91
    v_mfma_f32_16x16x32_bf16 v[172:175], v[24:27], a[140:143], v[172:175]
    ds_read_b64_tr_b16 v[24:25], v4 offset:0
    v_cvt_pk_bf16_f32 v44, v232, v233
    v_mfma_f32_16x16x32_bf16 v[176:179], v[28:31], a[128:131], v[176:179]
    ds_read_b64_tr_b16 v[26:27], v4 offset:512
    v_cvt_pk_bf16_f32 v45, v234, v235
    v_add_f32 v236, 1.0, v236
    v_mfma_f32_16x16x32_bf16 v[180:183], v[28:31], a[132:135], v[180:183]
    v_add_f32 v237, 1.0, v237
    v_add_u32 v5, 36864, v5
    v_mfma_f32_16x16x32_bf16 v[184:187], v[28:31], a[136:139], v[184:187]
    v_add_f32 v238, 1.0, v238
    v_add_f32 v239, 1.0, v239
    v_mul_f32 v224, s40, v96
    v_mfma_f32_16x16x32_bf16 v[188:191], v[28:31], a[140:143], v[188:191]
    s_waitcnt lgkmcnt(2)
    ds_read_b64_tr_b16 v[28:29], v5 offset:0
    v_mfma_f32_16x16x32_bf16 v[128:131], v[16:19], a[144:147], v[128:131]
    ds_read_b64_tr_b16 v[30:31], v5 offset:512
    v_rcp_f32 v236, v236
    v_mfma_f32_16x16x32_bf16 v[132:135], v[16:19], a[148:151], v[132:135]
    v_rcp_f32 v237, v237
    v_mfma_f32_16x16x32_bf16 v[136:139], v[16:19], a[152:155], v[136:139]
    v_rcp_f32 v238, v238
    v_mul_f32 v225, s40, v97
    v_mfma_f32_16x16x32_bf16 v[140:143], v[16:19], a[156:159], v[140:143]
    ds_read_b64_tr_b16 v[16:17], v2 offset:4096
    v_mul_f32 v226, s40, v98
    v_mfma_f32_16x16x32_bf16 v[144:147], v[20:23], a[144:147], v[144:147]
    ds_read_b64_tr_b16 v[18:19], v2 offset:4608
    v_rcp_f32 v239, v239
    v_mfma_f32_16x16x32_bf16 v[148:151], v[20:23], a[148:151], v[148:151]
    v_mul_f32 v236, v236, v92
    v_mul_f32 v237, v237, v93
    v_mul_f32 v238, v238, v94
    v_mfma_f32_16x16x32_bf16 v[152:155], v[20:23], a[152:155], v[152:155]
    v_mul_f32 v239, v239, v95
    v_mul_f32 v227, s40, v99
    v_mfma_f32_16x16x32_bf16 v[156:159], v[20:23], a[156:159], v[156:159]
    s_waitcnt lgkmcnt(2)
    ds_read_b64_tr_b16 v[20:21], v3 offset:4096
    v_cvt_pk_bf16_f32 v46, v236, v237
    v_mfma_f32_16x16x32_bf16 v[160:163], v[24:27], a[144:147], v[160:163]
    ds_read_b64_tr_b16 v[22:23], v3 offset:4608
    v_cvt_pk_bf16_f32 v47, v238, v239
    v_mfma_f32_16x16x32_bf16 v[164:167], v[24:27], a[148:151], v[164:167]
    v_exp_f32 v224, v224
    v_mul_f32 v228, s40, v100
    v_mfma_f32_16x16x32_bf16 v[168:171], v[24:27], a[152:155], v[168:171]
    v_exp_f32 v225, v225
    v_mfma_f32_16x16x32_bf16 v[172:175], v[24:27], a[156:159], v[172:175]
    ds_read_b64_tr_b16 v[24:25], v4 offset:4096
    v_exp_f32 v226, v226
    v_mfma_f32_16x16x32_bf16 v[176:179], v[28:31], a[144:147], v[176:179]
    ds_read_b64_tr_b16 v[26:27], v4 offset:4608
    v_mul_f32 v229, s40, v101
    v_mfma_f32_16x16x32_bf16 v[180:183], v[28:31], a[148:151], v[180:183]
    v_exp_f32 v227, v227
    v_mul_f32 v230, s40, v102
    v_mfma_f32_16x16x32_bf16 v[184:187], v[28:31], a[152:155], v[184:187]
    v_add_f32 v224, 1.0, v224
    v_add_f32 v225, 1.0, v225
    v_mfma_f32_16x16x32_bf16 v[188:191], v[28:31], a[156:159], v[188:191]
    s_waitcnt lgkmcnt(2)
    ds_read_b64_tr_b16 v[28:29], v5 offset:4096
    v_add_f32 v226, 1.0, v226
    v_mfma_f32_16x16x32_bf16 v[128:131], v[16:19], a[160:163], v[128:131]
    ds_read_b64_tr_b16 v[30:31], v5 offset:4608
    v_add_f32 v227, 1.0, v227
    v_mfma_f32_16x16x32_bf16 v[132:135], v[16:19], a[164:167], v[132:135]
    v_rcp_f32 v224, v224
    v_mul_f32 v231, s40, v103
    v_mfma_f32_16x16x32_bf16 v[136:139], v[16:19], a[168:171], v[136:139]
    v_rcp_f32 v225, v225
    v_mul_f32 v232, s40, v104
    v_mfma_f32_16x16x32_bf16 v[140:143], v[16:19], a[172:175], v[140:143]
    ds_read_b64_tr_b16 v[16:17], v2 offset:8192
    v_mul_f32 v233, s40, v105
    v_mfma_f32_16x16x32_bf16 v[144:147], v[20:23], a[160:163], v[144:147]
    ds_read_b64_tr_b16 v[18:19], v2 offset:8704
    v_rcp_f32 v226, v226
    v_mfma_f32_16x16x32_bf16 v[148:151], v[20:23], a[164:167], v[148:151]
    v_rcp_f32 v227, v227
    v_mfma_f32_16x16x32_bf16 v[152:155], v[20:23], a[168:171], v[152:155]
    v_exp_f32 v228, v228
    v_mul_f32 v224, v224, v96
    v_mfma_f32_16x16x32_bf16 v[156:159], v[20:23], a[172:175], v[156:159]
    s_waitcnt lgkmcnt(2)
    ds_read_b64_tr_b16 v[20:21], v3 offset:8192
    v_mfma_f32_16x16x32_bf16 v[160:163], v[24:27], a[160:163], v[160:163]
    ds_read_b64_tr_b16 v[22:23], v3 offset:8704
    v_exp_f32 v229, v229
    v_mfma_f32_16x16x32_bf16 v[164:167], v[24:27], a[164:167], v[164:167]
    v_exp_f32 v230, v230
    v_mfma_f32_16x16x32_bf16 v[168:171], v[24:27], a[168:171], v[168:171]
    v_exp_f32 v231, v231
    v_mul_f32 v225, v225, v97
    v_mfma_f32_16x16x32_bf16 v[172:175], v[24:27], a[172:175], v[172:175]
    ds_read_b64_tr_b16 v[24:25], v4 offset:8192
    v_mul_f32 v226, v226, v98
    v_mfma_f32_16x16x32_bf16 v[176:179], v[28:31], a[160:163], v[176:179]
    ds_read_b64_tr_b16 v[26:27], v4 offset:8704
    v_mul_f32 v227, v227, v99
    v_add_f32 v228, 1.0, v228
    v_mfma_f32_16x16x32_bf16 v[180:183], v[28:31], a[164:167], v[180:183]
    v_cvt_pk_bf16_f32 v48, v224, v225
    v_cvt_pk_bf16_f32 v49, v226, v227
    v_mfma_f32_16x16x32_bf16 v[184:187], v[28:31], a[168:171], v[184:187]
    v_add_f32 v229, 1.0, v229
    v_add_f32 v230, 1.0, v230
    v_add_f32 v231, 1.0, v231
    v_mfma_f32_16x16x32_bf16 v[188:191], v[28:31], a[172:175], v[188:191]
    s_waitcnt lgkmcnt(2)
    ds_read_b64_tr_b16 v[28:29], v5 offset:8192
    v_mul_f32 v234, s40, v106
    v_mfma_f32_16x16x32_bf16 v[128:131], v[16:19], a[176:179], v[128:131]
    ds_read_b64_tr_b16 v[30:31], v5 offset:8704
    v_mul_f32 v235, s40, v107
    v_mfma_f32_16x16x32_bf16 v[132:135], v[16:19], a[180:183], v[132:135]
    s_waitcnt vmcnt(20)
    s_barrier
    buffer_store_dword v254, off, s[20:23], s24 sc1
    v_mfma_f32_16x16x32_bf16 v[136:139], v[16:19], a[184:187], v[136:139]
    v_rcp_f32 v228, v228
    v_mfma_f32_16x16x32_bf16 v[140:143], v[16:19], a[188:191], v[140:143]
    ds_read_b64_tr_b16 v[16:17], v2 offset:12288
    v_rcp_f32 v229, v229
    v_mfma_f32_16x16x32_bf16 v[144:147], v[20:23], a[176:179], v[144:147]
    ds_read_b64_tr_b16 v[18:19], v2 offset:12800
    v_mul_f32 v236, s40, v108
    v_mfma_f32_16x16x32_bf16 v[148:151], v[20:23], a[180:183], v[148:151]
    v_rcp_f32 v230, v230
    v_mul_f32 v237, s40, v109
    v_mfma_f32_16x16x32_bf16 v[152:155], v[20:23], a[184:187], v[152:155]
    v_rcp_f32 v231, v231
    v_mfma_f32_16x16x32_bf16 v[156:159], v[20:23], a[188:191], v[156:159]
    s_waitcnt lgkmcnt(2)
    ds_read_b64_tr_b16 v[20:21], v3 offset:12288
    v_mul_f32 v228, v228, v100
    v_mfma_f32_16x16x32_bf16 v[160:163], v[24:27], a[176:179], v[160:163]
    ds_read_b64_tr_b16 v[22:23], v3 offset:12800
    v_mul_f32 v229, v229, v101
    v_mfma_f32_16x16x32_bf16 v[164:167], v[24:27], a[180:183], v[164:167]
    v_exp_f32 v232, v232
    v_mul_f32 v230, v230, v102
    v_mfma_f32_16x16x32_bf16 v[168:171], v[24:27], a[184:187], v[168:171]
    v_exp_f32 v233, v233
    v_mfma_f32_16x16x32_bf16 v[172:175], v[24:27], a[188:191], v[172:175]
    ds_read_b64_tr_b16 v[24:25], v4 offset:12288
    v_exp_f32 v234, v234
    v_mfma_f32_16x16x32_bf16 v[176:179], v[28:31], a[176:179], v[176:179]
    ds_read_b64_tr_b16 v[26:27], v4 offset:12800
    v_exp_f32 v235, v235
    v_mfma_f32_16x16x32_bf16 v[180:183], v[28:31], a[180:183], v[180:183]
    v_mul_f32 v231, v231, v103
    v_add_f32 v232, 1.0, v232
    v_mfma_f32_16x16x32_bf16 v[184:187], v[28:31], a[184:187], v[184:187]
    v_cvt_pk_bf16_f32 v50, v228, v229
    v_cvt_pk_bf16_f32 v51, v230, v231
    v_add_f32 v233, 1.0, v233
    v_mfma_f32_16x16x32_bf16 v[188:191], v[28:31], a[188:191], v[188:191]
    s_waitcnt lgkmcnt(2)
    ds_read_b64_tr_b16 v[28:29], v5 offset:12288
    v_mfma_f32_16x16x32_bf16 v[128:131], v[16:19], a[192:195], v[128:131]
    ds_read_b64_tr_b16 v[30:31], v5 offset:12800
    v_add_f32 v234, 1.0, v234
    v_add_f32 v235, 1.0, v235
    v_mfma_f32_16x16x32_bf16 v[132:135], v[16:19], a[196:199], v[132:135]
    v_rcp_f32 v232, v232
    v_mfma_f32_16x16x32_bf16 v[136:139], v[16:19], a[200:203], v[136:139]
    v_rcp_f32 v233, v233
    v_mul_f32 v238, s40, v110
    v_mfma_f32_16x16x32_bf16 v[140:143], v[16:19], a[204:207], v[140:143]
    ds_read_b64_tr_b16 v[16:17], v2 offset:16384
    v_mul_f32 v239, s40, v111
    v_mfma_f32_16x16x32_bf16 v[144:147], v[20:23], a[192:195], v[144:147]
    ds_read_b64_tr_b16 v[18:19], v2 offset:16896
    v_rcp_f32 v234, v234
    v_mfma_f32_16x16x32_bf16 v[148:151], v[20:23], a[196:199], v[148:151]
    v_rcp_f32 v235, v235
    v_mfma_f32_16x16x32_bf16 v[152:155], v[20:23], a[200:203], v[152:155]
    v_exp_f32 v236, v236
    v_mul_f32 v232, v232, v104
    v_mfma_f32_16x16x32_bf16 v[156:159], v[20:23], a[204:207], v[156:159]
    s_waitcnt lgkmcnt(2)
    ds_read_b64_tr_b16 v[20:21], v3 offset:16384
    v_mfma_f32_16x16x32_bf16 v[160:163], v[24:27], a[192:195], v[160:163]
    ds_read_b64_tr_b16 v[22:23], v3 offset:16896
    v_exp_f32 v237, v237
    v_mfma_f32_16x16x32_bf16 v[164:167], v[24:27], a[196:199], v[164:167]
    v_exp_f32 v238, v238
    v_mul_f32 v233, v233, v105
    v_mfma_f32_16x16x32_bf16 v[168:171], v[24:27], a[200:203], v[168:171]
    buffer_load_dword v12, v15, s[84:87], s28 offen
    v_exp_f32 v239, v239
    v_mfma_f32_16x16x32_bf16 v[172:175], v[24:27], a[204:207], v[172:175]
    ds_read_b64_tr_b16 v[24:25], v4 offset:16384
    v_mul_f32 v234, v234, v106
    v_mul_f32 v235, v235, v107
    v_mfma_f32_16x16x32_bf16 v[176:179], v[28:31], a[192:195], v[176:179]
    ds_read_b64_tr_b16 v[26:27], v4 offset:16896
    v_cvt_pk_bf16_f32 v52, v232, v233
    v_mfma_f32_16x16x32_bf16 v[180:183], v[28:31], a[196:199], v[180:183]
    v_cvt_pk_bf16_f32 v53, v234, v235
    v_add_f32 v236, 1.0, v236
    v_add_f32 v237, 1.0, v237
    v_mfma_f32_16x16x32_bf16 v[184:187], v[28:31], a[200:203], v[184:187]
    s_add_u32 s28, s28, 4608
    v_add_f32 v238, 1.0, v238
    v_add_f32 v239, 1.0, v239
    v_mfma_f32_16x16x32_bf16 v[188:191], v[28:31], a[204:207], v[188:191]
    s_waitcnt lgkmcnt(2)
    ds_read_b64_tr_b16 v[28:29], v5 offset:16384
    v_mul_f32 v224, s40, v112
    v_mfma_f32_16x16x32_bf16 v[128:131], v[16:19], a[208:211], v[128:131]
    ds_read_b64_tr_b16 v[30:31], v5 offset:16896
    v_mul_f32 v225, s40, v113
    v_mfma_f32_16x16x32_bf16 v[132:135], v[16:19], a[212:215], v[132:135]
    v_rcp_f32 v236, v236
    v_mul_f32 v226, s40, v114
    v_mfma_f32_16x16x32_bf16 v[136:139], v[16:19], a[216:219], v[136:139]
    v_rcp_f32 v237, v237
    v_mfma_f32_16x16x32_bf16 v[140:143], v[16:19], a[220:223], v[140:143]
    ds_read_b64_tr_b16 v[16:17], v2 offset:20480
    v_rcp_f32 v238, v238
    v_mfma_f32_16x16x32_bf16 v[144:147], v[20:23], a[208:211], v[144:147]
    ds_read_b64_tr_b16 v[18:19], v2 offset:20992
    v_mul_f32 v227, s40, v115
    v_mfma_f32_16x16x32_bf16 v[148:151], v[20:23], a[212:215], v[148:151]
    v_rcp_f32 v239, v239
    v_mul_f32 v228, s40, v116
    v_mfma_f32_16x16x32_bf16 v[152:155], v[20:23], a[216:219], v[152:155]
    v_exp_f32 v224, v224
    v_mfma_f32_16x16x32_bf16 v[156:159], v[20:23], a[220:223], v[156:159]
    s_waitcnt lgkmcnt(2)
    ds_read_b64_tr_b16 v[20:21], v3 offset:20480
    v_mul_f32 v236, v236, v108
    v_mfma_f32_16x16x32_bf16 v[160:163], v[24:27], a[208:211], v[160:163]
    ds_read_b64_tr_b16 v[22:23], v3 offset:20992
    v_exp_f32 v225, v225
    v_mfma_f32_16x16x32_bf16 v[164:167], v[24:27], a[212:215], v[164:167]
    v_exp_f32 v226, v226
    v_mfma_f32_16x16x32_bf16 v[168:171], v[24:27], a[216:219], v[168:171]
    v_exp_f32 v227, v227
    v_mul_f32 v237, v237, v109
    v_mfma_f32_16x16x32_bf16 v[172:175], v[24:27], a[220:223], v[172:175]
    ds_read_b64_tr_b16 v[24:25], v4 offset:20480
    v_mul_f32 v238, v238, v110
    v_mfma_f32_16x16x32_bf16 v[176:179], v[28:31], a[208:211], v[176:179]
    ds_read_b64_tr_b16 v[26:27], v4 offset:20992
    v_mul_f32 v239, v239, v111
    v_add_f32 v224, 1.0, v224
    v_mfma_f32_16x16x32_bf16 v[180:183], v[28:31], a[212:215], v[180:183]
    v_cvt_pk_bf16_f32 v54, v236, v237
    v_cvt_pk_bf16_f32 v55, v238, v239
    v_mfma_f32_16x16x32_bf16 v[184:187], v[28:31], a[216:219], v[184:187]
    v_add_f32 v225, 1.0, v225
    v_add_f32 v226, 1.0, v226
    v_add_f32 v227, 1.0, v227
    v_mfma_f32_16x16x32_bf16 v[188:191], v[28:31], a[220:223], v[188:191]
    s_waitcnt lgkmcnt(2)
    ds_read_b64_tr_b16 v[28:29], v5 offset:20480
    v_mfma_f32_16x16x32_bf16 v[128:131], v[16:19], a[224:227], v[128:131]
    ds_read_b64_tr_b16 v[30:31], v5 offset:20992
    v_rcp_f32 v224, v224
    v_mfma_f32_16x16x32_bf16 v[132:135], v[16:19], a[228:231], v[132:135]
    v_rcp_f32 v225, v225
    v_mfma_f32_16x16x32_bf16 v[136:139], v[16:19], a[232:235], v[136:139]
    v_rcp_f32 v226, v226
    v_mul_f32 v229, s40, v117
    v_mfma_f32_16x16x32_bf16 v[140:143], v[16:19], a[236:239], v[140:143]
    ds_read_b64_tr_b16 v[16:17], v2 offset:24576
    v_mul_f32 v230, s40, v118
    v_mfma_f32_16x16x32_bf16 v[144:147], v[20:23], a[224:227], v[144:147]
    ds_read_b64_tr_b16 v[18:19], v2 offset:25088
    v_rcp_f32 v227, v227
    v_mfma_f32_16x16x32_bf16 v[148:151], v[20:23], a[228:231], v[148:151]
    v_mul_f32 v224, v224, v112
    v_mul_f32 v225, v225, v113
    v_mul_f32 v226, v226, v114
    v_mfma_f32_16x16x32_bf16 v[152:155], v[20:23], a[232:235], v[152:155]
    v_mul_f32 v227, v227, v115
    v_mul_f32 v231, s40, v119
    v_mfma_f32_16x16x32_bf16 v[156:159], v[20:23], a[236:239], v[156:159]
    s_waitcnt lgkmcnt(2)
    ds_read_b64_tr_b16 v[20:21], v3 offset:24576
    v_cvt_pk_bf16_f32 v56, v224, v225
    v_mfma_f32_16x16x32_bf16 v[160:163], v[24:27], a[224:227], v[160:163]
    ds_read_b64_tr_b16 v[22:23], v3 offset:25088
    v_cvt_pk_bf16_f32 v57, v226, v227
    v_mfma_f32_16x16x32_bf16 v[164:167], v[24:27], a[228:231], v[164:167]
    v_exp_f32 v228, v228
    v_mul_f32 v232, s40, v120
    v_mfma_f32_16x16x32_bf16 v[168:171], v[24:27], a[232:235], v[168:171]
    v_exp_f32 v229, v229
    v_mfma_f32_16x16x32_bf16 v[172:175], v[24:27], a[236:239], v[172:175]
    ds_read_b64_tr_b16 v[24:25], v4 offset:24576
    v_exp_f32 v230, v230
    v_mfma_f32_16x16x32_bf16 v[176:179], v[28:31], a[224:227], v[176:179]
    ds_read_b64_tr_b16 v[26:27], v4 offset:25088
    v_mul_f32 v233, s40, v121
    v_mfma_f32_16x16x32_bf16 v[180:183], v[28:31], a[228:231], v[180:183]
    v_exp_f32 v231, v231
    v_mul_f32 v234, s40, v122
    v_mfma_f32_16x16x32_bf16 v[184:187], v[28:31], a[232:235], v[184:187]
    v_add_f32 v228, 1.0, v228
    v_add_f32 v229, 1.0, v229
    v_mfma_f32_16x16x32_bf16 v[188:191], v[28:31], a[236:239], v[188:191]
    s_waitcnt lgkmcnt(2)
    ds_read_b64_tr_b16 v[28:29], v5 offset:24576
    v_add_f32 v230, 1.0, v230
    v_mfma_f32_16x16x32_bf16 v[128:131], v[16:19], a[240:243], v[128:131]
    ds_read_b64_tr_b16 v[30:31], v5 offset:25088
    v_add_f32 v231, 1.0, v231
    v_mfma_f32_16x16x32_bf16 v[132:135], v[16:19], a[244:247], v[132:135]
    v_rcp_f32 v228, v228
    v_mul_f32 v235, s40, v123
    v_mfma_f32_16x16x32_bf16 v[136:139], v[16:19], a[248:251], v[136:139]
    v_rcp_f32 v229, v229
    v_mul_f32 v236, s40, v124
    v_mfma_f32_16x16x32_bf16 v[140:143], v[16:19], a[252:255], v[140:143]
    ds_read_b64_tr_b16 v[16:17], v2 offset:28672
    v_mul_f32 v237, s40, v125
    v_mfma_f32_16x16x32_bf16 v[144:147], v[20:23], a[240:243], v[144:147]
    ds_read_b64_tr_b16 v[18:19], v2 offset:29184
    v_rcp_f32 v230, v230
    v_mfma_f32_16x16x32_bf16 v[148:151], v[20:23], a[244:247], v[148:151]
    v_rcp_f32 v231, v231
    v_mfma_f32_16x16x32_bf16 v[152:155], v[20:23], a[248:251], v[152:155]
    v_exp_f32 v232, v232
    v_mul_f32 v228, v228, v116
    v_mfma_f32_16x16x32_bf16 v[156:159], v[20:23], a[252:255], v[156:159]
    s_waitcnt lgkmcnt(2)
    ds_read_b64_tr_b16 v[20:21], v3 offset:28672
    v_mfma_f32_16x16x32_bf16 v[160:163], v[24:27], a[240:243], v[160:163]
    ds_read_b64_tr_b16 v[22:23], v3 offset:29184
    v_exp_f32 v233, v233
    v_mfma_f32_16x16x32_bf16 v[164:167], v[24:27], a[244:247], v[164:167]
    v_exp_f32 v234, v234
    v_mfma_f32_16x16x32_bf16 v[168:171], v[24:27], a[248:251], v[168:171]
    v_exp_f32 v235, v235
    v_mul_f32 v229, v229, v117
    v_mfma_f32_16x16x32_bf16 v[172:175], v[24:27], a[252:255], v[172:175]
    ds_read_b64_tr_b16 v[24:25], v4 offset:28672
    v_mul_f32 v230, v230, v118
    v_mfma_f32_16x16x32_bf16 v[176:179], v[28:31], a[240:243], v[176:179]
    ds_read_b64_tr_b16 v[26:27], v4 offset:29184
    v_mul_f32 v231, v231, v119
    v_add_f32 v232, 1.0, v232
    v_mfma_f32_16x16x32_bf16 v[180:183], v[28:31], a[244:247], v[180:183]
    v_cvt_pk_bf16_f32 v58, v228, v229
    v_cvt_pk_bf16_f32 v59, v230, v231
    v_mfma_f32_16x16x32_bf16 v[184:187], v[28:31], a[248:251], v[184:187]
    v_add_f32 v233, 1.0, v233
    v_add_f32 v234, 1.0, v234
    v_add_f32 v235, 1.0, v235
    v_mfma_f32_16x16x32_bf16 v[188:191], v[28:31], a[252:255], v[188:191]
    s_waitcnt lgkmcnt(2)
    ds_read_b64_tr_b16 v[28:29], v5 offset:28672
    v_mul_f32 v238, s40, v126
    v_mfma_f32_16x16x32_bf16 v[128:131], v[16:19], v[192:195], v[128:131]
    ds_read_b64_tr_b16 v[30:31], v5 offset:29184
    v_mul_f32 v239, s40, v127
    v_mfma_f32_16x16x32_bf16 v[132:135], v[16:19], v[196:199], v[132:135]
    v_rcp_f32 v232, v232
    v_mfma_f32_16x16x32_bf16 v[136:139], v[16:19], v[200:203], v[136:139]
    v_rcp_f32 v233, v233
    v_mfma_f32_16x16x32_bf16 v[140:143], v[16:19], v[204:207], v[140:143]
    ds_read_b64_tr_b16 v[16:17], v2 offset:32768
    v_rcp_f32 v234, v234
    v_mfma_f32_16x16x32_bf16 v[144:147], v[20:23], v[192:195], v[144:147]
    ds_read_b64_tr_b16 v[18:19], v2 offset:33280
    v_mfma_f32_16x16x32_bf16 v[148:151], v[20:23], v[196:199], v[148:151]
    v_rcp_f32 v235, v235
    v_mfma_f32_16x16x32_bf16 v[152:155], v[20:23], v[200:203], v[152:155]
    v_exp_f32 v236, v236
    v_mfma_f32_16x16x32_bf16 v[156:159], v[20:23], v[204:207], v[156:159]
    s_waitcnt lgkmcnt(2)
    ds_read_b64_tr_b16 v[20:21], v3 offset:32768
    v_mul_f32 v232, v232, v120
    v_mfma_f32_16x16x32_bf16 v[160:163], v[24:27], v[192:195], v[160:163]
    ds_read_b64_tr_b16 v[22:23], v3 offset:33280
    v_mul_f32 v233, v233, v121
    v_mfma_f32_16x16x32_bf16 v[164:167], v[24:27], v[196:199], v[164:167]
    v_exp_f32 v237, v237
    v_mul_f32 v234, v234, v122
    v_mfma_f32_16x16x32_bf16 v[168:171], v[24:27], v[200:203], v[168:171]
    v_exp_f32 v238, v238
    v_mfma_f32_16x16x32_bf16 v[172:175], v[24:27], v[204:207], v[172:175]
    ds_read_b64_tr_b16 v[24:25], v4 offset:32768
    v_exp_f32 v239, v239
    v_mfma_f32_16x16x32_bf16 v[176:179], v[28:31], v[192:195], v[176:179]
    ds_read_b64_tr_b16 v[26:27], v4 offset:33280
    v_mul_f32 v235, v235, v123
    v_add_f32 v236, 1.0, v236
    v_mfma_f32_16x16x32_bf16 v[180:183], v[28:31], v[196:199], v[180:183]
    v_cvt_pk_bf16_f32 v60, v232, v233
    v_cvt_pk_bf16_f32 v61, v234, v235
    v_mfma_f32_16x16x32_bf16 v[184:187], v[28:31], v[200:203], v[184:187]
    v_add_f32 v237, 1.0, v237
    v_add_f32 v238, 1.0, v238
    v_add_f32 v239, 1.0, v239
    v_mfma_f32_16x16x32_bf16 v[188:191], v[28:31], v[204:207], v[188:191]
    s_waitcnt lgkmcnt(2)
    ds_read_b64_tr_b16 v[28:29], v5 offset:32768
    v_mfma_f32_16x16x32_bf16 v[128:131], v[16:19], v[208:211], v[128:131]
    ds_read_b64_tr_b16 v[30:31], v5 offset:33280
    v_rcp_f32 v236, v236
    v_mfma_f32_16x16x32_bf16 v[132:135], v[16:19], v[212:215], v[132:135]
    v_mov_b32 v2, v6
    v_mfma_f32_16x16x32_bf16 v[136:139], v[16:19], v[216:219], v[136:139]
    s_waitcnt vmcnt(4)
    s_barrier
    v_mfma_f32_16x16x32_bf16 v[140:143], v[16:19], v[220:223], v[140:143]
    ds_read_b64_tr_b16 v[16:17], v2 offset:0
    v_mfma_f32_16x16x32_bf16 v[144:147], v[20:23], v[208:211], v[144:147]
    ds_read_b64_tr_b16 v[18:19], v2 offset:512
    v_rcp_f32 v237, v237
    v_mfma_f32_16x16x32_bf16 v[148:151], v[20:23], v[212:215], v[148:151]
    v_mov_b32 v3, v7
    v_mfma_f32_16x16x32_bf16 v[152:155], v[20:23], v[216:219], v[152:155]
    v_rcp_f32 v238, v238
    v_mfma_f32_16x16x32_bf16 v[156:159], v[20:23], v[220:223], v[156:159]
    s_waitcnt lgkmcnt(2)
    ds_read_b64_tr_b16 v[20:21], v3 offset:0
    v_mfma_f32_16x16x32_bf16 v[160:163], v[24:27], v[208:211], v[160:163]
    ds_read_b64_tr_b16 v[22:23], v3 offset:512
    v_rcp_f32 v239, v239
    v_mfma_f32_16x16x32_bf16 v[164:167], v[24:27], v[212:215], v[164:167]
    v_mul_f32 v236, v236, v124
    v_mul_f32 v237, v237, v125
    v_mov_b32 v4, v8
    v_mfma_f32_16x16x32_bf16 v[168:171], v[24:27], v[216:219], v[168:171]
    v_mul_f32 v238, v238, v126
    v_mul_f32 v239, v239, v127
    v_mfma_f32_16x16x32_bf16 v[172:175], v[24:27], v[220:223], v[172:175]
    ds_read_b64_tr_b16 v[24:25], v4 offset:0
    v_cvt_pk_bf16_f32 v62, v236, v237
    v_cvt_pk_bf16_f32 v63, v238, v239
    v_mfma_f32_16x16x32_bf16 v[176:179], v[28:31], v[208:211], v[176:179]
    ds_read_b64_tr_b16 v[26:27], v4 offset:512
    v_mfma_f32_16x16x32_bf16 v[180:183], v[28:31], v[212:215], v[180:183]
    v_mov_b32 v5, v9
    v_mfma_f32_16x16x32_bf16 v[184:187], v[28:31], v[216:219], v[184:187]
    v_mfma_f32_16x16x32_bf16 v[188:191], v[28:31], v[220:223], v[188:191]
    ds_read_b64_tr_b16 v[28:29], v5 offset:0
    ds_read_b64_tr_b16 v[30:31], v5 offset:512
    s_cmp_lg_u32 s43, 0
    s_cbranch_scc1 KF_z
    v_lshl_add_u64 v[10:11], v[10:11], 0, s[58:59]
    v_add_u32 v6, 73728, v240
    v_add_u32 v7, 73728, v241
    v_add_u32 v8, 73728, v242
    v_add_u32 v9, 73728, v243
    s_waitcnt lgkmcnt(4)
    v_mfma_f32_16x16x32_bf16 v[64:67], v[16:19], a[0:3], 0
    v_mfma_f32_16x16x32_bf16 v[68:71], v[16:19], a[4:7], 0
    s_add_u32 m0, m0, 4096
    v_mfma_f32_16x16x32_bf16 v[72:75], v[16:19], a[8:11], 0
    global_load_lds_dwordx4 v[10:11], off
    v_lshl_add_u64 v[10:11], v[10:11], 0, s[100:101]
    v_mfma_f32_16x16x32_bf16 v[76:79], v[16:19], a[12:15], 0
    ds_read_b64_tr_b16 v[16:17], v2 offset:4096
    v_mfma_f32_16x16x32_bf16 v[80:83], v[20:23], a[0:3], 0
    ds_read_b64_tr_b16 v[18:19], v2 offset:4608
    v_mfma_f32_16x16x32_bf16 v[84:87], v[20:23], a[4:7], 0
    v_mfma_f32_16x16x32_bf16 v[88:91], v[20:23], a[8:11], 0
    s_add_u32 m0, m0, 4096
    v_mfma_f32_16x16x32_bf16 v[92:95], v[20:23], a[12:15], 0
    s_waitcnt lgkmcnt(2)
    global_load_lds_dwordx4 v[10:11], off
    ds_read_b64_tr_b16 v[20:21], v3 offset:4096
    v_lshl_add_u64 v[10:11], v[10:11], 0, s[100:101]
    v_mfma_f32_16x16x32_bf16 v[96:99], v[24:27], a[0:3], 0
    ds_read_b64_tr_b16 v[22:23], v3 offset:4608
    v_mfma_f32_16x16x32_bf16 v[100:103], v[24:27], a[4:7], 0
    v_mfma_f32_16x16x32_bf16 v[104:107], v[24:27], a[8:11], 0
    v_mfma_f32_16x16x32_bf16 v[108:111], v[24:27], a[12:15], 0
    s_add_u32 m0, m0, 4096
    ds_read_b64_tr_b16 v[24:25], v4 offset:4096
    v_mfma_f32_16x16x32_bf16 v[112:115], v[28:31], a[0:3], 0
    global_load_lds_dwordx4 v[10:11], off
    ds_read_b64_tr_b16 v[26:27], v4 offset:4608
    v_lshl_add_u64 v[10:11], v[10:11], 0, s[100:101]
    v_mfma_f32_16x16x32_bf16 v[116:119], v[28:31], a[4:7], 0
    v_mfma_f32_16x16x32_bf16 v[120:123], v[28:31], a[8:11], 0
    v_mfma_f32_16x16x32_bf16 v[124:127], v[28:31], a[12:15], 0
    s_waitcnt lgkmcnt(2)
    ds_read_b64_tr_b16 v[28:29], v5 offset:4096
    v_mfma_f32_16x16x32_bf16 v[64:67], v[16:19], a[16:19], v[64:67]
    ds_read_b64_tr_b16 v[30:31], v5 offset:4608
    v_mfma_f32_16x16x32_bf16 v[68:71], v[16:19], a[20:23], v[68:71]
    s_add_u32 m0, m0, 4096
    v_mfma_f32_16x16x32_bf16 v[72:75], v[16:19], a[24:27], v[72:75]
    global_load_lds_dwordx4 v[10:11], off
    v_lshl_add_u64 v[10:11], v[10:11], 0, s[100:101]
    v_mfma_f32_16x16x32_bf16 v[76:79], v[16:19], a[28:31], v[76:79]
    ds_read_b64_tr_b16 v[16:17], v2 offset:8192
    v_mfma_f32_16x16x32_bf16 v[80:83], v[20:23], a[16:19], v[80:83]
    ds_read_b64_tr_b16 v[18:19], v2 offset:8704
    v_mfma_f32_16x16x32_bf16 v[84:87], v[20:23], a[20:23], v[84:87]
    v_mfma_f32_16x16x32_bf16 v[88:91], v[20:23], a[24:27], v[88:91]
    s_add_u32 m0, m0, 4096
    v_mfma_f32_16x16x32_bf16 v[92:95], v[20:23], a[28:31], v[92:95]
    s_waitcnt lgkmcnt(2)
    global_load_lds_dwordx4 v[10:11], off
    ds_read_b64_tr_b16 v[20:21], v3 offset:8192
    v_lshl_add_u64 v[10:11], v[10:11], 0, s[100:101]
    v_mfma_f32_16x16x32_bf16 v[96:99], v[24:27], a[16:19], v[96:99]
    ds_read_b64_tr_b16 v[22:23], v3 offset:8704
    v_mfma_f32_16x16x32_bf16 v[100:103], v[24:27], a[20:23], v[100:103]
    v_mfma_f32_16x16x32_bf16 v[104:107], v[24:27], a[24:27], v[104:107]
    v_mfma_f32_16x16x32_bf16 v[108:111], v[24:27], a[28:31], v[108:111]
    s_add_u32 m0, m0, 4096
    ds_read_b64_tr_b16 v[24:25], v4 offset:8192
    v_mfma_f32_16x16x32_bf16 v[112:115], v[28:31], a[16:19], v[112:115]
    global_load_lds_dwordx4 v[10:11], off
    ds_read_b64_tr_b16 v[26:27], v4 offset:8704
    v_lshl_add_u64 v[10:11], v[10:11], 0, s[100:101]
    v_mfma_f32_16x16x32_bf16 v[116:119], v[28:31], a[20:23], v[116:119]
    v_mfma_f32_16x16x32_bf16 v[120:123], v[28:31], a[24:27], v[120:123]
    v_mfma_f32_16x16x32_bf16 v[124:127], v[28:31], a[28:31], v[124:127]
    s_waitcnt lgkmcnt(2)
    ds_read_b64_tr_b16 v[28:29], v5 offset:8192
    v_mfma_f32_16x16x32_bf16 v[64:67], v[16:19], a[32:35], v[64:67]
    ds_read_b64_tr_b16 v[30:31], v5 offset:8704
    v_mfma_f32_16x16x32_bf16 v[68:71], v[16:19], a[36:39], v[68:71]
    s_add_u32 m0, m0, 4096
    v_mfma_f32_16x16x32_bf16 v[72:75], v[16:19], a[40:43], v[72:75]
    global_load_lds_dwordx4 v[10:11], off
    v_lshl_add_u64 v[10:11], v[10:11], 0, s[100:101]
    v_mfma_f32_16x16x32_bf16 v[76:79], v[16:19], a[44:47], v[76:79]
    ds_read_b64_tr_b16 v[16:17], v2 offset:12288
    v_mfma_f32_16x16x32_bf16 v[80:83], v[20:23], a[32:35], v[80:83]
    ds_read_b64_tr_b16 v[18:19], v2 offset:12800
    v_mfma_f32_16x16x32_bf16 v[84:87], v[20:23], a[36:39], v[84:87]
    v_mfma_f32_16x16x32_bf16 v[88:91], v[20:23], a[40:43], v[88:91]
    s_add_u32 m0, m0, 4096
    v_mfma_f32_16x16x32_bf16 v[92:95], v[20:23], a[44:47], v[92:95]
    s_waitcnt lgkmcnt(2)
    global_load_lds_dwordx4 v[10:11], off
    ds_read_b64_tr_b16 v[20:21], v3 offset:12288
    v_lshl_add_u64 v[10:11], v[10:11], 0, s[100:101]
    v_mfma_f32_16x16x32_bf16 v[96:99], v[24:27], a[32:35], v[96:99]
    ds_read_b64_tr_b16 v[22:23], v3 offset:12800
    v_mfma_f32_16x16x32_bf16 v[100:103], v[24:27], a[36:39], v[100:103]
    v_mfma_f32_16x16x32_bf16 v[104:107], v[24:27], a[40:43], v[104:107]
    v_mfma_f32_16x16x32_bf16 v[108:111], v[24:27], a[44:47], v[108:111]
    s_add_u32 m0, m0, 4096
    ds_read_b64_tr_b16 v[24:25], v4 offset:12288
    v_mfma_f32_16x16x32_bf16 v[112:115], v[28:31], a[32:35], v[112:115]
    global_load_lds_dwordx4 v[10:11], off
    ds_read_b64_tr_b16 v[26:27], v4 offset:12800
    v_lshl_add_u64 v[10:11], v[10:11], 0, s[100:101]
    v_mfma_f32_16x16x32_bf16 v[116:119], v[28:31], a[36:39], v[116:119]
    v_mfma_f32_16x16x32_bf16 v[120:123], v[28:31], a[40:43], v[120:123]
    v_mfma_f32_16x16x32_bf16 v[124:127], v[28:31], a[44:47], v[124:127]
    s_waitcnt lgkmcnt(2)
    ds_read_b64_tr_b16 v[28:29], v5 offset:12288
    v_mfma_f32_16x16x32_bf16 v[64:67], v[16:19], a[48:51], v[64:67]
    ds_read_b64_tr_b16 v[30:31], v5 offset:12800
    v_mfma_f32_16x16x32_bf16 v[68:71], v[16:19], a[52:55], v[68:71]
    s_add_u32 m0, m0, 4096
    v_mfma_f32_16x16x32_bf16 v[72:75], v[16:19], a[56:59], v[72:75]
    global_load_lds_dwordx4 v[10:11], off
    v_lshl_add_u64 v[10:11], v[10:11], 0, s[100:101]
    v_mfma_f32_16x16x32_bf16 v[76:79], v[16:19], a[60:63], v[76:79]
    ds_read_b64_tr_b16 v[16:17], v2 offset:16384
    v_mfma_f32_16x16x32_bf16 v[80:83], v[20:23], a[48:51], v[80:83]
    ds_read_b64_tr_b16 v[18:19], v2 offset:16896
    v_mfma_f32_16x16x32_bf16 v[84:87], v[20:23], a[52:55], v[84:87]
    v_mfma_f32_16x16x32_bf16 v[88:91], v[20:23], a[56:59], v[88:91]
    s_add_u32 m0, m0, 4096
    v_mfma_f32_16x16x32_bf16 v[92:95], v[20:23], a[60:63], v[92:95]
    s_waitcnt lgkmcnt(2)
    global_load_lds_dwordx4 v[10:11], off
    ds_read_b64_tr_b16 v[20:21], v3 offset:16384
    v_lshl_add_u64 v[10:11], v[10:11], 0, s[100:101]
    v_mfma_f32_16x16x32_bf16 v[96:99], v[24:27], a[48:51], v[96:99]
    ds_read_b64_tr_b16 v[22:23], v3 offset:16896
    v_mfma_f32_16x16x32_bf16 v[100:103], v[24:27], a[52:55], v[100:103]
    v_mfma_f32_16x16x32_bf16 v[104:107], v[24:27], a[56:59], v[104:107]
    v_mfma_f32_16x16x32_bf16 v[108:111], v[24:27], a[60:63], v[108:111]
    s_add_u32 m0, m0, 4096
    ds_read_b64_tr_b16 v[24:25], v4 offset:16384
    v_mfma_f32_16x16x32_bf16 v[112:115], v[28:31], a[48:51], v[112:115]
    global_load_lds_dwordx4 v[10:11], off
    ds_read_b64_tr_b16 v[26:27], v4 offset:16896
    v_lshl_add_u64 v[10:11], v[10:11], 0, s[100:101]
    v_mfma_f32_16x16x32_bf16 v[116:119], v[28:31], a[52:55], v[116:119]
    v_mfma_f32_16x16x32_bf16 v[120:123], v[28:31], a[56:59], v[120:123]
    v_mfma_f32_16x16x32_bf16 v[124:127], v[28:31], a[60:63], v[124:127]
    s_waitcnt lgkmcnt(2)
    ds_read_b64_tr_b16 v[28:29], v5 offset:16384
    v_mfma_f32_16x16x32_bf16 v[64:67], v[16:19], a[64:67], v[64:67]
    ds_read_b64_tr_b16 v[30:31], v5 offset:16896
    v_mfma_f32_16x16x32_bf16 v[68:71], v[16:19], a[68:71], v[68:71]
    s_add_u32 m0, m0, 4096
    v_mfma_f32_16x16x32_bf16 v[72:75], v[16:19], a[72:75], v[72:75]
    global_load_lds_dwordx4 v[10:11], off
    v_lshl_add_u64 v[10:11], v[10:11], 0, s[100:101]
    v_mfma_f32_16x16x32_bf16 v[76:79], v[16:19], a[76:79], v[76:79]
    ds_read_b64_tr_b16 v[16:17], v2 offset:20480
    v_mfma_f32_16x16x32_bf16 v[80:83], v[20:23], a[64:67], v[80:83]
    ds_read_b64_tr_b16 v[18:19], v2 offset:20992
    v_mfma_f32_16x16x32_bf16 v[84:87], v[20:23], a[68:71], v[84:87]
    v_mfma_f32_16x16x32_bf16 v[88:91], v[20:23], a[72:75], v[88:91]
    s_add_u32 m0, m0, 4096
    v_mfma_f32_16x16x32_bf16 v[92:95], v[20:23], a[76:79], v[92:95]
    s_waitcnt lgkmcnt(2)
    global_load_lds_dwordx4 v[10:11], off
    ds_read_b64_tr_b16 v[20:21], v3 offset:20480
    v_lshl_add_u64 v[10:11], v[10:11], 0, s[100:101]
    v_mfma_f32_16x16x32_bf16 v[96:99], v[24:27], a[64:67], v[96:99]
    ds_read_b64_tr_b16 v[22:23], v3 offset:20992
    v_mfma_f32_16x16x32_bf16 v[100:103], v[24:27], a[68:71], v[100:103]
    v_mfma_f32_16x16x32_bf16 v[104:107], v[24:27], a[72:75], v[104:107]
    v_mfma_f32_16x16x32_bf16 v[108:111], v[24:27], a[76:79], v[108:111]
    s_add_u32 m0, m0, 4096
    ds_read_b64_tr_b16 v[24:25], v4 offset:20480
    v_mfma_f32_16x16x32_bf16 v[112:115], v[28:31], a[64:67], v[112:115]
    global_load_lds_dwordx4 v[10:11], off
    ds_read_b64_tr_b16 v[26:27], v4 offset:20992
    v_lshl_add_u64 v[10:11], v[10:11], 0, s[100:101]
    v_mfma_f32_16x16x32_bf16 v[116:119], v[28:31], a[68:71], v[116:119]
    v_mfma_f32_16x16x32_bf16 v[120:123], v[28:31], a[72:75], v[120:123]
    v_mfma_f32_16x16x32_bf16 v[124:127], v[28:31], a[76:79], v[124:127]
    s_waitcnt lgkmcnt(2)
    ds_read_b64_tr_b16 v[28:29], v5 offset:20480
    v_mfma_f32_16x16x32_bf16 v[64:67], v[16:19], a[80:83], v[64:67]
    ds_read_b64_tr_b16 v[30:31], v5 offset:20992
    v_lshlrev_b32 v224, 16, v32
    v_mfma_f32_16x16x32_bf16 v[68:71], v[16:19], a[84:87], v[68:71]
    s_add_u32 m0, m0, 4096
    v_and_b32 v225, s41, v32
    v_mfma_f32_16x16x32_bf16 v[72:75], v[16:19], a[88:91], v[72:75]
    global_load_lds_dwordx4 v[10:11], off
    v_lshl_add_u64 v[10:11], v[10:11], 0, s[100:101]
    v_mfma_f32_16x16x32_bf16 v[76:79], v[16:19], a[92:95], v[76:79]
    ds_read_b64_tr_b16 v[16:17], v2 offset:24576
    v_lshlrev_b32 v226, 16, v33
    v_mfma_f32_16x16x32_bf16 v[80:83], v[20:23], a[80:83], v[80:83]
    ds_read_b64_tr_b16 v[18:19], v2 offset:25088
    v_and_b32 v227, s41, v33
    v_mfma_f32_16x16x32_bf16 v[84:87], v[20:23], a[84:87], v[84:87]
    v_lshlrev_b32 v228, 16, v40
    v_and_b32 v229, s41, v40
    v_mfma_f32_16x16x32_bf16 v[88:91], v[20:23], a[88:91], v[88:91]
    s_add_u32 m0, m0, 4096
    v_lshlrev_b32 v230, 16, v41
    v_mfma_f32_16x16x32_bf16 v[92:95], v[20:23], a[92:95], v[92:95]
    s_waitcnt lgkmcnt(2)
    global_load_lds_dwordx4 v[10:11], off
    ds_read_b64_tr_b16 v[20:21], v3 offset:24576
    v_lshl_add_u64 v[10:11], v[10:11], 0, s[100:101]
    v_mfma_f32_16x16x32_bf16 v[96:99], v[24:27], a[80:83], v[96:99]
    ds_read_b64_tr_b16 v[22:23], v3 offset:25088
    v_and_b32 v231, s41, v41
    v_mfma_f32_16x16x32_bf16 v[100:103], v[24:27], a[84:87], v[100:103]
    v_mul_f32 v224, v224, v128
    v_mfma_f32_16x16x32_bf16 v[104:107], v[24:27], a[88:91], v[104:107]
    v_mul_f32 v225, v225, v129
    v_mfma_f32_16x16x32_bf16 v[108:111], v[24:27], a[92:95], v[108:111]
    s_add_u32 m0, m0, 4096
    ds_read_b64_tr_b16 v[24:25], v4 offset:24576
    v_mfma_f32_16x16x32_bf16 v[112:115], v[28:31], a[80:83], v[112:115]
    global_load_lds_dwordx4 v[10:11], off
    ds_read_b64_tr_b16 v[26:27], v4 offset:25088
    v_lshl_add_u64 v[10:11], v[10:11], 0, s[100:101]
    v_mfma_f32_16x16x32_bf16 v[116:119], v[28:31], a[84:87], v[116:119]
    v_mul_f32 v226, v226, v130
    v_mul_f32 v227, v227, v131
    v_mfma_f32_16x16x32_bf16 v[120:123], v[28:31], a[88:91], v[120:123]
    v_mul_f32 v228, v228, v144
    v_mul_f32 v229, v229, v145
    v_mfma_f32_16x16x32_bf16 v[124:127], v[28:31], a[92:95], v[124:127]
    s_waitcnt lgkmcnt(2)
    ds_read_b64_tr_b16 v[28:29], v5 offset:24576
    v_mfma_f32_16x16x32_bf16 v[64:67], v[16:19], a[96:99], v[64:67]
    ds_read_b64_tr_b16 v[30:31], v5 offset:25088
    v_mul_f32 v230, v230, v146
    v_mfma_f32_16x16x32_bf16 v[68:71], v[16:19], a[100:103], v[68:71]
    v_mul_f32 v231, v231, v147
    v_mfma_f32_16x16x32_bf16 v[72:75], v[16:19], a[104:107], v[72:75]
    v_cvt_pk_bf16_f32 v224, v224, v225
    v_mfma_f32_16x16x32_bf16 v[76:79], v[16:19], a[108:111], v[76:79]
    ds_read_b64_tr_b16 v[16:17], v2 offset:28672
    v_cvt_pk_bf16_f32 v225, v226, v227
    v_mfma_f32_16x16x32_bf16 v[80:83], v[20:23], a[96:99], v[80:83]
    ds_read_b64_tr_b16 v[18:19], v2 offset:29184
    v_cvt_pk_bf16_f32 v226, v228, v229
    v_mfma_f32_16x16x32_bf16 v[84:87], v[20:23], a[100:103], v[84:87]
    buffer_load_dword v12, v15, s[84:87], s28 offen
    v_cvt_pk_bf16_f32 v227, v230, v231
    v_mfma_f32_16x16x32_bf16 v[88:91], v[20:23], a[104:107], v[88:91]
    v_lshlrev_b32 v232, 16, v34
    v_mfma_f32_16x16x32_bf16 v[92:95], v[20:23], a[108:111], v[92:95]
    s_waitcnt lgkmcnt(2)
    ds_read_b64_tr_b16 v[20:21], v3 offset:28672
    v_mfma_f32_16x16x32_bf16 v[96:99], v[24:27], a[96:99], v[96:99]
    ds_read_b64_tr_b16 v[22:23], v3 offset:29184
    v_and_b32 v233, s41, v34
    v_mfma_f32_16x16x32_bf16 v[100:103], v[24:27], a[100:103], v[100:103]
    s_add_u32 s28, s28, 4608
    v_lshlrev_b32 v234, 16, v35
    v_mfma_f32_16x16x32_bf16 v[104:107], v[24:27], a[104:107], v[104:107]
    v_and_b32 v235, s41, v35
    v_mfma_f32_16x16x32_bf16 v[108:111], v[24:27], a[108:111], v[108:111]
    ds_read_b64_tr_b16 v[24:25], v4 offset:28672
    v_lshlrev_b32 v236, 16, v42
    v_mfma_f32_16x16x32_bf16 v[112:115], v[28:31], a[96:99], v[112:115]
    ds_read_b64_tr_b16 v[26:27], v4 offset:29184
    v_and_b32 v237, s41, v42
    v_mfma_f32_16x16x32_bf16 v[116:119], v[28:31], a[100:103], v[116:119]
    v_lshlrev_b32 v238, 16, v43
    v_mfma_f32_16x16x32_bf16 v[120:123], v[28:31], a[104:107], v[120:123]
    v_and_b32 v239, s41, v43
    v_mfma_f32_16x16x32_bf16 v[124:127], v[28:31], a[108:111], v[124:127]
    s_waitcnt lgkmcnt(2)
    ds_read_b64_tr_b16 v[28:29], v5 offset:28672
    v_mfma_f32_16x16x32_bf16 v[64:67], v[16:19], a[112:115], v[64:67]
    ds_read_b64_tr_b16 v[30:31], v5 offset:29184
    v_mul_f32 v232, v232, v132
    v_mfma_f32_16x16x32_bf16 v[68:71], v[16:19], a[116:119], v[68:71]
    v_mul_f32 v233, v233, v133
    v_mfma_f32_16x16x32_bf16 v[72:75], v[16:19], a[120:123], v[72:75]
    v_mul_f32 v234, v234, v134
    v_mfma_f32_16x16x32_bf16 v[76:79], v[16:19], a[124:127], v[76:79]
    ds_read_b64_tr_b16 v[16:17], v2 offset:32768
    v_mul_f32 v235, v235, v135
    v_mfma_f32_16x16x32_bf16 v[80:83], v[20:23], a[112:115], v[80:83]
    ds_read_b64_tr_b16 v[18:19], v2 offset:33280
    v_mul_f32 v236, v236, v148
    v_mfma_f32_16x16x32_bf16 v[84:87], v[20:23], a[116:119], v[84:87]
    v_mul_f32 v237, v237, v149
    v_mfma_f32_16x16x32_bf16 v[88:91], v[20:23], a[120:123], v[88:91]
    v_mfma_f32_16x16x32_bf16 v[92:95], v[20:23], a[124:127], v[92:95]
    s_waitcnt lgkmcnt(2)
    ds_read_b64_tr_b16 v[20:21], v3 offset:32768
    v_mfma_f32_16x16x32_bf16 v[96:99], v[24:27], a[112:115], v[96:99]
    ds_read_b64_tr_b16 v[22:23], v3 offset:33280
    v_mul_f32 v238, v238, v150
    v_mfma_f32_16x16x32_bf16 v[100:103], v[24:27], a[116:119], v[100:103]
    buffer_store_dwordx4 v[224:227], v14, s[20:23], s44 offen offset:0 sc1
    v_mfma_f32_16x16x32_bf16 v[104:107], v[24:27], a[120:123], v[104:107]
    v_mul_f32 v239, v239, v151
    v_mfma_f32_16x16x32_bf16 v[108:111], v[24:27], a[124:127], v[108:111]
    ds_read_b64_tr_b16 v[24:25], v4 offset:32768
    v_cvt_pk_bf16_f32 v232, v232, v233
    v_mfma_f32_16x16x32_bf16 v[112:115], v[28:31], a[112:115], v[112:115]
    ds_read_b64_tr_b16 v[26:27], v4 offset:33280
    v_cvt_pk_bf16_f32 v233, v234, v235
    v_mfma_f32_16x16x32_bf16 v[116:119], v[28:31], a[116:119], v[116:119]
    v_cvt_pk_bf16_f32 v234, v236, v237
    v_mfma_f32_16x16x32_bf16 v[120:123], v[28:31], a[120:123], v[120:123]
    v_mfma_f32_16x16x32_bf16 v[124:127], v[28:31], a[124:127], v[124:127]
    s_waitcnt lgkmcnt(2)
    ds_read_b64_tr_b16 v[28:29], v5 offset:32768
    v_mfma_f32_16x16x32_bf16 v[64:67], v[16:19], a[128:131], v[64:67]
    ds_read_b64_tr_b16 v[30:31], v5 offset:33280
    v_cvt_pk_bf16_f32 v235, v238, v239
    v_mfma_f32_16x16x32_bf16 v[68:71], v[16:19], a[132:135], v[68:71]
    v_lshlrev_b32 v224, 16, v36
    v_add_u32 v2, 36864, v2
    v_mfma_f32_16x16x32_bf16 v[72:75], v[16:19], a[136:139], v[72:75]
    buffer_store_dwordx4 v[232:235], v14, s[20:23], s45 offen offset:0 sc1
    v_mfma_f32_16x16x32_bf16 v[76:79], v[16:19], a[140:143], v[76:79]
    ds_read_b64_tr_b16 v[16:17], v2 offset:0
    v_and_b32 v225, s41, v36
    v_mfma_f32_16x16x32_bf16 v[80:83], v[20:23], a[128:131], v[80:83]
    ds_read_b64_tr_b16 v[18:19], v2 offset:512
    v_lshlrev_b32 v226, 16, v37
    v_mfma_f32_16x16x32_bf16 v[84:87], v[20:23], a[132:135], v[84:87]
    v_and_b32 v227, s41, v37
    v_add_u32 v3, 36864, v3
    v_mfma_f32_16x16x32_bf16 v[88:91], v[20:23], a[136:139], v[88:91]
    v_mfma_f32_16x16x32_bf16 v[92:95], v[20:23], a[140:143], v[92:95]
    s_waitcnt lgkmcnt(2)
    ds_read_b64_tr_b16 v[20:21], v3 offset:0
    v_mfma_f32_16x16x32_bf16 v[96:99], v[24:27], a[128:131], v[96:99]
    ds_read_b64_tr_b16 v[22:23], v3 offset:512
    v_lshlrev_b32 v228, 16, v44
    v_mfma_f32_16x16x32_bf16 v[100:103], v[24:27], a[132:135], v[100:103]
    v_and_b32 v229, s41, v44
    v_add_u32 v4, 36864, v4
    v_mfma_f32_16x16x32_bf16 v[104:107], v[24:27], a[136:139], v[104:107]
    v_lshlrev_b32 v230, 16, v45
    v_and_b32 v231, s41, v45
    v_mfma_f32_16x16x32_bf16 v[108:111], v[24:27], a[140:143], v[108:111]
    ds_read_b64_tr_b16 v[24:25], v4 offset:0
    v_mul_f32 v224, v224, v136
    v_mfma_f32_16x16x32_bf16 v[112:115], v[28:31], a[128:131], v[112:115]
    ds_read_b64_tr_b16 v[26:27], v4 offset:512
    v_mul_f32 v225, v225, v137
    v_mfma_f32_16x16x32_bf16 v[116:119], v[28:31], a[132:135], v[116:119]
    v_mul_f32 v226, v226, v138
    v_add_u32 v5, 36864, v5
    v_mfma_f32_16x16x32_bf16 v[120:123], v[28:31], a[136:139], v[120:123]
    v_lshlrev_b32 v251, 4, v0
    v_mfma_f32_16x16x32_bf16 v[124:127], v[28:31], a[140:143], v[124:127]
    s_waitcnt lgkmcnt(2)
    ds_read_b64_tr_b16 v[28:29], v5 offset:0
    v_lshrrev_b32 v1, 3, v0
    v_mfma_f32_16x16x32_bf16 v[64:67], v[16:19], a[144:147], v[64:67]
    ds_read_b64_tr_b16 v[30:31], v5 offset:512
    v_mul_f32 v227, v227, v139
    v_mfma_f32_16x16x32_bf16 v[68:71], v[16:19], a[148:151], v[68:71]
    v_mul_f32 v228, v228, v152
    v_mul_f32 v229, v229, v153
    v_mfma_f32_16x16x32_bf16 v[72:75], v[16:19], a[152:155], v[72:75]
    v_mul_f32 v230, v230, v154
    v_mfma_f32_16x16x32_bf16 v[76:79], v[16:19], a[156:159], v[76:79]
    ds_read_b64_tr_b16 v[16:17], v2 offset:4096
    v_mul_f32 v231, v231, v155
    v_mfma_f32_16x16x32_bf16 v[80:83], v[20:23], a[144:147], v[80:83]
    ds_read_b64_tr_b16 v[18:19], v2 offset:4608
    v_cvt_pk_bf16_f32 v224, v224, v225
    v_mfma_f32_16x16x32_bf16 v[84:87], v[20:23], a[148:151], v[84:87]
    s_lshl_b32 s92, s33, 3
    v_mfma_f32_16x16x32_bf16 v[88:91], v[20:23], a[152:155], v[88:91]
    v_cvt_pk_bf16_f32 v225, v226, v227
    v_add_u32 v1, s92, v1
    v_mfma_f32_16x16x32_bf16 v[92:95], v[20:23], a[156:159], v[92:95]
    s_waitcnt lgkmcnt(2)
    ds_read_b64_tr_b16 v[20:21], v3 offset:4096
    v_mfma_f32_16x16x32_bf16 v[96:99], v[24:27], a[144:147], v[96:99]
    ds_read_b64_tr_b16 v[22:23], v3 offset:4608
    v_cvt_pk_bf16_f32 v226, v228, v229
    v_mfma_f32_16x16x32_bf16 v[100:103], v[24:27], a[148:151], v[100:103]
    v_cvt_pk_bf16_f32 v227, v230, v231
    v_lshlrev_b32 v232, 16, v38
    v_mfma_f32_16x16x32_bf16 v[104:107], v[24:27], a[152:155], v[104:107]
    v_and_b32 v233, s41, v38
    v_bfe_u32 v255, v1, 2, 2
    v_mfma_f32_16x16x32_bf16 v[108:111], v[24:27], a[156:159], v[108:111]
    ds_read_b64_tr_b16 v[24:25], v4 offset:4096
    v_lshlrev_b32 v234, 16, v39
    v_mfma_f32_16x16x32_bf16 v[112:115], v[28:31], a[144:147], v[112:115]
    ds_read_b64_tr_b16 v[26:27], v4 offset:4608
    v_and_b32 v235, s41, v39
    v_mfma_f32_16x16x32_bf16 v[116:119], v[28:31], a[148:151], v[116:119]
    v_lshlrev_b32 v255, 3, v255
    v_mfma_f32_16x16x32_bf16 v[120:123], v[28:31], a[152:155], v[120:123]
    v_lshlrev_b32 v236, 16, v46
    v_mfma_f32_16x16x32_bf16 v[124:127], v[28:31], a[156:159], v[124:127]
    s_waitcnt lgkmcnt(2)
    ds_read_b64_tr_b16 v[28:29], v5 offset:4096
    v_mfma_f32_16x16x32_bf16 v[64:67], v[16:19], a[160:163], v[64:67]
    ds_read_b64_tr_b16 v[30:31], v5 offset:4608
    v_and_b32 v237, s41, v46
    v_mfma_f32_16x16x32_bf16 v[68:71], v[16:19], a[164:167], v[68:71]
    buffer_store_dwordx4 v[224:227], v14, s[20:23], s46 offen offset:0 sc1
    v_mfma_f32_16x16x32_bf16 v[72:75], v[16:19], a[168:171], v[72:75]
    v_lshlrev_b32 v238, 16, v47
    v_lshrrev_b32 v253, 4, v1
    v_mfma_f32_16x16x32_bf16 v[76:79], v[16:19], a[172:175], v[76:79]
    ds_read_b64_tr_b16 v[16:17], v2 offset:8192
    v_and_b32 v239, s41, v47
    v_mfma_f32_16x16x32_bf16 v[80:83], v[20:23], a[160:163], v[80:83]
    ds_read_b64_tr_b16 v[18:19], v2 offset:8704
    v_mul_f32 v232, v232, v140
    v_mfma_f32_16x16x32_bf16 v[84:87], v[20:23], a[164:167], v[84:87]
    v_lshl_add_u32 v255, v253, 2, v255
    v_mfma_f32_16x16x32_bf16 v[88:91], v[20:23], a[168:171], v[88:91]
    v_mul_f32 v233, v233, v141
    v_mfma_f32_16x16x32_bf16 v[92:95], v[20:23], a[172:175], v[92:95]
    s_waitcnt lgkmcnt(2)
    ds_read_b64_tr_b16 v[20:21], v3 offset:8192
    v_and_b32 v253, 3, v1
    v_mfma_f32_16x16x32_bf16 v[96:99], v[24:27], a[160:163], v[96:99]
    ds_read_b64_tr_b16 v[22:23], v3 offset:8704
    v_mul_f32 v234, v234, v142
    v_mfma_f32_16x16x32_bf16 v[100:103], v[24:27], a[164:167], v[100:103]
    v_mul_f32 v235, v235, v143
    v_mul_f32 v236, v236, v156
    v_mfma_f32_16x16x32_bf16 v[104:107], v[24:27], a[168:171], v[104:107]
    v_mul_f32 v237, v237, v157
    v_mfma_f32_16x16x32_bf16 v[108:111], v[24:27], a[172:175], v[108:111]
    ds_read_b64_tr_b16 v[24:25], v4 offset:8192
    v_mul_f32 v238, v238, v158
    v_mfma_f32_16x16x32_bf16 v[112:115], v[28:31], a[160:163], v[112:115]
    ds_read_b64_tr_b16 v[26:27], v4 offset:8704
    v_mul_f32 v239, v239, v159
    v_mfma_f32_16x16x32_bf16 v[116:119], v[28:31], a[164:167], v[116:119]
    v_add_u32 v255, v255, v253
    v_mfma_f32_16x16x32_bf16 v[120:123], v[28:31], a[168:171], v[120:123]
    s_cmp_eq_u32 s68, 0
    v_cvt_pk_bf16_f32 v232, v232, v233
    v_mfma_f32_16x16x32_bf16 v[124:127], v[28:31], a[172:175], v[124:127]
    s_waitcnt lgkmcnt(2)
    ds_read_b64_tr_b16 v[28:29], v5 offset:8192
    v_mfma_f32_16x16x32_bf16 v[64:67], v[16:19], a[176:179], v[64:67]
    ds_read_b64_tr_b16 v[30:31], v5 offset:8704
    v_cvt_pk_bf16_f32 v233, v234, v235
    v_mfma_f32_16x16x32_bf16 v[68:71], v[16:19], a[180:183], v[68:71]
    v_cvt_pk_bf16_f32 v234, v236, v237
    v_cvt_pk_bf16_f32 v235, v238, v239
    v_mfma_f32_16x16x32_bf16 v[72:75], v[16:19], a[184:187], v[72:75]
    s_cselect_b64 s[92:93], -1, 0
    v_lshlrev_b32 v224, 16, v48
    v_mfma_f32_16x16x32_bf16 v[76:79], v[16:19], a[188:191], v[76:79]
    ds_read_b64_tr_b16 v[16:17], v2 offset:12288
    v_and_b32 v225, s41, v48
    v_mfma_f32_16x16x32_bf16 v[80:83], v[20:23], a[176:179], v[80:83]
    ds_read_b64_tr_b16 v[18:19], v2 offset:12800
    v_cndmask_b32 v1, v255, v1, s[92:93]
    v_mfma_f32_16x16x32_bf16 v[84:87], v[20:23], a[180:183], v[84:87]
    v_lshlrev_b32 v226, 16, v49
    v_mfma_f32_16x16x32_bf16 v[88:91], v[20:23], a[184:187], v[88:91]
    v_and_b32 v227, s41, v49
    v_mfma_f32_16x16x32_bf16 v[92:95], v[20:23], a[188:191], v[92:95]
    s_waitcnt lgkmcnt(2)
    ds_read_b64_tr_b16 v[20:21], v3 offset:12288
    v_mfma_f32_16x16x32_bf16 v[96:99], v[24:27], a[176:179], v[96:99]
    ds_read_b64_tr_b16 v[22:23], v3 offset:12800
    v_lshlrev_b32 v228, 16, v56
    v_mfma_f32_16x16x32_bf16 v[100:103], v[24:27], a[180:183], v[100:103]
    buffer_store_dwordx4 v[232:235], v14, s[20:23], s47 offen offset:0 sc1
    v_mfma_f32_16x16x32_bf16 v[104:107], v[24:27], a[184:187], v[104:107]
    v_and_b32 v229, s41, v56
    v_mul_u32_u24 v1, 1152, v1
    v_mfma_f32_16x16x32_bf16 v[108:111], v[24:27], a[188:191], v[108:111]
    ds_read_b64_tr_b16 v[24:25], v4 offset:12288
    v_lshlrev_b32 v230, 16, v57
    v_mfma_f32_16x16x32_bf16 v[112:115], v[28:31], a[176:179], v[112:115]
    ds_read_b64_tr_b16 v[26:27], v4 offset:12800
    v_bfe_u32 v255, v0, 1, 2
    v_mfma_f32_16x16x32_bf16 v[116:119], v[28:31], a[180:183], v[116:119]
    v_and_b32 v231, s41, v57
    v_mfma_f32_16x16x32_bf16 v[120:123], v[28:31], a[184:187], v[120:123]
    v_mul_f32 v224, v224, v160
    v_mfma_f32_16x16x32_bf16 v[124:127], v[28:31], a[188:191], v[124:127]
    s_waitcnt lgkmcnt(2)
    ds_read_b64_tr_b16 v[28:29], v5 offset:12288
    v_lshrrev_b32 v253, 4, v0
    v_mfma_f32_16x16x32_bf16 v[64:67], v[16:19], a[192:195], v[64:67]
    ds_read_b64_tr_b16 v[30:31], v5 offset:12800
    v_mul_f32 v225, v225, v161
    v_mfma_f32_16x16x32_bf16 v[68:71], v[16:19], a[196:199], v[68:71]
    v_mul_f32 v226, v226, v162
    v_mul_f32 v227, v227, v163
    v_mfma_f32_16x16x32_bf16 v[72:75], v[16:19], a[200:203], v[72:75]
    v_mul_f32 v228, v228, v176
    v_xor_b32 v255, v255, v253
    v_mfma_f32_16x16x32_bf16 v[76:79], v[16:19], a[204:207], v[76:79]
    ds_read_b64_tr_b16 v[16:17], v2 offset:16384
    v_mul_f32 v229, v229, v177
    v_mfma_f32_16x16x32_bf16 v[80:83], v[20:23], a[192:195], v[80:83]
    ds_read_b64_tr_b16 v[18:19], v2 offset:16896
    v_mfma_f32_16x16x32_bf16 v[84:87], v[20:23], a[196:199], v[84:87]
    v_mul_f32 v230, v230, v178
    v_mfma_f32_16x16x32_bf16 v[88:91], v[20:23], a[200:203], v[88:91]
    v_mul_f32 v231, v231, v179
    v_lshl_add_u32 v1, v255, 5, v1
    v_mfma_f32_16x16x32_bf16 v[92:95], v[20:23], a[204:207], v[92:95]
    s_waitcnt lgkmcnt(2)
    ds_read_b64_tr_b16 v[20:21], v3 offset:16384
    v_mfma_f32_16x16x32_bf16 v[96:99], v[24:27], a[192:195], v[96:99]
    ds_read_b64_tr_b16 v[22:23], v3 offset:16896
    v_cvt_pk_bf16_f32 v224, v224, v225
    v_mfma_f32_16x16x32_bf16 v[100:103], v[24:27], a[196:199], v[100:103]
    v_cvt_pk_bf16_f32 v225, v226, v227
    v_cvt_pk_bf16_f32 v226, v228, v229
    v_mfma_f32_16x16x32_bf16 v[104:107], v[24:27], a[200:203], v[104:107]
    v_cvt_pk_bf16_f32 v227, v230, v231
    v_and_b32 v255, 1, v0
    v_mfma_f32_16x16x32_bf16 v[108:111], v[24:27], a[204:207], v[108:111]
    ds_read_b64_tr_b16 v[24:25], v4 offset:16384
    v_lshlrev_b32 v232, 16, v50
    v_mfma_f32_16x16x32_bf16 v[112:115], v[28:31], a[192:195], v[112:115]
    ds_read_b64_tr_b16 v[26:27], v4 offset:16896
    v_lshl_add_u32 v1, v255, 4, v1
    v_mfma_f32_16x16x32_bf16 v[116:119], v[28:31], a[196:199], v[116:119]
    v_and_b32 v233, s41, v50
    v_mfma_f32_16x16x32_bf16 v[120:123], v[28:31], a[200:203], v[120:123]
    v_lshlrev_b32 v234, 16, v51
    v_mfma_f32_16x16x32_bf16 v[124:127], v[28:31], a[204:207], v[124:127]
    s_waitcnt lgkmcnt(2)
    ds_read_b64_tr_b16 v[28:29], v5 offset:16384
    v_mfma_f32_16x16x32_bf16 v[64:67], v[16:19], a[208:211], v[64:67]
    ds_read_b64_tr_b16 v[30:31], v5 offset:16896
    v_and_b32 v235, s41, v51
    v_mfma_f32_16x16x32_bf16 v[68:71], v[16:19], a[212:215], v[68:71]
    buffer_store_dwordx4 v[224:227], v14, s[20:23], s44 offen offset:1024 sc1
    v_mfma_f32_16x16x32_bf16 v[72:75], v[16:19], a[216:219], v[72:75]
    v_lshlrev_b32 v236, 16, v58
    v_add_u32 v246, 2048, v1
    v_mfma_f32_16x16x32_bf16 v[76:79], v[16:19], a[220:223], v[76:79]
    ds_read_b64_tr_b16 v[16:17], v2 offset:20480
    v_and_b32 v237, s41, v58
    v_mfma_f32_16x16x32_bf16 v[80:83], v[20:23], a[208:211], v[80:83]
    ds_read_b64_tr_b16 v[18:19], v2 offset:20992
    v_add_u32 v247, 1152, v1
    v_mfma_f32_16x16x32_bf16 v[84:87], v[20:23], a[212:215], v[84:87]
    v_lshlrev_b32 v238, 16, v59
    v_mfma_f32_16x16x32_bf16 v[88:91], v[20:23], a[216:219], v[88:91]
    v_and_b32 v239, s41, v59
    v_mfma_f32_16x16x32_bf16 v[92:95], v[20:23], a[220:223], v[92:95]
    s_waitcnt lgkmcnt(2)
    ds_read_b64_tr_b16 v[20:21], v3 offset:20480
    v_add_u32 v248, 256, v1
    v_mfma_f32_16x16x32_bf16 v[96:99], v[24:27], a[208:211], v[96:99]
    ds_read_b64_tr_b16 v[22:23], v3 offset:20992
    v_mul_f32 v232, v232, v164
    v_mfma_f32_16x16x32_bf16 v[100:103], v[24:27], a[212:215], v[100:103]
    v_mul_f32 v233, v233, v165
    v_mul_f32 v234, v234, v166
    v_mfma_f32_16x16x32_bf16 v[104:107], v[24:27], a[216:219], v[104:107]
    s_lshl_b32 s92, s57, 3
    v_mul_f32 v235, v235, v167
    v_mfma_f32_16x16x32_bf16 v[108:111], v[24:27], a[220:223], v[108:111]
    ds_read_b64_tr_b16 v[24:25], v4 offset:20480
    v_mfma_f32_16x16x32_bf16 v[112:115], v[28:31], a[208:211], v[112:115]
    ds_read_b64_tr_b16 v[26:27], v4 offset:20992
    v_mul_f32 v236, v236, v180
    v_mfma_f32_16x16x32_bf16 v[116:119], v[28:31], a[212:215], v[116:119]
    s_lshl_b32 s93, s33, 1
    v_mul_f32 v237, v237, v181
    v_mfma_f32_16x16x32_bf16 v[120:123], v[28:31], a[216:219], v[120:123]
    v_mul_f32 v238, v238, v182
    v_mfma_f32_16x16x32_bf16 v[124:127], v[28:31], a[220:223], v[124:127]
    s_waitcnt lgkmcnt(2)
    ds_read_b64_tr_b16 v[28:29], v5 offset:20480
    v_mfma_f32_16x16x32_bf16 v[64:67], v[16:19], a[224:227], v[64:67]
    ds_read_b64_tr_b16 v[30:31], v5 offset:20992
    v_mul_f32 v239, v239, v183
    v_mfma_f32_16x16x32_bf16 v[68:71], v[16:19], a[228:231], v[68:71]
    v_cvt_pk_bf16_f32 v232, v232, v233
    v_cvt_pk_bf16_f32 v233, v234, v235
    v_mfma_f32_16x16x32_bf16 v[72:75], v[16:19], a[232:235], v[72:75]
    s_add_u32 s92, s92, s93
    v_cvt_pk_bf16_f32 v234, v236, v237
    v_mfma_f32_16x16x32_bf16 v[76:79], v[16:19], a[236:239], v[76:79]
    ds_read_b64_tr_b16 v[16:17], v2 offset:24576
    v_mfma_f32_16x16x32_bf16 v[80:83], v[20:23], a[224:227], v[80:83]
    ds_read_b64_tr_b16 v[18:19], v2 offset:25088
    v_cvt_pk_bf16_f32 v235, v238, v239
    v_mfma_f32_16x16x32_bf16 v[84:87], v[20:23], a[228:231], v[84:87]
    s_mul_i32 s93, s92, s7
    v_lshlrev_b32 v224, 16, v52
    v_mfma_f32_16x16x32_bf16 v[88:91], v[20:23], a[232:235], v[88:91]
    v_and_b32 v225, s41, v52
    v_mfma_f32_16x16x32_bf16 v[92:95], v[20:23], a[236:239], v[92:95]
    s_waitcnt lgkmcnt(2)
    ds_read_b64_tr_b16 v[20:21], v3 offset:24576
    v_mfma_f32_16x16x32_bf16 v[96:99], v[24:27], a[224:227], v[96:99]
    ds_read_b64_tr_b16 v[22:23], v3 offset:25088
    v_lshlrev_b32 v226, 16, v53
    v_mfma_f32_16x16x32_bf16 v[100:103], v[24:27], a[228:231], v[100:103]
    buffer_store_dwordx4 v[232:235], v14, s[20:23], s45 offen offset:1024 sc1
    v_mfma_f32_16x16x32_bf16 v[104:107], v[24:27], a[232:235], v[104:107]
    v_and_b32 v227, s41, v53
    v_add_u32 v249, s93, v251
    v_mfma_f32_16x16x32_bf16 v[108:111], v[24:27], a[236:239], v[108:111]
    ds_read_b64_tr_b16 v[24:25], v4 offset:24576
    v_add_u32 v250, s7, v249
    v_mfma_f32_16x16x32_bf16 v[112:115], v[28:31], a[224:227], v[112:115]
    ds_read_b64_tr_b16 v[26:27], v4 offset:25088
    v_lshlrev_b32 v228, 16, v60
    v_mfma_f32_16x16x32_bf16 v[116:119], v[28:31], a[228:231], v[116:119]
    v_and_b32 v229, s41, v60
    v_mfma_f32_16x16x32_bf16 v[120:123], v[28:31], a[232:235], v[120:123]
    v_lshlrev_b32 v230, 16, v61
    v_mfma_f32_16x16x32_bf16 v[124:127], v[28:31], a[236:239], v[124:127]
    s_waitcnt lgkmcnt(2)
    ds_read_b64_tr_b16 v[28:29], v5 offset:24576
    v_and_b32 v1, 7, v0
    v_mfma_f32_16x16x32_bf16 v[64:67], v[16:19], a[240:243], v[64:67]
    ds_read_b64_tr_b16 v[30:31], v5 offset:25088
    v_and_b32 v231, s41, v61
    v_mfma_f32_16x16x32_bf16 v[68:71], v[16:19], a[244:247], v[68:71]
    v_mul_f32 v224, v224, v168
    v_mul_f32 v225, v225, v169
    v_mfma_f32_16x16x32_bf16 v[72:75], v[16:19], a[248:251], v[72:75]
    v_mul_f32 v226, v226, v170
    v_lshlrev_b32 v1, 1, v1
    v_mfma_f32_16x16x32_bf16 v[76:79], v[16:19], a[252:255], v[76:79]
    ds_read_b64_tr_b16 v[16:17], v2 offset:28672
    v_mfma_f32_16x16x32_bf16 v[80:83], v[20:23], a[240:243], v[80:83]
    ds_read_b64_tr_b16 v[18:19], v2 offset:29184
    v_mul_f32 v227, v227, v171
    v_mfma_f32_16x16x32_bf16 v[84:87], v[20:23], a[244:247], v[84:87]
    v_mul_f32 v228, v228, v184
    v_bfe_u32 v255, v0, 3, 1
    v_mfma_f32_16x16x32_bf16 v[88:91], v[20:23], a[248:251], v[88:91]
    v_mul_f32 v229, v229, v185
    v_mfma_f32_16x16x32_bf16 v[92:95], v[20:23], a[252:255], v[92:95]
    s_waitcnt lgkmcnt(2)
    ds_read_b64_tr_b16 v[20:21], v3 offset:28672
    v_mfma_f32_16x16x32_bf16 v[96:99], v[24:27], a[240:243], v[96:99]
    ds_read_b64_tr_b16 v[22:23], v3 offset:29184
    v_mul_f32 v230, v230, v186
    v_mfma_f32_16x16x32_bf16 v[100:103], v[24:27], a[244:247], v[100:103]
    v_mul_f32 v231, v231, v187
    v_lshlrev_b32 v232, 16, v54
    v_mfma_f32_16x16x32_bf16 v[104:107], v[24:27], a[248:251], v[104:107]
    s_lshl_b32 s92, s92, 4
    v_mfma_f32_16x16x32_bf16 v[108:111], v[24:27], a[252:255], v[108:111]
    ds_read_b64_tr_b16 v[24:25], v4 offset:28672
    v_cvt_pk_bf16_f32 v224, v224, v225
    v_mfma_f32_16x16x32_bf16 v[112:115], v[28:31], a[240:243], v[112:115]
    ds_read_b64_tr_b16 v[26:27], v4 offset:29184
    v_cvt_pk_bf16_f32 v225, v226, v227
    v_mfma_f32_16x16x32_bf16 v[116:119], v[28:31], a[244:247], v[116:119]
    v_cvt_pk_bf16_f32 v226, v228, v229
    v_add3_u32 v1, v1, v255, s92
    v_mfma_f32_16x16x32_bf16 v[120:123], v[28:31], a[248:251], v[120:123]
    v_cvt_pk_bf16_f32 v227, v230, v231
    v_mfma_f32_16x16x32_bf16 v[124:127], v[28:31], a[252:255], v[124:127]
    s_waitcnt lgkmcnt(2)
    ds_read_b64_tr_b16 v[28:29], v5 offset:28672
    v_mfma_f32_16x16x32_bf16 v[64:67], v[16:19], v[192:195], v[64:67]
    ds_read_b64_tr_b16 v[30:31], v5 offset:29184
    v_and_b32 v233, s41, v54
    v_mfma_f32_16x16x32_bf16 v[68:71], v[16:19], v[196:199], v[68:71]
    buffer_store_dwordx4 v[224:227], v14, s[20:23], s46 offen offset:1024 sc1
    v_mfma_f32_16x16x32_bf16 v[72:75], v[16:19], v[200:203], v[72:75]
    v_mul_u32_u24 v1, 1152, v1
    v_mfma_f32_16x16x32_bf16 v[76:79], v[16:19], v[204:207], v[76:79]
    ds_read_b64_tr_b16 v[16:17], v2 offset:32768
    v_lshlrev_b32 v234, 16, v55
    v_mfma_f32_16x16x32_bf16 v[80:83], v[20:23], v[192:195], v[80:83]
    ds_read_b64_tr_b16 v[18:19], v2 offset:33280
    v_and_b32 v235, s41, v55
    v_mfma_f32_16x16x32_bf16 v[84:87], v[20:23], v[196:199], v[84:87]
    v_lshlrev_b32 v236, 16, v62
    v_lshrrev_b32 v255, 4, v0
    v_mfma_f32_16x16x32_bf16 v[88:91], v[20:23], v[200:203], v[88:91]
    v_and_b32 v237, s41, v62
    v_lshl_add_u32 v1, v255, 3, v1
    v_mfma_f32_16x16x32_bf16 v[92:95], v[20:23], v[204:207], v[92:95]
    s_waitcnt lgkmcnt(2)
    ds_read_b64_tr_b16 v[20:21], v3 offset:32768
    v_mfma_f32_16x16x32_bf16 v[96:99], v[24:27], v[192:195], v[96:99]
    ds_read_b64_tr_b16 v[22:23], v3 offset:33280
    v_lshlrev_b32 v238, 16, v63
    v_mfma_f32_16x16x32_bf16 v[100:103], v[24:27], v[196:199], v[100:103]
    v_and_b32 v239, s41, v63
    v_mfma_f32_16x16x32_bf16 v[104:107], v[24:27], v[200:203], v[104:107]
    s_lshl_b32 s92, s69, 5
    v_mul_f32 v232, v232, v172
    v_mfma_f32_16x16x32_bf16 v[108:111], v[24:27], v[204:207], v[108:111]
    ds_read_b64_tr_b16 v[24:25], v4 offset:32768
    v_mul_f32 v233, v233, v173
    v_mfma_f32_16x16x32_bf16 v[112:115], v[28:31], v[192:195], v[112:115]
    ds_read_b64_tr_b16 v[26:27], v4 offset:33280
    v_mul_f32 v234, v234, v174
    v_mfma_f32_16x16x32_bf16 v[116:119], v[28:31], v[196:199], v[116:119]
    s_add_u32 s92, s92, s71
    v_mul_f32 v235, v235, v175
    v_mfma_f32_16x16x32_bf16 v[120:123], v[28:31], v[200:203], v[120:123]
    v_mul_f32 v236, v236, v188
    v_mfma_f32_16x16x32_bf16 v[124:127], v[28:31], v[204:207], v[124:127]
    s_waitcnt lgkmcnt(2)
    ds_read_b64_tr_b16 v[28:29], v5 offset:32768
    v_mfma_f32_16x16x32_bf16 v[64:67], v[16:19], v[208:211], v[64:67]
    ds_read_b64_tr_b16 v[30:31], v5 offset:33280
    v_mul_f32 v237, v237, v189
    v_mfma_f32_16x16x32_bf16 v[68:71], v[16:19], v[212:215], v[68:71]
    v_mul_f32 v238, v238, v190
    v_add_u32 v252, s92, v1
    v_mov_b32 v2, v6
    v_mfma_f32_16x16x32_bf16 v[72:75], v[16:19], v[216:219], v[72:75]
    s_waitcnt vmcnt(8)
    s_barrier
    v_mfma_f32_16x16x32_bf16 v[76:79], v[16:19], v[220:223], v[76:79]
    ds_read_b64_tr_b16 v[16:17], v2 offset:0
    v_mul_f32 v239, v239, v191
    v_mfma_f32_16x16x32_bf16 v[80:83], v[20:23], v[208:211], v[80:83]
    ds_read_b64_tr_b16 v[18:19], v2 offset:512
    v_cvt_pk_bf16_f32 v232, v232, v233
    v_add_u32 v253, 18432, v252
    v_mfma_f32_16x16x32_bf16 v[84:87], v[20:23], v[212:215], v[84:87]
    v_cvt_pk_bf16_f32 v233, v234, v235
    v_mov_b32 v3, v7
    v_mfma_f32_16x16x32_bf16 v[88:91], v[20:23], v[216:219], v[88:91]
    v_cvt_pk_bf16_f32 v234, v236, v237
    v_cvt_pk_bf16_f32 v235, v238, v239
    v_mfma_f32_16x16x32_bf16 v[92:95], v[20:23], v[220:223], v[92:95]
    s_waitcnt lgkmcnt(2)
    ds_read_b64_tr_b16 v[20:21], v3 offset:0
    v_mfma_f32_16x16x32_bf16 v[96:99], v[24:27], v[208:211], v[96:99]
    ds_read_b64_tr_b16 v[22:23], v3 offset:512
    v_mfma_f32_16x16x32_bf16 v[100:103], v[24:27], v[212:215], v[100:103]
    v_mov_b32 v4, v8
    v_mfma_f32_16x16x32_bf16 v[104:107], v[24:27], v[216:219], v[104:107]
    buffer_store_dwordx4 v[232:235], v14, s[20:23], s47 offen offset:1024 sc1
    v_mfma_f32_16x16x32_bf16 v[108:111], v[24:27], v[220:223], v[108:111]
    ds_read_b64_tr_b16 v[24:25], v4 offset:0
    v_mfma_f32_16x16x32_bf16 v[112:115], v[28:31], v[208:211], v[112:115]
    ds_read_b64_tr_b16 v[26:27], v4 offset:512
    v_mfma_f32_16x16x32_bf16 v[116:119], v[28:31], v[212:215], v[116:119]
    v_mov_b32 v5, v9
    v_mfma_f32_16x16x32_bf16 v[120:123], v[28:31], v[216:219], v[120:123]
    v_mfma_f32_16x16x32_bf16 v[124:127], v[28:31], v[220:223], v[124:127]
    ds_read_b64_tr_b16 v[28:29], v5 offset:0
    ds_read_b64_tr_b16 v[30:31], v5 offset:512
    s_add_u32 s44, s44, 2048
    s_add_u32 s45, s45, 2048
    s_add_u32 s46, s46, 2048
    s_add_u32 s47, s47, 2048
    s_mov_b32 s24, s25
    s_mov_b32 s43, 1
    v_mov_b32 v10, v244
    v_mov_b32 v11, v245
    v_mov_b32 v6, v240
    v_mov_b32 v7, v241
    v_add_u32 v8, 4096, v240
    v_add_u32 v9, 4096, v241
    s_branch KF_loop
KF_z:
    s_cmp_eq_u32 s68, 0
    s_cbranch_scc0 KF_zl
    s_mov_b32 s6, s78
    s_mov_b32 s24, s62
    v_min_u32 v244, 7, v0
    v_lshlrev_b32 v244, 2, v244
    v_add_u32 v254, 1, v254
    v_add_u32 v255, 1, v254
    s_waitcnt lgkmcnt(4)
    v_mfma_f32_16x16x32_bf16 v[64:67], v[16:19], a[0:3], 0
    v_mfma_f32_16x16x32_bf16 v[68:71], v[16:19], a[4:7], 0
    v_lshlrev_b32 v224, 16, v32
    v_and_b32 v225, s41, v32
    v_mfma_f32_16x16x32_bf16 v[72:75], v[16:19], a[8:11], 0
    v_lshlrev_b32 v226, 16, v33
    v_and_b32 v227, s41, v33
    v_mov_b64 v[100:101], 0
    v_mfma_f32_16x16x32_bf16 v[76:79], v[16:19], a[12:15], 0
    ds_read_b64_tr_b16 v[16:17], v2 offset:8192
    v_lshlrev_b32 v228, 16, v40
    v_mfma_f32_16x16x32_bf16 v[80:83], v[20:23], a[0:3], 0
    ds_read_b64_tr_b16 v[18:19], v2 offset:8704
    v_and_b32 v229, s41, v40
    v_mfma_f32_16x16x32_bf16 v[84:87], v[20:23], a[4:7], 0
    v_lshlrev_b32 v230, 16, v41
    v_and_b32 v231, s41, v41
    v_mfma_f32_16x16x32_bf16 v[88:91], v[20:23], a[8:11], 0
    v_mul_f32 v224, v224, v128
    v_mul_f32 v225, v225, v129
    v_mov_b64 v[102:103], 0
    v_mfma_f32_16x16x32_bf16 v[92:95], v[20:23], a[12:15], 0
    s_waitcnt lgkmcnt(2)
    ds_read_b64_tr_b16 v[20:21], v3 offset:8192
    v_mfma_f32_16x16x32_bf16 v[64:67], v[24:27], a[16:19], v[64:67]
    ds_read_b64_tr_b16 v[22:23], v3 offset:8704
    v_mul_f32 v226, v226, v130
    v_mfma_f32_16x16x32_bf16 v[68:71], v[24:27], a[20:23], v[68:71]
    v_mul_f32 v227, v227, v131
    v_mul_f32 v228, v228, v144
    v_mfma_f32_16x16x32_bf16 v[72:75], v[24:27], a[24:27], v[72:75]
    v_mul_f32 v229, v229, v145
    v_mul_f32 v230, v230, v146
    v_mov_b64 v[104:105], 0
    v_mfma_f32_16x16x32_bf16 v[76:79], v[24:27], a[28:31], v[76:79]
    ds_read_b64_tr_b16 v[24:25], v4 offset:8192
    v_mul_f32 v231, v231, v147
    v_mfma_f32_16x16x32_bf16 v[80:83], v[28:31], a[16:19], v[80:83]
    ds_read_b64_tr_b16 v[26:27], v4 offset:8704
    v_cvt_pk_bf16_f32 v224, v224, v225
    v_mfma_f32_16x16x32_bf16 v[84:87], v[28:31], a[20:23], v[84:87]
    v_cvt_pk_bf16_f32 v225, v226, v227
    v_cvt_pk_bf16_f32 v226, v228, v229
    v_mfma_f32_16x16x32_bf16 v[88:91], v[28:31], a[24:27], v[88:91]
    v_cvt_pk_bf16_f32 v227, v230, v231
    v_lshlrev_b32 v232, 16, v34
    v_mov_b64 v[106:107], 0
    v_mfma_f32_16x16x32_bf16 v[92:95], v[28:31], a[28:31], v[92:95]
    s_waitcnt lgkmcnt(2)
    ds_read_b64_tr_b16 v[28:29], v5 offset:8192
    v_mfma_f32_16x16x32_bf16 v[64:67], v[16:19], a[32:35], v[64:67]
    ds_read_b64_tr_b16 v[30:31], v5 offset:8704
    v_and_b32 v233, s41, v34
    v_mfma_f32_16x16x32_bf16 v[68:71], v[16:19], a[36:39], v[68:71]
    buffer_store_dwordx4 v[224:227], v14, s[20:23], s44 offen offset:0 sc1
    v_mfma_f32_16x16x32_bf16 v[72:75], v[16:19], a[40:43], v[72:75]
    v_lshlrev_b32 v234, 16, v35
    v_and_b32 v235, s41, v35
    v_mov_b64 v[108:109], 0
    v_mfma_f32_16x16x32_bf16 v[76:79], v[16:19], a[44:47], v[76:79]
    ds_read_b64_tr_b16 v[16:17], v2 offset:16384
    v_lshlrev_b32 v236, 16, v42
    v_mfma_f32_16x16x32_bf16 v[80:83], v[20:23], a[32:35], v[80:83]
    ds_read_b64_tr_b16 v[18:19], v2 offset:16896
    v_and_b32 v237, s41, v42
    v_mfma_f32_16x16x32_bf16 v[84:87], v[20:23], a[36:39], v[84:87]
    v_lshlrev_b32 v238, 16, v43
    v_and_b32 v239, s41, v43
    v_mfma_f32_16x16x32_bf16 v[88:91], v[20:23], a[40:43], v[88:91]
    v_mul_f32 v232, v232, v132
    v_mul_f32 v233, v233, v133
    v_mov_b64 v[110:111], 0
    v_mfma_f32_16x16x32_bf16 v[92:95], v[20:23], a[44:47], v[92:95]
    s_waitcnt lgkmcnt(2)
    ds_read_b64_tr_b16 v[20:21], v3 offset:16384
    v_mfma_f32_16x16x32_bf16 v[64:67], v[24:27], a[48:51], v[64:67]
    ds_read_b64_tr_b16 v[22:23], v3 offset:16896
    v_mul_f32 v234, v234, v134
    v_mfma_f32_16x16x32_bf16 v[68:71], v[24:27], a[52:55], v[68:71]
    v_mul_f32 v235, v235, v135
    v_mul_f32 v236, v236, v148
    v_mfma_f32_16x16x32_bf16 v[72:75], v[24:27], a[56:59], v[72:75]
    v_mul_f32 v237, v237, v149
    v_mul_f32 v238, v238, v150
    v_mov_b64 v[112:113], 0
    v_mfma_f32_16x16x32_bf16 v[76:79], v[24:27], a[60:63], v[76:79]
    ds_read_b64_tr_b16 v[24:25], v4 offset:16384
    v_mul_f32 v239, v239, v151
    v_mfma_f32_16x16x32_bf16 v[80:83], v[28:31], a[48:51], v[80:83]
    ds_read_b64_tr_b16 v[26:27], v4 offset:16896
    v_cvt_pk_bf16_f32 v232, v232, v233
    v_mfma_f32_16x16x32_bf16 v[84:87], v[28:31], a[52:55], v[84:87]
    v_cvt_pk_bf16_f32 v233, v234, v235
    v_cvt_pk_bf16_f32 v234, v236, v237
    v_mfma_f32_16x16x32_bf16 v[88:91], v[28:31], a[56:59], v[88:91]
    v_cvt_pk_bf16_f32 v235, v238, v239
    v_lshlrev_b32 v224, 16, v36
    v_mfma_f32_16x16x32_bf16 v[92:95], v[28:31], a[60:63], v[92:95]
    s_waitcnt lgkmcnt(2)
    ds_read_b64_tr_b16 v[28:29], v5 offset:16384
    v_mov_b64 v[114:115], 0
    v_mfma_f32_16x16x32_bf16 v[64:67], v[16:19], a[64:67], v[64:67]
    ds_read_b64_tr_b16 v[30:31], v5 offset:16896
    v_and_b32 v225, s41, v36
    v_mfma_f32_16x16x32_bf16 v[68:71], v[16:19], a[68:71], v[68:71]
    buffer_store_dwordx4 v[232:235], v14, s[20:23], s45 offen offset:0 sc1
    v_mfma_f32_16x16x32_bf16 v[72:75], v[16:19], a[72:75], v[72:75]
    v_lshlrev_b32 v226, 16, v37
    v_and_b32 v227, s41, v37
    v_mfma_f32_16x16x32_bf16 v[76:79], v[16:19], a[76:79], v[76:79]
    ds_read_b64_tr_b16 v[16:17], v2 offset:24576
    v_lshlrev_b32 v228, 16, v44
    v_mov_b64 v[116:117], 0
    v_mfma_f32_16x16x32_bf16 v[80:83], v[20:23], a[64:67], v[80:83]
    ds_read_b64_tr_b16 v[18:19], v2 offset:25088
    v_and_b32 v229, s41, v44
    v_mfma_f32_16x16x32_bf16 v[84:87], v[20:23], a[68:71], v[84:87]
    v_lshlrev_b32 v230, 16, v45
    v_and_b32 v231, s41, v45
    v_mfma_f32_16x16x32_bf16 v[88:91], v[20:23], a[72:75], v[88:91]
    v_mul_f32 v224, v224, v136
    v_mul_f32 v225, v225, v137
    v_mfma_f32_16x16x32_bf16 v[92:95], v[20:23], a[76:79], v[92:95]
    s_waitcnt lgkmcnt(2)
    ds_read_b64_tr_b16 v[20:21], v3 offset:24576
    v_mov_b64 v[118:119], 0
    v_mfma_f32_16x16x32_bf16 v[64:67], v[24:27], a[80:83], v[64:67]
    ds_read_b64_tr_b16 v[22:23], v3 offset:25088
    v_mul_f32 v226, v226, v138
    v_mfma_f32_16x16x32_bf16 v[68:71], v[24:27], a[84:87], v[68:71]
    v_mul_f32 v227, v227, v139
    v_mul_f32 v228, v228, v152
    v_mfma_f32_16x16x32_bf16 v[72:75], v[24:27], a[88:91], v[72:75]
    v_mul_f32 v229, v229, v153
    v_mul_f32 v230, v230, v154
    v_mfma_f32_16x16x32_bf16 v[76:79], v[24:27], a[92:95], v[76:79]
    ds_read_b64_tr_b16 v[24:25], v4 offset:24576
    v_mul_f32 v231, v231, v155
    v_mov_b64 v[120:121], 0
    v_mfma_f32_16x16x32_bf16 v[80:83], v[28:31], a[80:83], v[80:83]
    ds_read_b64_tr_b16 v[26:27], v4 offset:25088
    v_cvt_pk_bf16_f32 v224, v224, v225
    v_mfma_f32_16x16x32_bf16 v[84:87], v[28:31], a[84:87], v[84:87]
    v_cvt_pk_bf16_f32 v225, v226, v227
    v_cvt_pk_bf16_f32 v226, v228, v229
    v_mfma_f32_16x16x32_bf16 v[88:91], v[28:31], a[88:91], v[88:91]
    v_cvt_pk_bf16_f32 v227, v230, v231
    v_lshlrev_b32 v232, 16, v38
    v_mfma_f32_16x16x32_bf16 v[92:95], v[28:31], a[92:95], v[92:95]
    s_waitcnt lgkmcnt(2)
    ds_read_b64_tr_b16 v[28:29], v5 offset:24576
    v_mov_b64 v[122:123], 0
    v_mfma_f32_16x16x32_bf16 v[64:67], v[16:19], a[96:99], v[64:67]
    ds_read_b64_tr_b16 v[30:31], v5 offset:25088
    v_and_b32 v233, s41, v38
    v_mfma_f32_16x16x32_bf16 v[68:71], v[16:19], a[100:103], v[68:71]
    buffer_store_dwordx4 v[224:227], v14, s[20:23], s46 offen offset:0 sc1
    v_mfma_f32_16x16x32_bf16 v[72:75], v[16:19], a[104:107], v[72:75]
    v_lshlrev_b32 v234, 16, v39
    v_and_b32 v235, s41, v39
    v_mfma_f32_16x16x32_bf16 v[76:79], v[16:19], a[108:111], v[76:79]
    ds_read_b64_tr_b16 v[16:17], v2 offset:32768
    v_lshlrev_b32 v236, 16, v46
    v_mov_b64 v[124:125], 0
    v_mfma_f32_16x16x32_bf16 v[80:83], v[20:23], a[96:99], v[80:83]
    ds_read_b64_tr_b16 v[18:19], v2 offset:33280
    v_and_b32 v237, s41, v46
    v_mfma_f32_16x16x32_bf16 v[84:87], v[20:23], a[100:103], v[84:87]
    v_lshlrev_b32 v238, 16, v47
    v_and_b32 v239, s41, v47
    v_mfma_f32_16x16x32_bf16 v[88:91], v[20:23], a[104:107], v[88:91]
    v_mul_f32 v232, v232, v140
    v_mul_f32 v233, v233, v141
    v_mfma_f32_16x16x32_bf16 v[92:95], v[20:23], a[108:111], v[92:95]
    s_waitcnt lgkmcnt(2)
    ds_read_b64_tr_b16 v[20:21], v3 offset:32768
    v_mov_b64 v[126:127], 0
    v_mfma_f32_16x16x32_bf16 v[64:67], v[24:27], a[112:115], v[64:67]
    ds_read_b64_tr_b16 v[22:23], v3 offset:33280
    v_mul_f32 v234, v234, v142
    v_mfma_f32_16x16x32_bf16 v[68:71], v[24:27], a[116:119], v[68:71]
    v_mul_f32 v235, v235, v143
    v_mul_f32 v236, v236, v156
    v_mfma_f32_16x16x32_bf16 v[72:75], v[24:27], a[120:123], v[72:75]
    v_mul_f32 v237, v237, v157
    v_mul_f32 v238, v238, v158
    v_mfma_f32_16x16x32_bf16 v[76:79], v[24:27], a[124:127], v[76:79]
    ds_read_b64_tr_b16 v[24:25], v4 offset:32768
    v_mul_f32 v239, v239, v159
    v_mfma_f32_16x16x32_bf16 v[80:83], v[28:31], a[112:115], v[80:83]
    ds_read_b64_tr_b16 v[26:27], v4 offset:33280
    buffer_load_dword v245, v244, s[20:23], s26 offen sc1
    v_cvt_pk_bf16_f32 v232, v232, v233
    v_mfma_f32_16x16x32_bf16 v[84:87], v[28:31], a[116:119], v[84:87]
    v_cvt_pk_bf16_f32 v233, v234, v235
    v_cvt_pk_bf16_f32 v234, v236, v237
    v_mfma_f32_16x16x32_bf16 v[88:91], v[28:31], a[120:123], v[88:91]
    s_and_b32 s79, s6, 31
    v_cvt_pk_bf16_f32 v235, v238, v239
    v_lshlrev_b32 v224, 16, v48
    v_mfma_f32_16x16x32_bf16 v[92:95], v[28:31], a[124:127], v[92:95]
    s_waitcnt lgkmcnt(2)
    s_mul_i32 s80, s79, 73728
    ds_read_b64_tr_b16 v[28:29], v5 offset:32768
    v_mfma_f32_16x16x32_bf16 v[64:67], v[16:19], a[128:131], v[64:67]
    ds_read_b64_tr_b16 v[30:31], v5 offset:33280
    v_and_b32 v225, s41, v48
    v_mfma_f32_16x16x32_bf16 v[68:71], v[16:19], a[132:135], v[68:71]
    s_add_u32 s80, s80, s73
    v_lshlrev_b32 v226, 16, v49
    v_add_u32 v2, 40960, v2
    v_mfma_f32_16x16x32_bf16 v[72:75], v[16:19], a[136:139], v[72:75]
    buffer_store_dwordx4 v[232:235], v14, s[20:23], s47 offen offset:0 sc1
    v_mfma_f32_16x16x32_bf16 v[76:79], v[16:19], a[140:143], v[76:79]
    s_cmp_lt_u32 s79, 18
    ds_read_b64_tr_b16 v[16:17], v2 offset:0
    v_and_b32 v227, s41, v49
    v_mfma_f32_16x16x32_bf16 v[80:83], v[20:23], a[128:131], v[80:83]
    ds_read_b64_tr_b16 v[18:19], v2 offset:512
    v_lshlrev_b32 v228, 16, v56
    v_mfma_f32_16x16x32_bf16 v[84:87], v[20:23], a[132:135], v[84:87]
    s_cselect_b32 s80, s80, 2147479552
    v_and_b32 v229, s41, v56
    v_add_u32 v3, 40960, v3
    v_mfma_f32_16x16x32_bf16 v[88:91], v[20:23], a[136:139], v[88:91]
    v_lshlrev_b32 v230, 16, v57
    v_and_b32 v231, s41, v57
    v_mfma_f32_16x16x32_bf16 v[92:95], v[20:23], a[140:143], v[92:95]
    s_waitcnt lgkmcnt(2)
    s_add_u32 m0, s72, 73728
    ds_read_b64_tr_b16 v[20:21], v3 offset:0
    v_mfma_f32_16x16x32_bf16 v[64:67], v[24:27], a[144:147], v[64:67]
    ds_read_b64_tr_b16 v[22:23], v3 offset:512
    v_mul_f32 v224, v224, v160
    v_mfma_f32_16x16x32_bf16 v[68:71], v[24:27], a[148:151], v[68:71]
    buffer_load_dwordx4 v246, s[84:87], s80 offen offset:0 lds
    v_mul_f32 v225, v225, v161
    v_add_u32 v4, 40960, v4
    v_mfma_f32_16x16x32_bf16 v[72:75], v[24:27], a[152:155], v[72:75]
    v_mul_f32 v226, v226, v162
    v_mul_f32 v227, v227, v163
    v_mfma_f32_16x16x32_bf16 v[76:79], v[24:27], a[156:159], v[76:79]
    s_lshr_b32 s6, s6, 5
    ds_read_b64_tr_b16 v[24:25], v4 offset:0
    v_mul_f32 v228, v228, v176
    v_mfma_f32_16x16x32_bf16 v[80:83], v[28:31], a[144:147], v[80:83]
    ds_read_b64_tr_b16 v[26:27], v4 offset:512
    v_mul_f32 v229, v229, v177
    v_mfma_f32_16x16x32_bf16 v[84:87], v[28:31], a[148:151], v[84:87]
    buffer_load_dwordx4 v247, s[84:87], s80 offen offset:1024 lds
    v_mul_f32 v230, v230, v178
    v_add_u32 v5, 40960, v5
    v_mfma_f32_16x16x32_bf16 v[88:91], v[28:31], a[152:155], v[88:91]
    v_mul_f32 v231, v231, v179
    v_lshlrev_b32 v232, 16, v50
    v_mfma_f32_16x16x32_bf16 v[92:95], v[28:31], a[156:159], v[92:95]
    s_waitcnt lgkmcnt(2)
    buffer_load_dwordx4 v248, s[84:87], s80 offen offset:2048 lds
    ds_read_b64_tr_b16 v[28:29], v5 offset:0
    v_mfma_f32_16x16x32_bf16 v[64:67], v[16:19], a[160:163], v[64:67]
    ds_read_b64_tr_b16 v[30:31], v5 offset:512
    v_cvt_pk_bf16_f32 v224, v224, v225
    v_mfma_f32_16x16x32_bf16 v[68:71], v[16:19], a[164:167], v[68:71]
    s_add_u32 m0, s72, 86016
    v_cvt_pk_bf16_f32 v225, v226, v227
    v_cvt_pk_bf16_f32 v226, v228, v229
    v_mfma_f32_16x16x32_bf16 v[72:75], v[16:19], a[168:171], v[72:75]
    v_cvt_pk_bf16_f32 v227, v230, v231
    v_and_b32 v233, s41, v50
    v_mfma_f32_16x16x32_bf16 v[76:79], v[16:19], a[172:175], v[76:79]
    s_add_u32 s80, s80, 36864
    ds_read_b64_tr_b16 v[16:17], v2 offset:8192
    v_lshlrev_b32 v234, 16, v51
    v_mfma_f32_16x16x32_bf16 v[80:83], v[20:23], a[160:163], v[80:83]
    ds_read_b64_tr_b16 v[18:19], v2 offset:8704
    v_and_b32 v235, s41, v51
    v_mfma_f32_16x16x32_bf16 v[84:87], v[20:23], a[164:167], v[84:87]
    buffer_store_dwordx4 v[224:227], v14, s[20:23], s44 offen offset:1024 sc1
    buffer_load_dwordx4 v246, s[84:87], s80 offen offset:0 lds
    v_mfma_f32_16x16x32_bf16 v[88:91], v[20:23], a[168:171], v[88:91]
    v_lshlrev_b32 v236, 16, v58
    v_and_b32 v237, s41, v58
    v_mfma_f32_16x16x32_bf16 v[92:95], v[20:23], a[172:175], v[92:95]
    s_waitcnt lgkmcnt(2)
    buffer_load_dwordx4 v247, s[84:87], s80 offen offset:1024 lds
    ds_read_b64_tr_b16 v[20:21], v3 offset:8192
    v_mfma_f32_16x16x32_bf16 v[64:67], v[24:27], a[176:179], v[64:67]
    ds_read_b64_tr_b16 v[22:23], v3 offset:8704
    v_lshlrev_b32 v238, 16, v59
    v_mfma_f32_16x16x32_bf16 v[68:71], v[24:27], a[180:183], v[68:71]
    buffer_load_dwordx4 v248, s[84:87], s80 offen offset:2048 lds
    v_and_b32 v239, s41, v59
    v_lshlrev_b32 v224, 16, v52
    v_mfma_f32_16x16x32_bf16 v[72:75], v[24:27], a[184:187], v[72:75]
    v_mul_f32 v232, v232, v164
    v_mul_f32 v233, v233, v165
    v_mfma_f32_16x16x32_bf16 v[76:79], v[24:27], a[188:191], v[76:79]
    s_and_b32 s79, s6, 31
    ds_read_b64_tr_b16 v[24:25], v4 offset:8192
    v_mul_f32 v234, v234, v166
    v_mfma_f32_16x16x32_bf16 v[80:83], v[28:31], a[176:179], v[80:83]
    ds_read_b64_tr_b16 v[26:27], v4 offset:8704
    v_mul_f32 v235, v235, v167
    v_mfma_f32_16x16x32_bf16 v[84:87], v[28:31], a[180:183], v[84:87]
    s_mul_i32 s80, s79, 73728
    v_mul_f32 v236, v236, v180
    v_mul_f32 v237, v237, v181
    v_mfma_f32_16x16x32_bf16 v[88:91], v[28:31], a[184:187], v[88:91]
    v_mul_f32 v238, v238, v182
    v_mul_f32 v239, v239, v183
    v_mfma_f32_16x16x32_bf16 v[92:95], v[28:31], a[188:191], v[92:95]
    s_waitcnt lgkmcnt(2)
    s_add_u32 s80, s80, s73
    ds_read_b64_tr_b16 v[28:29], v5 offset:8192
    v_mfma_f32_16x16x32_bf16 v[64:67], v[16:19], a[192:195], v[64:67]
    ds_read_b64_tr_b16 v[30:31], v5 offset:8704
    v_cvt_pk_bf16_f32 v232, v232, v233
    v_mfma_f32_16x16x32_bf16 v[68:71], v[16:19], a[196:199], v[68:71]
    s_cmp_lt_u32 s79, 18
    v_cvt_pk_bf16_f32 v233, v234, v235
    v_cvt_pk_bf16_f32 v234, v236, v237
    v_mfma_f32_16x16x32_bf16 v[72:75], v[16:19], a[200:203], v[72:75]
    v_cvt_pk_bf16_f32 v235, v238, v239
    v_and_b32 v225, s41, v52
    v_mfma_f32_16x16x32_bf16 v[76:79], v[16:19], a[204:207], v[76:79]
    s_cselect_b32 s80, s80, 2147479552
    ds_read_b64_tr_b16 v[16:17], v2 offset:16384
    v_lshlrev_b32 v226, 16, v53
    v_mfma_f32_16x16x32_bf16 v[80:83], v[20:23], a[192:195], v[80:83]
    ds_read_b64_tr_b16 v[18:19], v2 offset:16896
    v_and_b32 v227, s41, v53
    v_mfma_f32_16x16x32_bf16 v[84:87], v[20:23], a[196:199], v[84:87]
    buffer_store_dwordx4 v[232:235], v14, s[20:23], s45 offen offset:1024 sc1
    s_add_u32 m0, s72, 98304
    v_mfma_f32_16x16x32_bf16 v[88:91], v[20:23], a[200:203], v[88:91]
    v_lshlrev_b32 v228, 16, v60
    v_and_b32 v229, s41, v60
    v_mfma_f32_16x16x32_bf16 v[92:95], v[20:23], a[204:207], v[92:95]
    s_waitcnt lgkmcnt(2)
    buffer_load_dwordx4 v246, s[84:87], s80 offen offset:0 lds
    ds_read_b64_tr_b16 v[20:21], v3 offset:16384
    v_mfma_f32_16x16x32_bf16 v[64:67], v[24:27], a[208:211], v[64:67]
    ds_read_b64_tr_b16 v[22:23], v3 offset:16896
    v_lshlrev_b32 v230, 16, v61
    v_mfma_f32_16x16x32_bf16 v[68:71], v[24:27], a[212:215], v[68:71]
    s_lshr_b32 s6, s6, 5
    v_and_b32 v231, s41, v61
    v_lshlrev_b32 v232, 16, v54
    v_mfma_f32_16x16x32_bf16 v[72:75], v[24:27], a[216:219], v[72:75]
    buffer_load_dwordx4 v247, s[84:87], s80 offen offset:1024 lds
    v_mul_f32 v224, v224, v168
    v_mul_f32 v225, v225, v169
    v_mfma_f32_16x16x32_bf16 v[76:79], v[24:27], a[220:223], v[76:79]
    ds_read_b64_tr_b16 v[24:25], v4 offset:16384
    v_mul_f32 v226, v226, v170
    v_mfma_f32_16x16x32_bf16 v[80:83], v[28:31], a[208:211], v[80:83]
    buffer_load_dwordx4 v248, s[84:87], s80 offen offset:2048 lds
    ds_read_b64_tr_b16 v[26:27], v4 offset:16896
    v_mul_f32 v227, v227, v171
    v_mfma_f32_16x16x32_bf16 v[84:87], v[28:31], a[212:215], v[84:87]
    v_mul_f32 v228, v228, v184
    v_mul_f32 v229, v229, v185
    v_mfma_f32_16x16x32_bf16 v[88:91], v[28:31], a[216:219], v[88:91]
    s_add_u32 m0, s72, 110592
    v_mul_f32 v230, v230, v186
    v_mul_f32 v231, v231, v187
    v_mfma_f32_16x16x32_bf16 v[92:95], v[28:31], a[220:223], v[92:95]
    s_waitcnt lgkmcnt(2)
    ds_read_b64_tr_b16 v[28:29], v5 offset:16384
    v_mfma_f32_16x16x32_bf16 v[64:67], v[16:19], a[224:227], v[64:67]
    s_add_u32 s80, s80, 36864
    ds_read_b64_tr_b16 v[30:31], v5 offset:16896
    v_cvt_pk_bf16_f32 v224, v224, v225
    v_mfma_f32_16x16x32_bf16 v[68:71], v[16:19], a[228:231], v[68:71]
    v_cvt_pk_bf16_f32 v225, v226, v227
    v_cvt_pk_bf16_f32 v226, v228, v229
    v_mfma_f32_16x16x32_bf16 v[72:75], v[16:19], a[232:235], v[72:75]
    buffer_load_dwordx4 v246, s[84:87], s80 offen offset:0 lds
    v_cvt_pk_bf16_f32 v227, v230, v231
    v_and_b32 v233, s41, v54
    v_mfma_f32_16x16x32_bf16 v[76:79], v[16:19], a[236:239], v[76:79]
    ds_read_b64_tr_b16 v[16:17], v2 offset:24576
    v_lshlrev_b32 v234, 16, v55
    v_mfma_f32_16x16x32_bf16 v[80:83], v[20:23], a[224:227], v[80:83]
    buffer_load_dwordx4 v247, s[84:87], s80 offen offset:1024 lds
    ds_read_b64_tr_b16 v[18:19], v2 offset:25088
    v_and_b32 v235, s41, v55
    v_mfma_f32_16x16x32_bf16 v[84:87], v[20:23], a[228:231], v[84:87]
    buffer_store_dwordx4 v[224:227], v14, s[20:23], s46 offen offset:1024 sc1
    v_mfma_f32_16x16x32_bf16 v[88:91], v[20:23], a[232:235], v[88:91]
    buffer_load_dwordx4 v248, s[84:87], s80 offen offset:2048 lds
    v_lshlrev_b32 v236, 16, v62
    v_and_b32 v237, s41, v62
    v_mfma_f32_16x16x32_bf16 v[92:95], v[20:23], a[236:239], v[92:95]
    s_waitcnt lgkmcnt(2)
    ds_read_b64_tr_b16 v[20:21], v3 offset:24576
    v_mfma_f32_16x16x32_bf16 v[64:67], v[24:27], a[240:243], v[64:67]
    ds_read_b64_tr_b16 v[22:23], v3 offset:25088
    v_lshlrev_b32 v238, 16, v63
    v_mfma_f32_16x16x32_bf16 v[68:71], v[24:27], a[244:247], v[68:71]
    s_and_b32 s79, s6, 31
    v_and_b32 v239, s41, v63
    v_mfma_f32_16x16x32_bf16 v[72:75], v[24:27], a[248:251], v[72:75]
    s_mul_i32 s80, s79, 73728
    v_mul_f32 v232, v232, v172
    v_mul_f32 v233, v233, v173
    v_mfma_f32_16x16x32_bf16 v[76:79], v[24:27], a[252:255], v[76:79]
    ds_read_b64_tr_b16 v[24:25], v4 offset:24576
    v_mul_f32 v234, v234, v174
    v_mfma_f32_16x16x32_bf16 v[80:83], v[28:31], a[240:243], v[80:83]
    s_add_u32 s80, s80, s73
    ds_read_b64_tr_b16 v[26:27], v4 offset:25088
    v_mul_f32 v235, v235, v175
    v_mfma_f32_16x16x32_bf16 v[84:87], v[28:31], a[244:247], v[84:87]
    v_mul_f32 v236, v236, v188
    v_mul_f32 v237, v237, v189
    v_mfma_f32_16x16x32_bf16 v[88:91], v[28:31], a[248:251], v[88:91]
    s_cmp_lt_u32 s79, 18
    v_mul_f32 v238, v238, v190
    v_mul_f32 v239, v239, v191
    v_mfma_f32_16x16x32_bf16 v[92:95], v[28:31], a[252:255], v[92:95]
    s_waitcnt lgkmcnt(2)
    ds_read_b64_tr_b16 v[28:29], v5 offset:24576
    v_mfma_f32_16x16x32_bf16 v[64:67], v[16:19], v[192:195], v[64:67]
    s_cselect_b32 s80, s80, 2147479552
    ds_read_b64_tr_b16 v[30:31], v5 offset:25088
    v_cvt_pk_bf16_f32 v232, v232, v233
    v_mfma_f32_16x16x32_bf16 v[68:71], v[16:19], v[196:199], v[68:71]
    v_cvt_pk_bf16_f32 v233, v234, v235
    v_add_u32 v2, 0, v242
    v_mfma_f32_16x16x32_bf16 v[72:75], v[16:19], v[200:203], v[72:75]
    v_cvt_pk_bf16_f32 v234, v236, v237
    v_cvt_pk_bf16_f32 v235, v238, v239
    v_mfma_f32_16x16x32_bf16 v[76:79], v[16:19], v[204:207], v[76:79]
    s_add_u32 m0, s72, 122880
    ds_read_b64_tr_b16 v[16:17], v2 offset:0
    v_mfma_f32_16x16x32_bf16 v[80:83], v[20:23], v[192:195], v[80:83]
    buffer_load_dwordx4 v246, s[84:87], s80 offen offset:0 lds
    ds_read_b64_tr_b16 v[18:19], v2 offset:512
    v_mfma_f32_16x16x32_bf16 v[84:87], v[20:23], v[196:199], v[84:87]
    v_add_u32 v3, 0, v243
    v_mfma_f32_16x16x32_bf16 v[88:91], v[20:23], v[200:203], v[88:91]
    buffer_store_dwordx4 v[232:235], v14, s[20:23], s47 offen offset:1024 sc1
    s_lshr_b32 s6, s6, 5
    v_mfma_f32_16x16x32_bf16 v[92:95], v[20:23], v[204:207], v[92:95]
    s_waitcnt lgkmcnt(2)
    ds_read_b64_tr_b16 v[20:21], v3 offset:0
    v_mfma_f32_16x16x32_bf16 v[64:67], v[24:27], v[208:211], v[64:67]
    buffer_load_dwordx4 v247, s[84:87], s80 offen offset:1024 lds
    ds_read_b64_tr_b16 v[22:23], v3 offset:512
    v_mfma_f32_16x16x32_bf16 v[68:71], v[24:27], v[212:215], v[68:71]
    v_add_u32 v4, 4096, v242
    v_mfma_f32_16x16x32_bf16 v[72:75], v[24:27], v[216:219], v[72:75]
    buffer_load_dwordx4 v248, s[84:87], s80 offen offset:2048 lds
    v_mfma_f32_16x16x32_bf16 v[76:79], v[24:27], v[220:223], v[76:79]
    ds_read_b64_tr_b16 v[24:25], v4 offset:0
    v_mfma_f32_16x16x32_bf16 v[80:83], v[28:31], v[208:211], v[80:83]
    s_add_u32 m0, s72, 135168
    ds_read_b64_tr_b16 v[26:27], v4 offset:512
    v_mfma_f32_16x16x32_bf16 v[84:87], v[28:31], v[212:215], v[84:87]
    v_add_u32 v5, 4096, v243
    v_mfma_f32_16x16x32_bf16 v[88:91], v[28:31], v[216:219], v[88:91]
    s_add_u32 s80, s80, 36864
    v_mfma_f32_16x16x32_bf16 v[92:95], v[28:31], v[220:223], v[92:95]
    s_waitcnt lgkmcnt(2)
    ds_read_b64_tr_b16 v[28:29], v5 offset:0
    v_mfma_f32_16x16x32_bf16 v[32:35], v[16:19], a[0:3], 0
    ds_read_b64_tr_b16 v[30:31], v5 offset:512
    v_mfma_f32_16x16x32_bf16 v[36:39], v[16:19], a[4:7], 0
    buffer_load_dwordx4 v246, s[84:87], s80 offen offset:0 lds
    v_mfma_f32_16x16x32_bf16 v[40:43], v[16:19], a[8:11], 0
    buffer_load_dwordx4 v247, s[84:87], s80 offen offset:1024 lds
    v_lshrrev_b32 v1, 5, v0
    v_mfma_f32_16x16x32_bf16 v[44:47], v[16:19], a[12:15], 0
    ds_read_b64_tr_b16 v[16:17], v2 offset:8192
    v_mfma_f32_16x16x32_bf16 v[48:51], v[20:23], a[0:3], 0
    ds_read_b64_tr_b16 v[18:19], v2 offset:8704
    v_mul_u32_u24 v1, 3072, v1
    v_mul_f32 v224, s40, v64
    v_mfma_f32_16x16x32_bf16 v[52:55], v[20:23], a[4:7], 0
    buffer_load_dwordx4 v248, s[84:87], s80 offen offset:2048 lds
    v_mul_f32 v225, s40, v65
    v_mul_f32 v226, s40, v66
    v_mfma_f32_16x16x32_bf16 v[56:59], v[20:23], a[8:11], 0
    v_bfe_u32 v96, v0, 2, 3
    v_mul_f32 v227, s40, v67
    v_mul_f32 v228, s40, v68
    v_mfma_f32_16x16x32_bf16 v[60:63], v[20:23], a[12:15], 0
    s_waitcnt lgkmcnt(2)
    ds_read_b64_tr_b16 v[20:21], v3 offset:8192
    v_mul_f32 v229, s40, v69
    v_mfma_f32_16x16x32_bf16 v[32:35], v[24:27], a[16:19], v[32:35]
    ds_read_b64_tr_b16 v[22:23], v3 offset:8704
    v_exp_f32 v224, v224
    v_mfma_f32_16x16x32_bf16 v[36:39], v[24:27], a[20:23], v[36:39]
    s_waitcnt vmcnt(23)
    v_subrev_u32 v245, s39, v245
    v_cmp_lt_u32 vcc, 2, v245
    s_mov_b32 s3, 0
    s_cbranch_vccz K_Zh_ok
K_Zh_c:
    buffer_load_dword v245, v244, s[20:23], s26 offen sc1
    s_add_u32 s3, s3, 1
    s_cmp_gt_u32 s3, 1000000
    s_cbranch_scc1 K_Zh_ok
    s_waitcnt vmcnt(0)
    v_subrev_u32 v245, s39, v245
    v_cmp_lt_u32 vcc, 2, v245
    s_nop 0
    s_cbranch_vccnz K_Zh_c
K_Zh_ok:
    v_mul_f32 v230, s40, v70
    v_mfma_f32_16x16x32_bf16 v[40:43], v[24:27], a[24:27], v[40:43]
    s_and_b32 s79, s78, 31
    v_lshl_add_u32 v1, v96, 7, v1
    v_mul_f32 v231, s40, v71
    v_mfma_f32_16x16x32_bf16 v[44:47], v[24:27], a[28:31], v[44:47]
    ds_read_b64_tr_b16 v[24:25], v4 offset:8192
    v_lshrrev_b32 v96, 1, v96
    v_mul_f32 v232, s40, v72
    v_mfma_f32_16x16x32_bf16 v[48:51], v[28:31], a[16:19], v[48:51]
    ds_read_b64_tr_b16 v[26:27], v4 offset:8704
    v_exp_f32 v225, v225
    v_mfma_f32_16x16x32_bf16 v[52:55], v[28:31], a[20:23], v[52:55]
    s_lshl_b32 s81, s79, 11
    v_exp_f32 v226, v226
    v_mfma_f32_16x16x32_bf16 v[56:59], v[28:31], a[24:27], v[56:59]
    s_add_u32 s81, s81, s74
    v_xor_b32 v96, s69, v96
    v_mul_f32 v233, s40, v73
    v_mfma_f32_16x16x32_bf16 v[60:63], v[28:31], a[28:31], v[60:63]
    s_waitcnt lgkmcnt(2)
    ds_read_b64_tr_b16 v[28:29], v5 offset:8192
    v_mul_f32 v234, s40, v74
    v_mfma_f32_16x16x32_bf16 v[32:35], v[16:19], a[32:35], v[32:35]
    ds_read_b64_tr_b16 v[30:31], v5 offset:8704
    v_and_b32 v97, 3, v0
    v_mul_f32 v235, s40, v75
    v_mfma_f32_16x16x32_bf16 v[36:39], v[16:19], a[36:39], v[36:39]
    s_cmp_lt_u32 s79, 18
    v_exp_f32 v227, v227
    v_mfma_f32_16x16x32_bf16 v[40:43], v[16:19], a[40:43], v[40:43]
    v_lshl_add_u32 v1, v97, 3, v1
    v_exp_f32 v228, v228
    v_mfma_f32_16x16x32_bf16 v[44:47], v[16:19], a[44:47], v[44:47]
    s_cselect_b32 s81, s81, 2147479552
    ds_read_b64_tr_b16 v[16:17], v2 offset:16384
    v_add_f32 v224, 1.0, v224
    v_mfma_f32_16x16x32_bf16 v[48:51], v[20:23], a[32:35], v[48:51]
    ds_read_b64_tr_b16 v[18:19], v2 offset:16896
    v_exp_f32 v229, v229
    v_mfma_f32_16x16x32_bf16 v[52:55], v[20:23], a[36:39], v[52:55]
    buffer_load_dwordx4 a[0:3], v249, s[20:23], s81 offen offset:0 sc1
    v_exp_f32 v230, v230
    v_mfma_f32_16x16x32_bf16 v[56:59], v[20:23], a[40:43], v[56:59]
    v_xor_b32 v97, 0, v96
    v_exp_f32 v231, v231
    v_mfma_f32_16x16x32_bf16 v[60:63], v[20:23], a[44:47], v[60:63]
    s_waitcnt lgkmcnt(2)
    ds_read_b64_tr_b16 v[20:21], v3 offset:16384
    v_add_f32 v225, 1.0, v225
    v_mfma_f32_16x16x32_bf16 v[32:35], v[24:27], a[48:51], v[32:35]
    ds_read_b64_tr_b16 v[22:23], v3 offset:16896
    v_lshl_add_u32 v6, v97, 5, v1
    v_add_f32 v226, 1.0, v226
    v_mfma_f32_16x16x32_bf16 v[36:39], v[24:27], a[52:55], v[36:39]
    s_lshr_b32 s78, s78, 5
    v_exp_f32 v232, v232
    v_mfma_f32_16x16x32_bf16 v[40:43], v[24:27], a[56:59], v[40:43]
    buffer_load_dwordx4 a[4:7], v250, s[20:23], s81 offen offset:0 sc1
    v_add_u32 v10, 49152, v6
    v_add_f32 v227, 1.0, v227
    v_mfma_f32_16x16x32_bf16 v[44:47], v[24:27], a[60:63], v[44:47]
    ds_read_b64_tr_b16 v[24:25], v4 offset:16384
    v_rcp_f32 v224, v224
    v_mfma_f32_16x16x32_bf16 v[48:51], v[28:31], a[48:51], v[48:51]
    ds_read_b64_tr_b16 v[26:27], v4 offset:16896
    v_add_u32 v240, 98304, v6
    v_add_f32 v228, 1.0, v228
    v_mfma_f32_16x16x32_bf16 v[52:55], v[28:31], a[52:55], v[52:55]
    buffer_load_dwordx4 a[8:11], v249, s[20:23], s81 offen offset:1024 sc1
    v_rcp_f32 v225, v225
    v_mfma_f32_16x16x32_bf16 v[56:59], v[28:31], a[56:59], v[56:59]
    v_xor_b32 v97, 1, v96
    v_rcp_f32 v226, v226
    v_mfma_f32_16x16x32_bf16 v[60:63], v[28:31], a[60:63], v[60:63]
    s_waitcnt lgkmcnt(2)
    ds_read_b64_tr_b16 v[28:29], v5 offset:16384
    v_add_f32 v229, 1.0, v229
    v_mfma_f32_16x16x32_bf16 v[32:35], v[16:19], a[64:67], v[32:35]
    buffer_load_dwordx4 a[12:15], v250, s[20:23], s81 offen offset:1024 sc1
    ds_read_b64_tr_b16 v[30:31], v5 offset:16896
    v_add_f32 v230, 1.0, v230
    v_mfma_f32_16x16x32_bf16 v[36:39], v[16:19], a[68:71], v[36:39]
    s_and_b32 s79, s78, 31
    v_rcp_f32 v227, v227
    v_mfma_f32_16x16x32_bf16 v[40:43], v[16:19], a[72:75], v[40:43]
    v_lshl_add_u32 v7, v97, 5, v1
    v_exp_f32 v233, v233
    v_mfma_f32_16x16x32_bf16 v[44:47], v[16:19], a[76:79], v[44:47]
    ds_read_b64_tr_b16 v[16:17], v2 offset:24576
    v_add_u32 v11, 49152, v7
    v_mul_f32 v64, v224, v64
    v_mfma_f32_16x16x32_bf16 v[48:51], v[20:23], a[64:67], v[48:51]
    ds_read_b64_tr_b16 v[18:19], v2 offset:25088
    v_exp_f32 v234, v234
    v_mfma_f32_16x16x32_bf16 v[52:55], v[20:23], a[68:71], v[52:55]
    s_lshl_b32 s81, s79, 11
    v_exp_f32 v235, v235
    v_mfma_f32_16x16x32_bf16 v[56:59], v[20:23], a[72:75], v[56:59]
    s_add_u32 s81, s81, s74
    v_add_u32 v241, 98304, v7
    v_mul_f32 v65, v225, v65
    v_mfma_f32_16x16x32_bf16 v[60:63], v[20:23], a[76:79], v[60:63]
    s_waitcnt lgkmcnt(2)
    ds_read_b64_tr_b16 v[20:21], v3 offset:24576
    v_mul_f32 v66, v226, v66
    v_mfma_f32_16x16x32_bf16 v[32:35], v[24:27], a[80:83], v[32:35]
    ds_read_b64_tr_b16 v[22:23], v3 offset:25088
    v_xor_b32 v97, 2, v96
    v_mul_f32 v67, v227, v67
    v_mfma_f32_16x16x32_bf16 v[36:39], v[24:27], a[84:87], v[36:39]
    s_cmp_lt_u32 s79, 18
    v_add_f32 v231, 1.0, v231
    v_add_f32 v232, 1.0, v232
    v_mfma_f32_16x16x32_bf16 v[40:43], v[24:27], a[88:91], v[40:43]
    s_cselect_b32 s81, s81, 2147479552
    v_rcp_f32 v228, v228
    v_mfma_f32_16x16x32_bf16 v[44:47], v[24:27], a[92:95], v[44:47]
    ds_read_b64_tr_b16 v[24:25], v4 offset:24576
    v_lshl_add_u32 v8, v97, 5, v1
    v_add_f32 v233, 1.0, v233
    v_mfma_f32_16x16x32_bf16 v[48:51], v[28:31], a[80:83], v[48:51]
    ds_read_b64_tr_b16 v[26:27], v4 offset:25088
    v_rcp_f32 v229, v229
    v_mfma_f32_16x16x32_bf16 v[52:55], v[28:31], a[84:87], v[52:55]
    buffer_load_dwordx4 a[16:19], v249, s[20:23], s81 offen offset:0 sc1
    v_rcp_f32 v230, v230
    v_mfma_f32_16x16x32_bf16 v[56:59], v[28:31], a[88:91], v[56:59]
    v_add_u32 v13, 49152, v8
    v_rcp_f32 v231, v231
    v_mfma_f32_16x16x32_bf16 v[60:63], v[28:31], a[92:95], v[60:63]
    s_waitcnt lgkmcnt(2)
    ds_read_b64_tr_b16 v[28:29], v5 offset:24576
    v_mul_f32 v68, v228, v68
    v_mfma_f32_16x16x32_bf16 v[32:35], v[16:19], a[96:99], v[32:35]
    s_lshr_b32 s78, s78, 5
    ds_read_b64_tr_b16 v[30:31], v5 offset:25088
    v_mul_f32 v69, v229, v69
    v_mfma_f32_16x16x32_bf16 v[36:39], v[16:19], a[100:103], v[36:39]
    buffer_load_dwordx4 a[20:23], v250, s[20:23], s81 offen offset:0 sc1
    v_add_u32 v242, 98304, v8
    v_mul_f32 v70, v230, v70
    v_mfma_f32_16x16x32_bf16 v[40:43], v[16:19], a[104:107], v[40:43]
    v_xor_b32 v97, 3, v96
    v_mul_f32 v71, v231, v71
    v_add_f32 v234, 1.0, v234
    v_mfma_f32_16x16x32_bf16 v[44:47], v[16:19], a[108:111], v[44:47]
    ds_read_b64_tr_b16 v[16:17], v2 offset:32768
    v_add_f32 v235, 1.0, v235
    v_mul_f32 v236, s40, v76
    v_mfma_f32_16x16x32_bf16 v[48:51], v[20:23], a[96:99], v[48:51]
    ds_read_b64_tr_b16 v[18:19], v2 offset:33280
    v_lshl_add_u32 v9, v97, 5, v1
    v_mul_f32 v237, s40, v77
    v_mfma_f32_16x16x32_bf16 v[52:55], v[20:23], a[100:103], v[52:55]
    buffer_load_dwordx4 a[24:27], v249, s[20:23], s81 offen offset:1024 sc1
    v_rcp_f32 v232, v232
    v_mfma_f32_16x16x32_bf16 v[56:59], v[20:23], a[104:107], v[56:59]
    buffer_load_dwordx4 a[28:31], v250, s[20:23], s81 offen offset:1024 sc1
    v_rcp_f32 v233, v233
    v_mfma_f32_16x16x32_bf16 v[60:63], v[20:23], a[108:111], v[60:63]
    s_waitcnt lgkmcnt(2)
    ds_read_b64_tr_b16 v[20:21], v3 offset:32768
    v_mul_f32 v238, s40, v78
    v_mfma_f32_16x16x32_bf16 v[32:35], v[24:27], a[112:115], v[32:35]
    ds_read_b64_tr_b16 v[22:23], v3 offset:33280
    v_add_u32 v15, 49152, v9
    v_mul_f32 v239, s40, v79
    v_mfma_f32_16x16x32_bf16 v[36:39], v[24:27], a[116:119], v[36:39]
    s_and_b32 s79, s78, 31
    v_add_u32 v243, 98304, v9
    v_mul_f32 v224, s40, v80
    v_mfma_f32_16x16x32_bf16 v[40:43], v[24:27], a[120:123], v[40:43]
    s_lshl_b32 s81, s79, 11
    v_rcp_f32 v234, v234
    v_mfma_f32_16x16x32_bf16 v[44:47], v[24:27], a[124:127], v[44:47]
    ds_read_b64_tr_b16 v[24:25], v4 offset:32768
    v_mov_b64 v[96:97], 0
    v_mul_f32 v225, s40, v81
    v_mfma_f32_16x16x32_bf16 v[48:51], v[28:31], a[112:115], v[48:51]
    ds_read_b64_tr_b16 v[26:27], v4 offset:33280
    v_rcp_f32 v235, v235
    v_mfma_f32_16x16x32_bf16 v[52:55], v[28:31], a[116:119], v[52:55]
    s_add_u32 s81, s81, s74
    v_exp_f32 v236, v236
    v_mfma_f32_16x16x32_bf16 v[56:59], v[28:31], a[120:123], v[56:59]
    v_mov_b64 v[98:99], 0
    v_exp_f32 v237, v237
    v_mfma_f32_16x16x32_bf16 v[60:63], v[28:31], a[124:127], v[60:63]
    s_waitcnt lgkmcnt(2)
    ds_read_b64_tr_b16 v[28:29], v5 offset:32768
    v_mul_f32 v72, v232, v72
    v_mfma_f32_16x16x32_bf16 v[32:35], v[16:19], a[128:131], v[32:35]
    s_cmp_lt_u32 s79, 18
    ds_read_b64_tr_b16 v[30:31], v5 offset:33280
    v_mul_f32 v73, v233, v73
    v_mfma_f32_16x16x32_bf16 v[36:39], v[16:19], a[132:135], v[36:39]
    v_mov_b64 v[128:129], 0
    v_mul_f32 v74, v234, v74
    v_add_u32 v2, 40960, v2
    v_mfma_f32_16x16x32_bf16 v[40:43], v[16:19], a[136:139], v[40:43]
    s_cselect_b32 s81, s81, 2147479552
    v_exp_f32 v238, v238
    v_mfma_f32_16x16x32_bf16 v[44:47], v[16:19], a[140:143], v[44:47]
    ds_read_b64_tr_b16 v[16:17], v2 offset:0
    v_mov_b64 v[130:131], 0
    v_mul_f32 v75, v235, v75
    v_mfma_f32_16x16x32_bf16 v[48:51], v[20:23], a[128:131], v[48:51]
    buffer_load_dwordx4 a[32:35], v249, s[20:23], s81 offen offset:0 sc1
    ds_read_b64_tr_b16 v[18:19], v2 offset:512
    v_mul_f32 v226, s40, v82
    v_mfma_f32_16x16x32_bf16 v[52:55], v[20:23], a[132:135], v[52:55]
    v_mov_b64 v[132:133], 0
    v_mul_f32 v227, s40, v83
    v_add_u32 v3, 40960, v3
    v_mfma_f32_16x16x32_bf16 v[56:59], v[20:23], a[136:139], v[56:59]
    s_lshr_b32 s78, s78, 5
    v_exp_f32 v239, v239
    v_mfma_f32_16x16x32_bf16 v[60:63], v[20:23], a[140:143], v[60:63]
    s_waitcnt lgkmcnt(2)
    ds_read_b64_tr_b16 v[20:21], v3 offset:0
    v_add_f32 v236, 1.0, v236
    v_mfma_f32_16x16x32_bf16 v[32:35], v[24:27], a[144:147], v[32:35]
    ds_read_b64_tr_b16 v[22:23], v3 offset:512
    v_mov_b64 v[134:135], 0
    v_add_f32 v237, 1.0, v237
    v_mfma_f32_16x16x32_bf16 v[36:39], v[24:27], a[148:151], v[36:39]
    v_exp_f32 v224, v224
    v_add_u32 v4, 40960, v4
    v_mfma_f32_16x16x32_bf16 v[40:43], v[24:27], a[152:155], v[40:43]
    buffer_load_dwordx4 a[36:39], v250, s[20:23], s81 offen offset:0 sc1
    v_mov_b64 v[136:137], 0
    v_add_f32 v238, 1.0, v238
    v_mfma_f32_16x16x32_bf16 v[44:47], v[24:27], a[156:159], v[44:47]
    buffer_load_dwordx4 a[40:43], v249, s[20:23], s81 offen offset:1024 sc1
    ds_read_b64_tr_b16 v[24:25], v4 offset:0
    v_add_f32 v239, 1.0, v239
    v_mfma_f32_16x16x32_bf16 v[48:51], v[28:31], a[144:147], v[48:51]
    ds_read_b64_tr_b16 v[26:27], v4 offset:512
    v_mov_b64 v[138:139], 0
    v_mul_f32 v228, s40, v84
    v_mfma_f32_16x16x32_bf16 v[52:55], v[28:31], a[148:151], v[52:55]
    v_rcp_f32 v236, v236
    v_add_u32 v5, 40960, v5
    v_mfma_f32_16x16x32_bf16 v[56:59], v[28:31], a[152:155], v[56:59]
    buffer_load_dwordx4 a[44:47], v250, s[20:23], s81 offen offset:1024 sc1
    v_rcp_f32 v237, v237
    v_mfma_f32_16x16x32_bf16 v[60:63], v[28:31], a[156:159], v[60:63]
    s_waitcnt lgkmcnt(2)
    ds_read_b64_tr_b16 v[28:29], v5 offset:0
    v_mul_f32 v229, s40, v85
    v_mfma_f32_16x16x32_bf16 v[32:35], v[16:19], a[160:163], v[32:35]
    ds_read_b64_tr_b16 v[30:31], v5 offset:512
    v_mov_b64 v[140:141], 0
    v_mul_f32 v230, s40, v86
    v_mfma_f32_16x16x32_bf16 v[36:39], v[16:19], a[164:167], v[36:39]
    s_and_b32 s79, s78, 31
    v_mov_b64 v[142:143], 0
    v_mul_f32 v231, s40, v87
    v_mfma_f32_16x16x32_bf16 v[40:43], v[16:19], a[168:171], v[40:43]
    s_lshl_b32 s81, s79, 11
    v_rcp_f32 v238, v238
    v_mfma_f32_16x16x32_bf16 v[44:47], v[16:19], a[172:175], v[44:47]
    ds_read_b64_tr_b16 v[16:17], v2 offset:8192
    v_rcp_f32 v239, v239
    v_mfma_f32_16x16x32_bf16 v[48:51], v[20:23], a[160:163], v[48:51]
    ds_read_b64_tr_b16 v[18:19], v2 offset:8704
    v_mov_b64 v[144:145], 0
    v_mul_f32 v76, v236, v76
    v_mfma_f32_16x16x32_bf16 v[52:55], v[20:23], a[164:167], v[52:55]
    s_add_u32 s81, s81, s74
    v_exp_f32 v225, v225
    v_mfma_f32_16x16x32_bf16 v[56:59], v[20:23], a[168:171], v[56:59]
    s_cmp_lt_u32 s79, 18
    v_mov_b64 v[146:147], 0
    v_mul_f32 v77, v237, v77
    v_mfma_f32_16x16x32_bf16 v[60:63], v[20:23], a[172:175], v[60:63]
    s_waitcnt lgkmcnt(2)
    ds_read_b64_tr_b16 v[20:21], v3 offset:8192
    v_mul_f32 v78, v238, v78
    v_mfma_f32_16x16x32_bf16 v[32:35], v[24:27], a[176:179], v[32:35]
    ds_read_b64_tr_b16 v[22:23], v3 offset:8704
    v_exp_f32 v226, v226
    v_mfma_f32_16x16x32_bf16 v[36:39], v[24:27], a[180:183], v[36:39]
    s_cselect_b32 s81, s81, 2147479552
    v_exp_f32 v227, v227
    v_mfma_f32_16x16x32_bf16 v[40:43], v[24:27], a[184:187], v[40:43]
    v_mov_b64 v[148:149], 0
    v_exp_f32 v228, v228
    v_mfma_f32_16x16x32_bf16 v[44:47], v[24:27], a[188:191], v[44:47]
    buffer_load_dwordx4 a[48:51], v249, s[20:23], s81 offen offset:0 sc1
    ds_read_b64_tr_b16 v[24:25], v4 offset:8192
    s_waitcnt vmcnt(18)
    buffer_store_dword v254, off, s[20:23], s25 sc1
    v_mfma_f32_16x16x32_bf16 v[48:51], v[28:31], a[176:179], v[48:51]
    ds_read_b64_tr_b16 v[26:27], v4 offset:8704
    v_mov_b64 v[150:151], 0
    v_mul_f32 v79, v239, v79
    v_mfma_f32_16x16x32_bf16 v[52:55], v[28:31], a[180:183], v[52:55]
    s_lshr_b32 s78, s78, 5
    v_exp_f32 v229, v229
    v_mfma_f32_16x16x32_bf16 v[56:59], v[28:31], a[184:187], v[56:59]
    v_mov_b64 v[152:153], 0
    v_exp_f32 v230, v230
    v_mfma_f32_16x16x32_bf16 v[60:63], v[28:31], a[188:191], v[60:63]
    s_waitcnt lgkmcnt(2)
    ds_read_b64_tr_b16 v[28:29], v5 offset:8192
    v_add_f32 v224, 1.0, v224
    v_mfma_f32_16x16x32_bf16 v[32:35], v[16:19], a[192:195], v[32:35]
    ds_read_b64_tr_b16 v[30:31], v5 offset:8704
    v_mov_b64 v[154:155], 0
    v_add_f32 v225, 1.0, v225
    v_mfma_f32_16x16x32_bf16 v[36:39], v[16:19], a[196:199], v[36:39]
    buffer_load_dwordx4 a[52:55], v250, s[20:23], s81 offen offset:0 sc1
    v_exp_f32 v231, v231
    v_mfma_f32_16x16x32_bf16 v[40:43], v[16:19], a[200:203], v[40:43]
    buffer_load_dwordx4 a[56:59], v249, s[20:23], s81 offen offset:1024 sc1
    v_mov_b64 v[156:157], 0
    v_add_f32 v226, 1.0, v226
    v_mfma_f32_16x16x32_bf16 v[44:47], v[16:19], a[204:207], v[44:47]
    ds_read_b64_tr_b16 v[16:17], v2 offset:16384
    v_add_f32 v227, 1.0, v227
    v_add_f32 v228, 1.0, v228
    v_mfma_f32_16x16x32_bf16 v[48:51], v[20:23], a[192:195], v[48:51]
    ds_read_b64_tr_b16 v[18:19], v2 offset:16896
    v_mov_b64 v[158:159], 0
    v_add_f32 v229, 1.0, v229
    v_mfma_f32_16x16x32_bf16 v[52:55], v[20:23], a[196:199], v[52:55]
    buffer_load_dwordx4 a[60:63], v250, s[20:23], s81 offen offset:1024 sc1
    v_rcp_f32 v224, v224
    v_mfma_f32_16x16x32_bf16 v[56:59], v[20:23], a[200:203], v[56:59]
    s_and_b32 s79, s78, 31
    v_rcp_f32 v225, v225
    v_mfma_f32_16x16x32_bf16 v[60:63], v[20:23], a[204:207], v[60:63]
    s_waitcnt lgkmcnt(2)
    ds_read_b64_tr_b16 v[20:21], v3 offset:16384
    v_add_f32 v230, 1.0, v230
    v_mfma_f32_16x16x32_bf16 v[32:35], v[24:27], a[208:211], v[32:35]
    ds_read_b64_tr_b16 v[22:23], v3 offset:16896
    v_mov_b64 v[160:161], 0
    v_add_f32 v231, 1.0, v231
    v_mfma_f32_16x16x32_bf16 v[36:39], v[24:27], a[212:215], v[36:39]
    s_lshl_b32 s81, s79, 11
    v_rcp_f32 v226, v226
    v_mfma_f32_16x16x32_bf16 v[40:43], v[24:27], a[216:219], v[40:43]
    v_mov_b64 v[162:163], 0
    v_rcp_f32 v227, v227
    v_mfma_f32_16x16x32_bf16 v[44:47], v[24:27], a[220:223], v[44:47]
    s_add_u32 s81, s81, s74
    ds_read_b64_tr_b16 v[24:25], v4 offset:16384
    v_mul_f32 v80, v224, v80
    v_mfma_f32_16x16x32_bf16 v[48:51], v[28:31], a[208:211], v[48:51]
    ds_read_b64_tr_b16 v[26:27], v4 offset:16896
    v_mov_b64 v[164:165], 0
    v_mul_f32 v81, v225, v81
    v_mfma_f32_16x16x32_bf16 v[52:55], v[28:31], a[212:215], v[52:55]
    s_cmp_lt_u32 s79, 18
    v_rcp_f32 v228, v228
    v_mfma_f32_16x16x32_bf16 v[56:59], v[28:31], a[216:219], v[56:59]
    v_mov_b64 v[166:167], 0
    v_rcp_f32 v229, v229
    v_mfma_f32_16x16x32_bf16 v[60:63], v[28:31], a[220:223], v[60:63]
    s_waitcnt lgkmcnt(2)
    ds_read_b64_tr_b16 v[28:29], v5 offset:16384
    v_mul_f32 v82, v226, v82
    v_mfma_f32_16x16x32_bf16 v[32:35], v[16:19], a[224:227], v[32:35]
    ds_read_b64_tr_b16 v[30:31], v5 offset:16896
    v_rcp_f32 v230, v230
    v_mfma_f32_16x16x32_bf16 v[36:39], v[16:19], a[228:231], v[36:39]
    s_cselect_b32 s81, s81, 2147479552
    v_mov_b64 v[168:169], 0
    v_mul_f32 v83, v227, v83
    v_mfma_f32_16x16x32_bf16 v[40:43], v[16:19], a[232:235], v[40:43]
    buffer_load_dwordx4 a[64:67], v249, s[20:23], s81 offen offset:0 sc1
    v_rcp_f32 v231, v231
    v_mfma_f32_16x16x32_bf16 v[44:47], v[16:19], a[236:239], v[44:47]
    ds_read_b64_tr_b16 v[16:17], v2 offset:24576
    v_mov_b64 v[170:171], 0
    v_mul_f32 v84, v228, v84
    v_mfma_f32_16x16x32_bf16 v[48:51], v[20:23], a[224:227], v[48:51]
    ds_read_b64_tr_b16 v[18:19], v2 offset:25088
    v_mul_f32 v85, v229, v85
    v_mul_f32 v86, v230, v86
    v_mfma_f32_16x16x32_bf16 v[52:55], v[20:23], a[228:231], v[52:55]
    s_lshr_b32 s78, s78, 5
    v_mul_f32 v87, v231, v87
    v_mul_f32 v232, s40, v88
    v_mfma_f32_16x16x32_bf16 v[56:59], v[20:23], a[232:235], v[56:59]
    v_mov_b64 v[172:173], 0
    v_mul_f32 v233, s40, v89
    v_mul_f32 v234, s40, v90
    v_mfma_f32_16x16x32_bf16 v[60:63], v[20:23], a[236:239], v[60:63]
    s_waitcnt lgkmcnt(2)
    ds_read_b64_tr_b16 v[20:21], v3 offset:24576
    v_mul_f32 v235, s40, v91
    v_mfma_f32_16x16x32_bf16 v[32:35], v[24:27], a[240:243], v[32:35]
    buffer_load_dwordx4 a[68:71], v250, s[20:23], s81 offen offset:0 sc1
    ds_read_b64_tr_b16 v[22:23], v3 offset:25088
    v_mul_f32 v236, s40, v92
    v_mfma_f32_16x16x32_bf16 v[36:39], v[24:27], a[244:247], v[36:39]
    buffer_load_dwordx4 a[72:75], v249, s[20:23], s81 offen offset:1024 sc1
    v_mov_b64 v[174:175], 0
    v_mul_f32 v237, s40, v93
    v_mfma_f32_16x16x32_bf16 v[40:43], v[24:27], a[248:251], v[40:43]
    v_mov_b64 v[176:177], 0
    v_exp_f32 v232, v232
    v_mfma_f32_16x16x32_bf16 v[44:47], v[24:27], a[252:255], v[44:47]
    ds_read_b64_tr_b16 v[24:25], v4 offset:24576
    v_exp_f32 v233, v233
    v_mfma_f32_16x16x32_bf16 v[48:51], v[28:31], a[240:243], v[48:51]
    ds_read_b64_tr_b16 v[26:27], v4 offset:25088
    v_exp_f32 v234, v234
    v_mfma_f32_16x16x32_bf16 v[52:55], v[28:31], a[244:247], v[52:55]
    buffer_load_dwordx4 a[76:79], v250, s[20:23], s81 offen offset:1024 sc1
    v_exp_f32 v235, v235
    v_mfma_f32_16x16x32_bf16 v[56:59], v[28:31], a[248:251], v[56:59]
    v_mov_b64 v[178:179], 0
    v_add_f32 v232, 1.0, v232
    v_add_f32 v233, 1.0, v233
    v_mfma_f32_16x16x32_bf16 v[60:63], v[28:31], a[252:255], v[60:63]
    s_waitcnt lgkmcnt(2)
    ds_read_b64_tr_b16 v[28:29], v5 offset:24576
    v_add_f32 v234, 1.0, v234
    v_mfma_f32_16x16x32_bf16 v[32:35], v[16:19], v[192:195], v[32:35]
    ds_read_b64_tr_b16 v[30:31], v5 offset:25088
    v_mov_b64 v[180:181], 0
    v_add_f32 v235, 1.0, v235
    v_mfma_f32_16x16x32_bf16 v[36:39], v[16:19], v[196:199], v[36:39]
    v_mov_b64 v[182:183], 0
    v_rcp_f32 v232, v232
    v_mfma_f32_16x16x32_bf16 v[40:43], v[16:19], v[200:203], v[40:43]
    v_rcp_f32 v233, v233
    v_mul_f32 v238, s40, v94
    v_mfma_f32_16x16x32_bf16 v[44:47], v[16:19], v[204:207], v[44:47]
    v_rcp_f32 v234, v234
    v_mul_f32 v239, s40, v95
    v_mfma_f32_16x16x32_bf16 v[48:51], v[20:23], v[192:195], v[48:51]
    v_mov_b64 v[184:185], 0
    v_rcp_f32 v235, v235
    v_mfma_f32_16x16x32_bf16 v[52:55], v[20:23], v[196:199], v[52:55]
    v_exp_f32 v236, v236
    v_mul_f32 v88, v232, v88
    v_mfma_f32_16x16x32_bf16 v[56:59], v[20:23], v[200:203], v[56:59]
    v_mov_b64 v[186:187], 0
    v_exp_f32 v237, v237
    v_mfma_f32_16x16x32_bf16 v[60:63], v[20:23], v[204:207], v[60:63]
    s_waitcnt lgkmcnt(0)
    v_exp_f32 v238, v238
    v_mfma_f32_16x16x32_bf16 v[32:35], v[24:27], v[208:211], v[32:35]
    v_exp_f32 v239, v239
    v_mul_f32 v89, v233, v89
    v_mfma_f32_16x16x32_bf16 v[36:39], v[24:27], v[212:215], v[36:39]
    v_mov_b64 v[188:189], 0
    v_mul_f32 v90, v234, v90
    v_mul_f32 v91, v235, v91
    v_mfma_f32_16x16x32_bf16 v[40:43], v[24:27], v[216:219], v[40:43]
    v_add_f32 v236, 1.0, v236
    v_add_f32 v237, 1.0, v237
    v_add_f32 v238, 1.0, v238
    v_mfma_f32_16x16x32_bf16 v[44:47], v[24:27], v[220:223], v[44:47]
    v_mov_b64 v[190:191], 0
    v_add_f32 v239, 1.0, v239
    v_mfma_f32_16x16x32_bf16 v[48:51], v[28:31], v[208:211], v[48:51]
    v_rcp_f32 v236, v236
    v_mfma_f32_16x16x32_bf16 v[52:55], v[28:31], v[212:215], v[52:55]
    v_rcp_f32 v237, v237
    v_mfma_f32_16x16x32_bf16 v[56:59], v[28:31], v[216:219], v[56:59]
    v_rcp_f32 v238, v238
    v_mfma_f32_16x16x32_bf16 v[60:63], v[28:31], v[220:223], v[60:63]
    v_rcp_f32 v239, v239
    v_mul_f32 v92, v236, v92
    v_mul_f32 v93, v237, v93
    v_mul_f32 v94, v238, v94
    v_mul_f32 v95, v239, v95
    s_nop 4
    s_mul_i32 s35, s30, 18
    s_add_u32 s35, s35, s31
    s_add_u32 s35, s35, 14
    s_lshl_b32 s35, s35, 10
    s_add_u32 s44, s35, 11796480
    s_add_u32 s45, s44, 147456
    s_add_u32 s46, s44, 294912
    s_add_u32 s47, s44, 442368
    v_mul_f32 v32, v32, v64
    v_mul_f32 v33, v33, v65
    v_mul_f32 v34, v34, v66
    v_mul_f32 v35, v35, v67
    v_cvt_pk_bf16_f32 v224, v32, v33
    v_cvt_pk_bf16_f32 v225, v34, v35
    v_mul_f32 v48, v48, v80
    v_mul_f32 v49, v49, v81
    v_mul_f32 v50, v50, v82
    v_mul_f32 v51, v51, v83
    v_cvt_pk_bf16_f32 v226, v48, v49
    v_cvt_pk_bf16_f32 v227, v50, v51
    buffer_store_dwordx4 v[224:227], v14, s[20:23], s44 offen sc1
    v_mul_f32 v36, v36, v68
    v_mul_f32 v37, v37, v69
    v_mul_f32 v38, v38, v70
    v_mul_f32 v39, v39, v71
    v_cvt_pk_bf16_f32 v228, v36, v37
    v_cvt_pk_bf16_f32 v229, v38, v39
    v_mul_f32 v52, v52, v84
    v_mul_f32 v53, v53, v85
    v_mul_f32 v54, v54, v86
    v_mul_f32 v55, v55, v87
    v_cvt_pk_bf16_f32 v230, v52, v53
    v_cvt_pk_bf16_f32 v231, v54, v55
    buffer_store_dwordx4 v[228:231], v14, s[20:23], s45 offen sc1
    v_mul_f32 v40, v40, v72
    v_mul_f32 v41, v41, v73
    v_mul_f32 v42, v42, v74
    v_mul_f32 v43, v43, v75
    v_cvt_pk_bf16_f32 v232, v40, v41
    v_cvt_pk_bf16_f32 v233, v42, v43
    v_mul_f32 v56, v56, v88
    v_mul_f32 v57, v57, v89
    v_mul_f32 v58, v58, v90
    v_mul_f32 v59, v59, v91
    v_cvt_pk_bf16_f32 v234, v56, v57
    v_cvt_pk_bf16_f32 v235, v58, v59
    buffer_store_dwordx4 v[232:235], v14, s[20:23], s46 offen sc1
    v_mul_f32 v44, v44, v76
    v_mul_f32 v45, v45, v77
    v_mul_f32 v46, v46, v78
    v_mul_f32 v47, v47, v79
    v_cvt_pk_bf16_f32 v236, v44, v45
    v_cvt_pk_bf16_f32 v237, v46, v47
    v_mul_f32 v60, v60, v92
    v_mul_f32 v61, v61, v93
    v_mul_f32 v62, v62, v94
    v_mul_f32 v63, v63, v95
    v_cvt_pk_bf16_f32 v238, v60, v61
    v_cvt_pk_bf16_f32 v239, v62, v63
    buffer_store_dwordx4 v[236:239], v14, s[20:23], s47 offen sc1
    buffer_load_dword v245, v244, s[20:23], s26 offen sc1
    s_waitcnt vmcnt(17) lgkmcnt(0)
    s_barrier
    ds_read_b64_tr_b16 v[16:17], v10 offset:24576
    ds_read_b64_tr_b16 v[18:19], v10 offset:30720
    ds_read_b64_tr_b16 v[20:21], v11 offset:24576
    ds_read_b64_tr_b16 v[22:23], v11 offset:30720
    ds_read_b64_tr_b16 v[24:25], v13 offset:24576
    ds_read_b64_tr_b16 v[26:27], v13 offset:30720
    ds_read_b64_tr_b16 v[28:29], v15 offset:24576
    ds_read_b64_tr_b16 v[30:31], v15 offset:30720
    ds_read_b64_tr_b16 v[64:65], v10 offset:25600
    ds_read_b64_tr_b16 v[66:67], v10 offset:31744
    ds_read_b64_tr_b16 v[68:69], v11 offset:25600
    ds_read_b64_tr_b16 v[70:71], v11 offset:31744
    s_and_b32 s79, s6, 31
    s_mul_i32 s80, s79, 73728
    s_add_u32 s80, s80, s73
    s_cmp_lt_u32 s79, 18
    s_cselect_b32 s80, s80, 2147479552
    s_add_u32 m0, s72, 0
    s_nop 0
    buffer_load_dwordx4 v246, s[84:87], s80 offen offset:0 lds
    s_lshr_b32 s6, s6, 5
    buffer_load_dwordx4 v247, s[84:87], s80 offen offset:1024 lds
    buffer_load_dwordx4 v248, s[84:87], s80 offen offset:2048 lds
    s_add_u32 m0, s72, 12288
    s_nop 0
    s_add_u32 s80, s80, 36864
    buffer_load_dwordx4 v246, s[84:87], s80 offen offset:0 lds
    buffer_load_dwordx4 v247, s[84:87], s80 offen offset:1024 lds
    buffer_load_dwordx4 v248, s[84:87], s80 offen offset:2048 lds
    s_nop 0
    s_nop 0
    s_and_b32 s79, s6, 31
    s_mul_i32 s80, s79, 73728
    s_add_u32 s80, s80, s73
    s_cmp_lt_u32 s79, 18
    s_cselect_b32 s80, s80, 2147479552
    s_add_u32 m0, s72, 24576
    s_nop 0
    buffer_load_dwordx4 v246, s[84:87], s80 offen offset:0 lds
    s_lshr_b32 s6, s6, 5
    buffer_load_dwordx4 v247, s[84:87], s80 offen offset:1024 lds
    buffer_load_dwordx4 v248, s[84:87], s80 offen offset:2048 lds
    s_add_u32 m0, s72, 36864
    s_nop 0
    s_add_u32 s80, s80, 36864
    buffer_load_dwordx4 v246, s[84:87], s80 offen offset:0 lds
    buffer_load_dwordx4 v247, s[84:87], s80 offen offset:1024 lds
    buffer_load_dwordx4 v248, s[84:87], s80 offen offset:2048 lds
    s_nop 0
    s_nop 0
    s_waitcnt lgkmcnt(0)
    s_branch C_go
KF_zl:
    v_lshlrev_b32 v251, 4, v0
    v_lshrrev_b32 v1, 3, v0
    s_lshl_b32 s92, s33, 3
    v_add_u32 v1, s92, v1
    v_bfe_u32 v255, v1, 2, 2
    v_lshlrev_b32 v255, 3, v255
    v_lshrrev_b32 v253, 4, v1
    v_lshl_add_u32 v255, v253, 2, v255
    v_and_b32 v253, 3, v1
    v_add_u32 v255, v255, v253
    s_cmp_eq_u32 s68, 0
    s_cselect_b64 s[92:93], -1, 0
    v_cndmask_b32 v1, v255, v1, s[92:93]
    v_mul_u32_u24 v1, 1152, v1
    v_bfe_u32 v255, v0, 1, 2
    v_lshrrev_b32 v253, 4, v0
    v_xor_b32 v255, v255, v253
    v_lshl_add_u32 v1, v255, 5, v1
    v_and_b32 v255, 1, v0
    v_lshl_add_u32 v1, v255, 4, v1
    v_add_u32 v246, 2048, v1
    v_add_u32 v247, 1152, v1
    v_add_u32 v248, 256, v1
    s_lshl_b32 s92, s57, 3
    s_lshl_b32 s93, s33, 1
    s_add_u32 s92, s92, s93
    s_mul_i32 s93, s92, s7
    v_add_u32 v249, s93, v251
    v_add_u32 v250, s7, v249
    v_and_b32 v1, 7, v0
    v_lshlrev_b32 v1, 1, v1
    v_bfe_u32 v255, v0, 3, 1
    s_lshl_b32 s92, s92, 4
    v_add3_u32 v1, v1, v255, s92
    v_mul_u32_u24 v1, 1152, v1
    v_lshrrev_b32 v255, 4, v0
    v_lshl_add_u32 v1, v255, 3, v1
    s_lshl_b32 s92, s69, 5
    s_add_u32 s92, s92, s71
    v_add_u32 v252, s92, v1
    v_add_u32 v253, 18432, v252
    s_lshr_b32 s26, s83, 3
    s_max_u32 s26, s26, 1
    s_sub_u32 s26, s26, 1
    s_lshl_b32 s26, s26, 7
    s_add_u32 s26, s26, 50348032
    v_lshlrev_b32 v253, 2, v0
    s_lshr_b32 s3, s83, 3
    s_cmp_eq_u32 s3, 0
    s_movk_i32 s3, 255
    s_cselect_b32 s3, 127, s3
    v_and_b32 v253, s3, v253
    s_and_b32 s92, s83, 1
    s_lshl_b32 s92, s92, 10
    s_lshr_b32 s93, s83, 1
    s_lshl_b32 s93, s93, 5
    s_add_u32 s92, s92, s93
    s_mul_i32 s92, s92, 3456
    s_add_u32 s92, s92, 4694400
    s_add_u32 s92, s92, s66
    s_add_u32 s93, s92, 86400
    s_waitcnt lgkmcnt(4)
    v_mfma_f32_16x16x32_bf16 v[64:67], v[16:19], a[0:3], 0
    v_mfma_f32_16x16x32_bf16 v[68:71], v[16:19], a[4:7], 0
    v_lshlrev_b32 v224, 16, v32
    v_and_b32 v225, s41, v32
    v_mfma_f32_16x16x32_bf16 v[72:75], v[16:19], a[8:11], 0
    v_lshlrev_b32 v226, 16, v33
    v_and_b32 v227, s41, v33
    v_mfma_f32_16x16x32_bf16 v[76:79], v[16:19], a[12:15], 0
    ds_read_b64_tr_b16 v[16:17], v2 offset:8192
    v_lshlrev_b32 v228, 16, v40
    v_mfma_f32_16x16x32_bf16 v[80:83], v[20:23], a[0:3], 0
    ds_read_b64_tr_b16 v[18:19], v2 offset:8704
    v_and_b32 v229, s41, v40
    v_mfma_f32_16x16x32_bf16 v[84:87], v[20:23], a[4:7], 0
    v_lshlrev_b32 v230, 16, v41
    v_and_b32 v231, s41, v41
    v_mfma_f32_16x16x32_bf16 v[88:91], v[20:23], a[8:11], 0
    v_mul_f32 v224, v224, v128
    v_mul_f32 v225, v225, v129
    v_mfma_f32_16x16x32_bf16 v[92:95], v[20:23], a[12:15], 0
    s_waitcnt lgkmcnt(2)
    ds_read_b64_tr_b16 v[20:21], v3 offset:8192
    v_mfma_f32_16x16x32_bf16 v[64:67], v[24:27], a[16:19], v[64:67]
    ds_read_b64_tr_b16 v[22:23], v3 offset:8704
    v_mul_f32 v226, v226, v130
    v_mfma_f32_16x16x32_bf16 v[68:71], v[24:27], a[20:23], v[68:71]
    v_mul_f32 v227, v227, v131
    v_mul_f32 v228, v228, v144
    v_mfma_f32_16x16x32_bf16 v[72:75], v[24:27], a[24:27], v[72:75]
    v_mul_f32 v229, v229, v145
    v_mul_f32 v230, v230, v146
    v_mfma_f32_16x16x32_bf16 v[76:79], v[24:27], a[28:31], v[76:79]
    ds_read_b64_tr_b16 v[24:25], v4 offset:8192
    v_mul_f32 v231, v231, v147
    v_mfma_f32_16x16x32_bf16 v[80:83], v[28:31], a[16:19], v[80:83]
    ds_read_b64_tr_b16 v[26:27], v4 offset:8704
    v_cvt_pk_bf16_f32 v224, v224, v225
    v_mfma_f32_16x16x32_bf16 v[84:87], v[28:31], a[20:23], v[84:87]
    v_cvt_pk_bf16_f32 v225, v226, v227
    v_cvt_pk_bf16_f32 v226, v228, v229
    v_mfma_f32_16x16x32_bf16 v[88:91], v[28:31], a[24:27], v[88:91]
    v_cvt_pk_bf16_f32 v227, v230, v231
    v_lshlrev_b32 v232, 16, v34
    v_mfma_f32_16x16x32_bf16 v[92:95], v[28:31], a[28:31], v[92:95]
    s_waitcnt lgkmcnt(2)
    ds_read_b64_tr_b16 v[28:29], v5 offset:8192
    v_mfma_f32_16x16x32_bf16 v[64:67], v[16:19], a[32:35], v[64:67]
    ds_read_b64_tr_b16 v[30:31], v5 offset:8704
    v_and_b32 v233, s41, v34
    v_mfma_f32_16x16x32_bf16 v[68:71], v[16:19], a[36:39], v[68:71]
    buffer_store_dwordx4 v[224:227], v14, s[20:23], s44 offen offset:0 sc1
    v_mfma_f32_16x16x32_bf16 v[72:75], v[16:19], a[40:43], v[72:75]
    v_lshlrev_b32 v234, 16, v35
    v_and_b32 v235, s41, v35
    v_mfma_f32_16x16x32_bf16 v[76:79], v[16:19], a[44:47], v[76:79]
    ds_read_b64_tr_b16 v[16:17], v2 offset:16384
    v_lshlrev_b32 v236, 16, v42
    v_mfma_f32_16x16x32_bf16 v[80:83], v[20:23], a[32:35], v[80:83]
    ds_read_b64_tr_b16 v[18:19], v2 offset:16896
    v_and_b32 v237, s41, v42
    v_mfma_f32_16x16x32_bf16 v[84:87], v[20:23], a[36:39], v[84:87]
    v_lshlrev_b32 v238, 16, v43
    v_and_b32 v239, s41, v43
    v_mfma_f32_16x16x32_bf16 v[88:91], v[20:23], a[40:43], v[88:91]
    v_mul_f32 v232, v232, v132
    v_mul_f32 v233, v233, v133
    v_mfma_f32_16x16x32_bf16 v[92:95], v[20:23], a[44:47], v[92:95]
    s_waitcnt lgkmcnt(2)
    ds_read_b64_tr_b16 v[20:21], v3 offset:16384
    v_mfma_f32_16x16x32_bf16 v[64:67], v[24:27], a[48:51], v[64:67]
    ds_read_b64_tr_b16 v[22:23], v3 offset:16896
    v_mul_f32 v234, v234, v134
    v_mfma_f32_16x16x32_bf16 v[68:71], v[24:27], a[52:55], v[68:71]
    v_mul_f32 v235, v235, v135
    v_mul_f32 v236, v236, v148
    v_mfma_f32_16x16x32_bf16 v[72:75], v[24:27], a[56:59], v[72:75]
    v_mul_f32 v237, v237, v149
    v_mul_f32 v238, v238, v150
    v_mfma_f32_16x16x32_bf16 v[76:79], v[24:27], a[60:63], v[76:79]
    ds_read_b64_tr_b16 v[24:25], v4 offset:16384
    v_mul_f32 v239, v239, v151
    v_mfma_f32_16x16x32_bf16 v[80:83], v[28:31], a[48:51], v[80:83]
    ds_read_b64_tr_b16 v[26:27], v4 offset:16896
    v_cvt_pk_bf16_f32 v232, v232, v233
    v_mfma_f32_16x16x32_bf16 v[84:87], v[28:31], a[52:55], v[84:87]
    v_cvt_pk_bf16_f32 v233, v234, v235
    v_cvt_pk_bf16_f32 v234, v236, v237
    v_mfma_f32_16x16x32_bf16 v[88:91], v[28:31], a[56:59], v[88:91]
    v_cvt_pk_bf16_f32 v235, v238, v239
    v_lshlrev_b32 v224, 16, v36
    v_mfma_f32_16x16x32_bf16 v[92:95], v[28:31], a[60:63], v[92:95]
    s_waitcnt lgkmcnt(2)
    ds_read_b64_tr_b16 v[28:29], v5 offset:16384
    v_mfma_f32_16x16x32_bf16 v[64:67], v[16:19], a[64:67], v[64:67]
    ds_read_b64_tr_b16 v[30:31], v5 offset:16896
    v_and_b32 v225, s41, v36
    v_mfma_f32_16x16x32_bf16 v[68:71], v[16:19], a[68:71], v[68:71]
    buffer_store_dwordx4 v[232:235], v14, s[20:23], s45 offen offset:0 sc1
    v_mfma_f32_16x16x32_bf16 v[72:75], v[16:19], a[72:75], v[72:75]
    v_lshlrev_b32 v226, 16, v37
    v_and_b32 v227, s41, v37
    v_mfma_f32_16x16x32_bf16 v[76:79], v[16:19], a[76:79], v[76:79]
    ds_read_b64_tr_b16 v[16:17], v2 offset:24576
    v_lshlrev_b32 v228, 16, v44
    v_mfma_f32_16x16x32_bf16 v[80:83], v[20:23], a[64:67], v[80:83]
    ds_read_b64_tr_b16 v[18:19], v2 offset:25088
    v_and_b32 v229, s41, v44
    v_mfma_f32_16x16x32_bf16 v[84:87], v[20:23], a[68:71], v[84:87]
    v_lshlrev_b32 v230, 16, v45
    v_and_b32 v231, s41, v45
    v_mfma_f32_16x16x32_bf16 v[88:91], v[20:23], a[72:75], v[88:91]
    v_mul_f32 v224, v224, v136
    v_mul_f32 v225, v225, v137
    v_mfma_f32_16x16x32_bf16 v[92:95], v[20:23], a[76:79], v[92:95]
    s_waitcnt lgkmcnt(2)
    ds_read_b64_tr_b16 v[20:21], v3 offset:24576
    v_mfma_f32_16x16x32_bf16 v[64:67], v[24:27], a[80:83], v[64:67]
    ds_read_b64_tr_b16 v[22:23], v3 offset:25088
    v_mul_f32 v226, v226, v138
    v_mfma_f32_16x16x32_bf16 v[68:71], v[24:27], a[84:87], v[68:71]
    v_mul_f32 v227, v227, v139
    v_mul_f32 v228, v228, v152
    v_mfma_f32_16x16x32_bf16 v[72:75], v[24:27], a[88:91], v[72:75]
    v_mul_f32 v229, v229, v153
    v_mul_f32 v230, v230, v154
    v_mfma_f32_16x16x32_bf16 v[76:79], v[24:27], a[92:95], v[76:79]
    ds_read_b64_tr_b16 v[24:25], v4 offset:24576
    v_mul_f32 v231, v231, v155
    v_mfma_f32_16x16x32_bf16 v[80:83], v[28:31], a[80:83], v[80:83]
    ds_read_b64_tr_b16 v[26:27], v4 offset:25088
    v_cvt_pk_bf16_f32 v224, v224, v225
    v_mfma_f32_16x16x32_bf16 v[84:87], v[28:31], a[84:87], v[84:87]
    v_cvt_pk_bf16_f32 v225, v226, v227
    v_cvt_pk_bf16_f32 v226, v228, v229
    v_mfma_f32_16x16x32_bf16 v[88:91], v[28:31], a[88:91], v[88:91]
    v_cvt_pk_bf16_f32 v227, v230, v231
    v_lshlrev_b32 v232, 16, v38
    v_mfma_f32_16x16x32_bf16 v[92:95], v[28:31], a[92:95], v[92:95]
    s_waitcnt lgkmcnt(2)
    ds_read_b64_tr_b16 v[28:29], v5 offset:24576
    v_mfma_f32_16x16x32_bf16 v[64:67], v[16:19], a[96:99], v[64:67]
    ds_read_b64_tr_b16 v[30:31], v5 offset:25088
    v_and_b32 v233, s41, v38
    v_mfma_f32_16x16x32_bf16 v[68:71], v[16:19], a[100:103], v[68:71]
    buffer_store_dwordx4 v[224:227], v14, s[20:23], s46 offen offset:0 sc1
    v_mfma_f32_16x16x32_bf16 v[72:75], v[16:19], a[104:107], v[72:75]
    v_lshlrev_b32 v234, 16, v39
    v_and_b32 v235, s41, v39
    v_mfma_f32_16x16x32_bf16 v[76:79], v[16:19], a[108:111], v[76:79]
    ds_read_b64_tr_b16 v[16:17], v2 offset:32768
    v_lshlrev_b32 v236, 16, v46
    v_mfma_f32_16x16x32_bf16 v[80:83], v[20:23], a[96:99], v[80:83]
    ds_read_b64_tr_b16 v[18:19], v2 offset:33280
    v_and_b32 v237, s41, v46
    v_mfma_f32_16x16x32_bf16 v[84:87], v[20:23], a[100:103], v[84:87]
    v_lshlrev_b32 v238, 16, v47
    v_and_b32 v239, s41, v47
    v_mfma_f32_16x16x32_bf16 v[88:91], v[20:23], a[104:107], v[88:91]
    v_mul_f32 v232, v232, v140
    v_mul_f32 v233, v233, v141
    v_mfma_f32_16x16x32_bf16 v[92:95], v[20:23], a[108:111], v[92:95]
    s_waitcnt lgkmcnt(2)
    ds_read_b64_tr_b16 v[20:21], v3 offset:32768
    v_mfma_f32_16x16x32_bf16 v[64:67], v[24:27], a[112:115], v[64:67]
    ds_read_b64_tr_b16 v[22:23], v3 offset:33280
    v_mul_f32 v234, v234, v142
    v_mfma_f32_16x16x32_bf16 v[68:71], v[24:27], a[116:119], v[68:71]
    v_mul_f32 v235, v235, v143
    v_mul_f32 v236, v236, v156
    v_mfma_f32_16x16x32_bf16 v[72:75], v[24:27], a[120:123], v[72:75]
    v_mul_f32 v237, v237, v157
    v_mul_f32 v238, v238, v158
    v_mfma_f32_16x16x32_bf16 v[76:79], v[24:27], a[124:127], v[76:79]
    ds_read_b64_tr_b16 v[24:25], v4 offset:32768
    v_mul_f32 v239, v239, v159
    v_mfma_f32_16x16x32_bf16 v[80:83], v[28:31], a[112:115], v[80:83]
    ds_read_b64_tr_b16 v[26:27], v4 offset:33280
    buffer_load_dword v255, v253, s[20:23], s26 offen sc1
    v_cvt_pk_bf16_f32 v232, v232, v233
    v_mfma_f32_16x16x32_bf16 v[84:87], v[28:31], a[116:119], v[84:87]
    v_cvt_pk_bf16_f32 v233, v234, v235
    v_cvt_pk_bf16_f32 v234, v236, v237
    v_mfma_f32_16x16x32_bf16 v[88:91], v[28:31], a[120:123], v[88:91]
    v_cvt_pk_bf16_f32 v235, v238, v239
    v_lshlrev_b32 v224, 16, v48
    v_mfma_f32_16x16x32_bf16 v[92:95], v[28:31], a[124:127], v[92:95]
    s_waitcnt lgkmcnt(2)
    ds_read_b64_tr_b16 v[28:29], v5 offset:32768
    v_mfma_f32_16x16x32_bf16 v[64:67], v[16:19], a[128:131], v[64:67]
    ds_read_b64_tr_b16 v[30:31], v5 offset:33280
    v_and_b32 v225, s41, v48
    v_mfma_f32_16x16x32_bf16 v[68:71], v[16:19], a[132:135], v[68:71]
    v_lshlrev_b32 v226, 16, v49
    v_add_u32 v2, 40960, v2
    v_mfma_f32_16x16x32_bf16 v[72:75], v[16:19], a[136:139], v[72:75]
    buffer_store_dwordx4 v[232:235], v14, s[20:23], s47 offen offset:0 sc1
    v_mfma_f32_16x16x32_bf16 v[76:79], v[16:19], a[140:143], v[76:79]
    ds_read_b64_tr_b16 v[16:17], v2 offset:0
    v_and_b32 v227, s41, v49
    v_mfma_f32_16x16x32_bf16 v[80:83], v[20:23], a[128:131], v[80:83]
    ds_read_b64_tr_b16 v[18:19], v2 offset:512
    v_lshlrev_b32 v228, 16, v56
    v_mfma_f32_16x16x32_bf16 v[84:87], v[20:23], a[132:135], v[84:87]
    v_and_b32 v229, s41, v56
    v_add_u32 v3, 40960, v3
    v_mfma_f32_16x16x32_bf16 v[88:91], v[20:23], a[136:139], v[88:91]
    v_lshlrev_b32 v230, 16, v57
    v_and_b32 v231, s41, v57
    v_mfma_f32_16x16x32_bf16 v[92:95], v[20:23], a[140:143], v[92:95]
    s_waitcnt lgkmcnt(2)
    ds_read_b64_tr_b16 v[20:21], v3 offset:0
    v_mfma_f32_16x16x32_bf16 v[64:67], v[24:27], a[144:147], v[64:67]
    ds_read_b64_tr_b16 v[22:23], v3 offset:512
    v_mul_f32 v224, v224, v160
    v_mfma_f32_16x16x32_bf16 v[68:71], v[24:27], a[148:151], v[68:71]
    v_mul_f32 v225, v225, v161
    v_add_u32 v4, 40960, v4
    v_mfma_f32_16x16x32_bf16 v[72:75], v[24:27], a[152:155], v[72:75]
    v_mul_f32 v226, v226, v162
    v_mul_f32 v227, v227, v163
    v_mfma_f32_16x16x32_bf16 v[76:79], v[24:27], a[156:159], v[76:79]
    ds_read_b64_tr_b16 v[24:25], v4 offset:0
    v_mul_f32 v228, v228, v176
    v_mfma_f32_16x16x32_bf16 v[80:83], v[28:31], a[144:147], v[80:83]
    ds_read_b64_tr_b16 v[26:27], v4 offset:512
    v_mul_f32 v229, v229, v177
    v_mfma_f32_16x16x32_bf16 v[84:87], v[28:31], a[148:151], v[84:87]
    v_mul_f32 v230, v230, v178
    v_add_u32 v5, 40960, v5
    v_mfma_f32_16x16x32_bf16 v[88:91], v[28:31], a[152:155], v[88:91]
    v_mul_f32 v231, v231, v179
    v_lshlrev_b32 v232, 16, v50
    v_mfma_f32_16x16x32_bf16 v[92:95], v[28:31], a[156:159], v[92:95]
    s_waitcnt lgkmcnt(2)
    ds_read_b64_tr_b16 v[28:29], v5 offset:0
    v_mfma_f32_16x16x32_bf16 v[64:67], v[16:19], a[160:163], v[64:67]
    ds_read_b64_tr_b16 v[30:31], v5 offset:512
    v_cvt_pk_bf16_f32 v224, v224, v225
    v_mfma_f32_16x16x32_bf16 v[68:71], v[16:19], a[164:167], v[68:71]
    v_cvt_pk_bf16_f32 v225, v226, v227
    v_cvt_pk_bf16_f32 v226, v228, v229
    v_mfma_f32_16x16x32_bf16 v[72:75], v[16:19], a[168:171], v[72:75]
    v_cvt_pk_bf16_f32 v227, v230, v231
    v_and_b32 v233, s41, v50
    v_mfma_f32_16x16x32_bf16 v[76:79], v[16:19], a[172:175], v[76:79]
    ds_read_b64_tr_b16 v[16:17], v2 offset:8192
    v_lshlrev_b32 v234, 16, v51
    v_mfma_f32_16x16x32_bf16 v[80:83], v[20:23], a[160:163], v[80:83]
    ds_read_b64_tr_b16 v[18:19], v2 offset:8704
    v_and_b32 v235, s41, v51
    v_mfma_f32_16x16x32_bf16 v[84:87], v[20:23], a[164:167], v[84:87]
    buffer_store_dwordx4 v[224:227], v14, s[20:23], s44 offen offset:1024 sc1
    v_mfma_f32_16x16x32_bf16 v[88:91], v[20:23], a[168:171], v[88:91]
    v_lshlrev_b32 v236, 16, v58
    v_and_b32 v237, s41, v58
    v_mfma_f32_16x16x32_bf16 v[92:95], v[20:23], a[172:175], v[92:95]
    s_waitcnt lgkmcnt(2)
    ds_read_b64_tr_b16 v[20:21], v3 offset:8192
    v_mfma_f32_16x16x32_bf16 v[64:67], v[24:27], a[176:179], v[64:67]
    ds_read_b64_tr_b16 v[22:23], v3 offset:8704
    v_lshlrev_b32 v238, 16, v59
    v_mfma_f32_16x16x32_bf16 v[68:71], v[24:27], a[180:183], v[68:71]
    v_and_b32 v239, s41, v59
    v_lshlrev_b32 v224, 16, v52
    v_mfma_f32_16x16x32_bf16 v[72:75], v[24:27], a[184:187], v[72:75]
    v_mul_f32 v232, v232, v164
    v_mul_f32 v233, v233, v165
    v_mfma_f32_16x16x32_bf16 v[76:79], v[24:27], a[188:191], v[76:79]
    ds_read_b64_tr_b16 v[24:25], v4 offset:8192
    v_mul_f32 v234, v234, v166
    v_mfma_f32_16x16x32_bf16 v[80:83], v[28:31], a[176:179], v[80:83]
    ds_read_b64_tr_b16 v[26:27], v4 offset:8704
    v_mul_f32 v235, v235, v167
    v_mfma_f32_16x16x32_bf16 v[84:87], v[28:31], a[180:183], v[84:87]
    v_mul_f32 v236, v236, v180
    v_mul_f32 v237, v237, v181
    v_mfma_f32_16x16x32_bf16 v[88:91], v[28:31], a[184:187], v[88:91]
    v_mul_f32 v238, v238, v182
    v_mul_f32 v239, v239, v183
    v_mfma_f32_16x16x32_bf16 v[92:95], v[28:31], a[188:191], v[92:95]
    s_waitcnt lgkmcnt(2)
    ds_read_b64_tr_b16 v[28:29], v5 offset:8192
    v_mfma_f32_16x16x32_bf16 v[64:67], v[16:19], a[192:195], v[64:67]
    ds_read_b64_tr_b16 v[30:31], v5 offset:8704
    v_cvt_pk_bf16_f32 v232, v232, v233
    v_mfma_f32_16x16x32_bf16 v[68:71], v[16:19], a[196:199], v[68:71]
    v_cvt_pk_bf16_f32 v233, v234, v235
    v_cvt_pk_bf16_f32 v234, v236, v237
    v_mfma_f32_16x16x32_bf16 v[72:75], v[16:19], a[200:203], v[72:75]
    v_cvt_pk_bf16_f32 v235, v238, v239
    v_and_b32 v225, s41, v52
    v_mfma_f32_16x16x32_bf16 v[76:79], v[16:19], a[204:207], v[76:79]
    ds_read_b64_tr_b16 v[16:17], v2 offset:16384
    v_lshlrev_b32 v226, 16, v53
    v_mfma_f32_16x16x32_bf16 v[80:83], v[20:23], a[192:195], v[80:83]
    ds_read_b64_tr_b16 v[18:19], v2 offset:16896
    v_and_b32 v227, s41, v53
    v_mfma_f32_16x16x32_bf16 v[84:87], v[20:23], a[196:199], v[84:87]
    buffer_store_dwordx4 v[232:235], v14, s[20:23], s45 offen offset:1024 sc1
    v_mfma_f32_16x16x32_bf16 v[88:91], v[20:23], a[200:203], v[88:91]
    v_lshlrev_b32 v228, 16, v60
    v_and_b32 v229, s41, v60
    v_mfma_f32_16x16x32_bf16 v[92:95], v[20:23], a[204:207], v[92:95]
    s_waitcnt lgkmcnt(2)
    ds_read_b64_tr_b16 v[20:21], v3 offset:16384
    v_mfma_f32_16x16x32_bf16 v[64:67], v[24:27], a[208:211], v[64:67]
    ds_read_b64_tr_b16 v[22:23], v3 offset:16896
    v_lshlrev_b32 v230, 16, v61
    v_mfma_f32_16x16x32_bf16 v[68:71], v[24:27], a[212:215], v[68:71]
    v_and_b32 v231, s41, v61
    v_lshlrev_b32 v232, 16, v54
    v_mfma_f32_16x16x32_bf16 v[72:75], v[24:27], a[216:219], v[72:75]
    v_mul_f32 v224, v224, v168
    v_mul_f32 v225, v225, v169
    v_mfma_f32_16x16x32_bf16 v[76:79], v[24:27], a[220:223], v[76:79]
    ds_read_b64_tr_b16 v[24:25], v4 offset:16384
    v_mul_f32 v226, v226, v170
    v_mfma_f32_16x16x32_bf16 v[80:83], v[28:31], a[208:211], v[80:83]
    ds_read_b64_tr_b16 v[26:27], v4 offset:16896
    v_mul_f32 v227, v227, v171
    v_mfma_f32_16x16x32_bf16 v[84:87], v[28:31], a[212:215], v[84:87]
    v_mul_f32 v228, v228, v184
    v_mul_f32 v229, v229, v185
    v_mfma_f32_16x16x32_bf16 v[88:91], v[28:31], a[216:219], v[88:91]
    v_mul_f32 v230, v230, v186
    v_mul_f32 v231, v231, v187
    v_mfma_f32_16x16x32_bf16 v[92:95], v[28:31], a[220:223], v[92:95]
    s_waitcnt lgkmcnt(2)
    ds_read_b64_tr_b16 v[28:29], v5 offset:16384
    v_mfma_f32_16x16x32_bf16 v[64:67], v[16:19], a[224:227], v[64:67]
    ds_read_b64_tr_b16 v[30:31], v5 offset:16896
    v_cvt_pk_bf16_f32 v224, v224, v225
    v_mfma_f32_16x16x32_bf16 v[68:71], v[16:19], a[228:231], v[68:71]
    v_cvt_pk_bf16_f32 v225, v226, v227
    v_cvt_pk_bf16_f32 v226, v228, v229
    v_mfma_f32_16x16x32_bf16 v[72:75], v[16:19], a[232:235], v[72:75]
    v_cvt_pk_bf16_f32 v227, v230, v231
    v_and_b32 v233, s41, v54
    v_mfma_f32_16x16x32_bf16 v[76:79], v[16:19], a[236:239], v[76:79]
    ds_read_b64_tr_b16 v[16:17], v2 offset:24576
    v_lshlrev_b32 v234, 16, v55
    v_mfma_f32_16x16x32_bf16 v[80:83], v[20:23], a[224:227], v[80:83]
    ds_read_b64_tr_b16 v[18:19], v2 offset:25088
    v_and_b32 v235, s41, v55
    v_mfma_f32_16x16x32_bf16 v[84:87], v[20:23], a[228:231], v[84:87]
    buffer_store_dwordx4 v[224:227], v14, s[20:23], s46 offen offset:1024 sc1
    v_mfma_f32_16x16x32_bf16 v[88:91], v[20:23], a[232:235], v[88:91]
    v_lshlrev_b32 v236, 16, v62
    v_and_b32 v237, s41, v62
    v_mfma_f32_16x16x32_bf16 v[92:95], v[20:23], a[236:239], v[92:95]
    s_waitcnt lgkmcnt(2)
    ds_read_b64_tr_b16 v[20:21], v3 offset:24576
    v_mfma_f32_16x16x32_bf16 v[64:67], v[24:27], a[240:243], v[64:67]
    ds_read_b64_tr_b16 v[22:23], v3 offset:25088
    v_lshlrev_b32 v238, 16, v63
    v_mfma_f32_16x16x32_bf16 v[68:71], v[24:27], a[244:247], v[68:71]
    v_and_b32 v239, s41, v63
    v_mfma_f32_16x16x32_bf16 v[72:75], v[24:27], a[248:251], v[72:75]
    v_mul_f32 v232, v232, v172
    v_mul_f32 v233, v233, v173
    v_mfma_f32_16x16x32_bf16 v[76:79], v[24:27], a[252:255], v[76:79]
    ds_read_b64_tr_b16 v[24:25], v4 offset:24576
    v_mul_f32 v234, v234, v174
    v_mfma_f32_16x16x32_bf16 v[80:83], v[28:31], a[240:243], v[80:83]
    ds_read_b64_tr_b16 v[26:27], v4 offset:25088
    v_mul_f32 v235, v235, v175
    v_mfma_f32_16x16x32_bf16 v[84:87], v[28:31], a[244:247], v[84:87]
    v_mul_f32 v236, v236, v188
    v_mul_f32 v237, v237, v189
    v_mfma_f32_16x16x32_bf16 v[88:91], v[28:31], a[248:251], v[88:91]
    v_mul_f32 v238, v238, v190
    v_mul_f32 v239, v239, v191
    v_mfma_f32_16x16x32_bf16 v[92:95], v[28:31], a[252:255], v[92:95]
    s_waitcnt lgkmcnt(2)
    ds_read_b64_tr_b16 v[28:29], v5 offset:24576
    v_mfma_f32_16x16x32_bf16 v[64:67], v[16:19], v[192:195], v[64:67]
    ds_read_b64_tr_b16 v[30:31], v5 offset:25088
    v_cvt_pk_bf16_f32 v232, v232, v233
    v_mfma_f32_16x16x32_bf16 v[68:71], v[16:19], v[196:199], v[68:71]
    v_cvt_pk_bf16_f32 v233, v234, v235
    v_add_u32 v2, 0, v242
    v_mfma_f32_16x16x32_bf16 v[72:75], v[16:19], v[200:203], v[72:75]
    v_cvt_pk_bf16_f32 v234, v236, v237
    v_cvt_pk_bf16_f32 v235, v238, v239
    v_mfma_f32_16x16x32_bf16 v[76:79], v[16:19], v[204:207], v[76:79]
    ds_read_b64_tr_b16 v[16:17], v2 offset:0
    s_waitcnt vmcnt(4)
    s_mov_b32 s3, 0
    s_branch P_q_t
P_q:
    s_add_u32 s3, s3, 1
    s_cmp_gt_u32 s3, 1000000
    s_cbranch_scc1 P_q_ok
    buffer_load_dword v255, v253, s[20:23], s26 offen sc1
    s_waitcnt vmcnt(0)
P_q_t:
    v_cmp_ne_u32 vcc, s39, v255
    s_nop 1
    s_cmp_eq_u64 vcc, 0
    s_cbranch_scc1 P_q_ok
    s_branch P_q
P_q_ok:
    v_mfma_f32_16x16x32_bf16 v[80:83], v[20:23], v[192:195], v[80:83]
    s_add_u32 m0, s66, 73728
    ds_read_b64_tr_b16 v[18:19], v2 offset:512
    v_mfma_f32_16x16x32_bf16 v[84:87], v[20:23], v[196:199], v[84:87]
    v_add_u32 v3, 0, v243
    v_mfma_f32_16x16x32_bf16 v[88:91], v[20:23], v[200:203], v[88:91]
    buffer_store_dwordx4 v[232:235], v14, s[20:23], s47 offen offset:1024 sc1
    buffer_load_dwordx4 v251, s[20:23], s92 offen sc1 lds
    v_mfma_f32_16x16x32_bf16 v[92:95], v[20:23], v[204:207], v[92:95]
    s_waitcnt lgkmcnt(2)
    ds_read_b64_tr_b16 v[20:21], v3 offset:0
    v_mfma_f32_16x16x32_bf16 v[64:67], v[24:27], v[208:211], v[64:67]
    s_add_u32 s92, s92, 4096
    ds_read_b64_tr_b16 v[22:23], v3 offset:512
    v_mfma_f32_16x16x32_bf16 v[68:71], v[24:27], v[212:215], v[68:71]
    v_add_u32 v4, 4096, v242
    v_mfma_f32_16x16x32_bf16 v[72:75], v[24:27], v[216:219], v[72:75]
    s_add_u32 m0, s66, 77824
    v_mfma_f32_16x16x32_bf16 v[76:79], v[24:27], v[220:223], v[76:79]
    ds_read_b64_tr_b16 v[24:25], v4 offset:0
    v_mfma_f32_16x16x32_bf16 v[80:83], v[28:31], v[208:211], v[80:83]
    ds_read_b64_tr_b16 v[26:27], v4 offset:512
    v_mfma_f32_16x16x32_bf16 v[84:87], v[28:31], v[212:215], v[84:87]
    v_add_u32 v5, 4096, v243
    v_mfma_f32_16x16x32_bf16 v[88:91], v[28:31], v[216:219], v[88:91]
    buffer_load_dwordx4 v251, s[20:23], s92 offen sc1 lds
    v_mfma_f32_16x16x32_bf16 v[92:95], v[28:31], v[220:223], v[92:95]
    s_waitcnt lgkmcnt(2)
    ds_read_b64_tr_b16 v[28:29], v5 offset:0
    v_mfma_f32_16x16x32_bf16 v[32:35], v[16:19], a[0:3], 0
    s_add_u32 s92, s92, 4096
    ds_read_b64_tr_b16 v[30:31], v5 offset:512
    v_mfma_f32_16x16x32_bf16 v[36:39], v[16:19], a[4:7], 0
    s_add_u32 m0, s66, 81920
    v_mfma_f32_16x16x32_bf16 v[40:43], v[16:19], a[8:11], 0
    v_mfma_f32_16x16x32_bf16 v[44:47], v[16:19], a[12:15], 0
    ds_read_b64_tr_b16 v[16:17], v2 offset:8192
    v_mfma_f32_16x16x32_bf16 v[48:51], v[20:23], a[0:3], 0
    ds_read_b64_tr_b16 v[18:19], v2 offset:8704
    v_mul_f32 v224, s40, v64
    v_mfma_f32_16x16x32_bf16 v[52:55], v[20:23], a[4:7], 0
    buffer_load_dwordx4 v251, s[20:23], s92 offen sc1 lds
    v_mul_f32 v225, s40, v65
    v_mul_f32 v226, s40, v66
    v_mfma_f32_16x16x32_bf16 v[56:59], v[20:23], a[8:11], 0
    s_add_u32 s92, s92, 4096
    v_mul_f32 v227, s40, v67
    v_mul_f32 v228, s40, v68
    v_mfma_f32_16x16x32_bf16 v[60:63], v[20:23], a[12:15], 0
    s_waitcnt lgkmcnt(2)
    ds_read_b64_tr_b16 v[20:21], v3 offset:8192
    v_mfma_f32_16x16x32_bf16 v[32:35], v[24:27], a[16:19], v[32:35]
    ds_read_b64_tr_b16 v[22:23], v3 offset:8704
    v_exp_f32 v224, v224
    v_mfma_f32_16x16x32_bf16 v[36:39], v[24:27], a[20:23], v[36:39]
    s_add_u32 m0, s66, 86016
    v_exp_f32 v225, v225
    v_mfma_f32_16x16x32_bf16 v[40:43], v[24:27], a[24:27], v[40:43]
    buffer_load_dwordx4 v251, s[20:23], s92 offen sc1 lds
    v_mul_f32 v229, s40, v69
    v_mfma_f32_16x16x32_bf16 v[44:47], v[24:27], a[28:31], v[44:47]
    ds_read_b64_tr_b16 v[24:25], v4 offset:8192
    v_exp_f32 v226, v226
    v_mfma_f32_16x16x32_bf16 v[48:51], v[28:31], a[16:19], v[48:51]
    ds_read_b64_tr_b16 v[26:27], v4 offset:8704
    v_exp_f32 v227, v227
    v_mfma_f32_16x16x32_bf16 v[52:55], v[28:31], a[20:23], v[52:55]
    s_add_u32 s92, s92, 4096
    v_add_f32 v224, 1.0, v224
    v_mfma_f32_16x16x32_bf16 v[56:59], v[28:31], a[24:27], v[56:59]
    v_add_f32 v225, 1.0, v225
    v_add_f32 v226, 1.0, v226
    v_add_f32 v227, 1.0, v227
    v_mfma_f32_16x16x32_bf16 v[60:63], v[28:31], a[28:31], v[60:63]
    s_waitcnt lgkmcnt(2)
    ds_read_b64_tr_b16 v[28:29], v5 offset:8192
    v_mul_f32 v230, s40, v70
    v_mfma_f32_16x16x32_bf16 v[32:35], v[16:19], a[32:35], v[32:35]
    s_add_u32 m0, s66, 90112
    ds_read_b64_tr_b16 v[30:31], v5 offset:8704
    v_mfma_f32_16x16x32_bf16 v[36:39], v[16:19], a[36:39], v[36:39]
    buffer_load_dwordx4 v251, s[20:23], s92 offen sc1 lds
    v_rcp_f32 v224, v224
    v_mfma_f32_16x16x32_bf16 v[40:43], v[16:19], a[40:43], v[40:43]
    v_rcp_f32 v225, v225
    v_mul_f32 v231, s40, v71
    v_mfma_f32_16x16x32_bf16 v[44:47], v[16:19], a[44:47], v[44:47]
    s_add_u32 s92, s92, 4096
    ds_read_b64_tr_b16 v[16:17], v2 offset:16384
    v_mul_f32 v232, s40, v72
    v_mfma_f32_16x16x32_bf16 v[48:51], v[20:23], a[32:35], v[48:51]
    ds_read_b64_tr_b16 v[18:19], v2 offset:16896
    v_mul_f32 v233, s40, v73
    v_mfma_f32_16x16x32_bf16 v[52:55], v[20:23], a[36:39], v[52:55]
    s_add_u32 m0, s66, 94208
    v_rcp_f32 v226, v226
    v_mfma_f32_16x16x32_bf16 v[56:59], v[20:23], a[40:43], v[56:59]
    v_rcp_f32 v227, v227
    v_mul_f32 v234, s40, v74
    v_mfma_f32_16x16x32_bf16 v[60:63], v[20:23], a[44:47], v[60:63]
    s_waitcnt lgkmcnt(2)
    ds_read_b64_tr_b16 v[20:21], v3 offset:16384
    v_mfma_f32_16x16x32_bf16 v[32:35], v[24:27], a[48:51], v[32:35]
    ds_read_b64_tr_b16 v[22:23], v3 offset:16896
    v_exp_f32 v228, v228
    v_mfma_f32_16x16x32_bf16 v[36:39], v[24:27], a[52:55], v[36:39]
    buffer_load_dwordx4 v251, s[20:23], s92 offen sc1 lds
    v_exp_f32 v229, v229
    v_mfma_f32_16x16x32_bf16 v[40:43], v[24:27], a[56:59], v[40:43]
    s_add_u32 s92, s92, 4096
    v_mul_f32 v64, v224, v64
    v_mfma_f32_16x16x32_bf16 v[44:47], v[24:27], a[60:63], v[44:47]
    ds_read_b64_tr_b16 v[24:25], v4 offset:16384
    v_exp_f32 v230, v230
    v_mfma_f32_16x16x32_bf16 v[48:51], v[28:31], a[48:51], v[48:51]
    ds_read_b64_tr_b16 v[26:27], v4 offset:16896
    v_exp_f32 v231, v231
    v_mfma_f32_16x16x32_bf16 v[52:55], v[28:31], a[52:55], v[52:55]
    s_add_u32 m0, s66, 98304
    v_mul_f32 v65, v225, v65
    v_mfma_f32_16x16x32_bf16 v[56:59], v[28:31], a[56:59], v[56:59]
    buffer_load_dwordx4 v251, s[20:23], s92 offen sc1 lds
    v_mul_f32 v66, v226, v66
    v_mul_f32 v67, v227, v67
    v_mfma_f32_16x16x32_bf16 v[60:63], v[28:31], a[60:63], v[60:63]
    s_waitcnt lgkmcnt(2)
    ds_read_b64_tr_b16 v[28:29], v5 offset:16384
    v_add_f32 v228, 1.0, v228
    v_mfma_f32_16x16x32_bf16 v[32:35], v[16:19], a[64:67], v[32:35]
    ds_read_b64_tr_b16 v[30:31], v5 offset:16896
    v_add_f32 v229, 1.0, v229
    v_mfma_f32_16x16x32_bf16 v[36:39], v[16:19], a[68:71], v[36:39]
    s_add_u32 s92, s92, 4096
    v_add_f32 v230, 1.0, v230
    v_add_f32 v231, 1.0, v231
    v_mfma_f32_16x16x32_bf16 v[40:43], v[16:19], a[72:75], v[40:43]
    v_rcp_f32 v228, v228
    v_mul_f32 v235, s40, v75
    v_mfma_f32_16x16x32_bf16 v[44:47], v[16:19], a[76:79], v[44:47]
    s_add_u32 m0, s66, 102400
    ds_read_b64_tr_b16 v[16:17], v2 offset:24576
    v_mul_f32 v236, s40, v76
    v_mfma_f32_16x16x32_bf16 v[48:51], v[20:23], a[64:67], v[48:51]
    ds_read_b64_tr_b16 v[18:19], v2 offset:25088
    v_mul_f32 v237, s40, v77
    v_mfma_f32_16x16x32_bf16 v[52:55], v[20:23], a[68:71], v[52:55]
    buffer_load_dwordx4 v251, s[20:23], s92 offen sc1 lds
    v_rcp_f32 v229, v229
    v_mfma_f32_16x16x32_bf16 v[56:59], v[20:23], a[72:75], v[56:59]
    v_rcp_f32 v230, v230
    v_mul_f32 v238, s40, v78
    v_mfma_f32_16x16x32_bf16 v[60:63], v[20:23], a[76:79], v[60:63]
    s_waitcnt lgkmcnt(2)
    ds_read_b64_tr_b16 v[20:21], v3 offset:24576
    v_mfma_f32_16x16x32_bf16 v[32:35], v[24:27], a[80:83], v[32:35]
    s_add_u32 s92, s92, 4096
    ds_read_b64_tr_b16 v[22:23], v3 offset:25088
    v_mul_f32 v239, s40, v79
    v_mfma_f32_16x16x32_bf16 v[36:39], v[24:27], a[84:87], v[36:39]
    s_add_u32 m0, s66, 106496
    v_rcp_f32 v231, v231
    v_mfma_f32_16x16x32_bf16 v[40:43], v[24:27], a[88:91], v[40:43]
    v_exp_f32 v232, v232
    v_mfma_f32_16x16x32_bf16 v[44:47], v[24:27], a[92:95], v[44:47]
    ds_read_b64_tr_b16 v[24:25], v4 offset:24576
    v_exp_f32 v233, v233
    v_mfma_f32_16x16x32_bf16 v[48:51], v[28:31], a[80:83], v[48:51]
    ds_read_b64_tr_b16 v[26:27], v4 offset:25088
    v_exp_f32 v234, v234
    v_mfma_f32_16x16x32_bf16 v[52:55], v[28:31], a[84:87], v[52:55]
    buffer_load_dwordx4 v251, s[20:23], s92 offen sc1 lds
    v_mul_f32 v68, v228, v68
    v_mfma_f32_16x16x32_bf16 v[56:59], v[28:31], a[88:91], v[56:59]
    s_add_u32 s92, s92, 4096
    v_exp_f32 v235, v235
    v_mfma_f32_16x16x32_bf16 v[60:63], v[28:31], a[92:95], v[60:63]
    s_waitcnt lgkmcnt(2)
    ds_read_b64_tr_b16 v[28:29], v5 offset:24576
    v_mul_f32 v69, v229, v69
    v_mfma_f32_16x16x32_bf16 v[32:35], v[16:19], a[96:99], v[32:35]
    ds_read_b64_tr_b16 v[30:31], v5 offset:25088
    v_mul_f32 v70, v230, v70
    v_mfma_f32_16x16x32_bf16 v[36:39], v[16:19], a[100:103], v[36:39]
    s_add_u32 m0, s66, 110592
    v_exp_f32 v236, v236
    v_mfma_f32_16x16x32_bf16 v[40:43], v[16:19], a[104:107], v[40:43]
    buffer_load_dwordx4 v251, s[20:23], s92 offen sc1 lds
    v_exp_f32 v237, v237
    v_mfma_f32_16x16x32_bf16 v[44:47], v[16:19], a[108:111], v[44:47]
    ds_read_b64_tr_b16 v[16:17], v2 offset:32768
    v_exp_f32 v238, v238
    v_mfma_f32_16x16x32_bf16 v[48:51], v[20:23], a[96:99], v[48:51]
    ds_read_b64_tr_b16 v[18:19], v2 offset:33280
    v_mul_f32 v71, v231, v71
    v_mfma_f32_16x16x32_bf16 v[52:55], v[20:23], a[100:103], v[52:55]
    s_add_u32 s92, s92, 4096
    v_exp_f32 v239, v239
    v_mfma_f32_16x16x32_bf16 v[56:59], v[20:23], a[104:107], v[56:59]
    v_add_f32 v232, 1.0, v232
    v_add_f32 v233, 1.0, v233
    v_add_f32 v234, 1.0, v234
    v_mfma_f32_16x16x32_bf16 v[60:63], v[20:23], a[108:111], v[60:63]
    s_waitcnt lgkmcnt(2)
    ds_read_b64_tr_b16 v[20:21], v3 offset:32768
    v_mfma_f32_16x16x32_bf16 v[32:35], v[24:27], a[112:115], v[32:35]
    s_add_u32 m0, s66, 114688
    ds_read_b64_tr_b16 v[22:23], v3 offset:33280
    v_add_f32 v235, 1.0, v235
    v_mfma_f32_16x16x32_bf16 v[36:39], v[24:27], a[116:119], v[36:39]
    buffer_load_dwordx4 v251, s[20:23], s92 offen sc1 lds
    v_rcp_f32 v232, v232
    v_mfma_f32_16x16x32_bf16 v[40:43], v[24:27], a[120:123], v[40:43]
    v_rcp_f32 v233, v233
    v_mfma_f32_16x16x32_bf16 v[44:47], v[24:27], a[124:127], v[44:47]
    ds_read_b64_tr_b16 v[24:25], v4 offset:32768
    v_rcp_f32 v234, v234
    v_mfma_f32_16x16x32_bf16 v[48:51], v[28:31], a[112:115], v[48:51]
    ds_read_b64_tr_b16 v[26:27], v4 offset:33280
    v_rcp_f32 v235, v235
    v_mfma_f32_16x16x32_bf16 v[52:55], v[28:31], a[116:119], v[52:55]
    s_add_u32 s92, s92, 4096
    v_mul_f32 v72, v232, v72
    v_mfma_f32_16x16x32_bf16 v[56:59], v[28:31], a[120:123], v[56:59]
    s_add_u32 m0, s66, 118784
    v_mul_f32 v73, v233, v73
    v_mul_f32 v74, v234, v74
    v_mfma_f32_16x16x32_bf16 v[60:63], v[28:31], a[124:127], v[60:63]
    s_waitcnt lgkmcnt(2)
    ds_read_b64_tr_b16 v[28:29], v5 offset:32768
    v_mul_f32 v75, v235, v75
    v_mfma_f32_16x16x32_bf16 v[32:35], v[16:19], a[128:131], v[32:35]
    buffer_load_dwordx4 v251, s[20:23], s92 offen sc1 lds
    ds_read_b64_tr_b16 v[30:31], v5 offset:33280
    v_mfma_f32_16x16x32_bf16 v[36:39], v[16:19], a[132:135], v[36:39]
    v_add_f32 v236, 1.0, v236
    v_add_f32 v237, 1.0, v237
    v_add_u32 v2, 40960, v2
    v_mfma_f32_16x16x32_bf16 v[40:43], v[16:19], a[136:139], v[40:43]
    s_add_u32 s92, s92, 4096
    v_add_f32 v238, 1.0, v238
    v_add_f32 v239, 1.0, v239
    v_mfma_f32_16x16x32_bf16 v[44:47], v[16:19], a[140:143], v[44:47]
    ds_read_b64_tr_b16 v[16:17], v2 offset:0
    v_rcp_f32 v236, v236
    v_mfma_f32_16x16x32_bf16 v[48:51], v[20:23], a[128:131], v[48:51]
    ds_read_b64_tr_b16 v[18:19], v2 offset:512
    v_mul_f32 v224, s40, v80
    v_mfma_f32_16x16x32_bf16 v[52:55], v[20:23], a[132:135], v[52:55]
    v_rcp_f32 v237, v237
    v_add_u32 v3, 40960, v3
    v_mfma_f32_16x16x32_bf16 v[56:59], v[20:23], a[136:139], v[56:59]
    s_add_u32 m0, s66, 122880
    v_rcp_f32 v238, v238
    v_mfma_f32_16x16x32_bf16 v[60:63], v[20:23], a[140:143], v[60:63]
    s_waitcnt lgkmcnt(2)
    ds_read_b64_tr_b16 v[20:21], v3 offset:0
    v_mfma_f32_16x16x32_bf16 v[32:35], v[24:27], a[144:147], v[32:35]
    buffer_load_dwordx4 v251, s[20:23], s92 offen sc1 lds
    ds_read_b64_tr_b16 v[22:23], v3 offset:512
    v_mul_f32 v225, s40, v81
    v_mfma_f32_16x16x32_bf16 v[36:39], v[24:27], a[148:151], v[36:39]
    v_rcp_f32 v239, v239
    v_add_u32 v4, 40960, v4
    v_mfma_f32_16x16x32_bf16 v[40:43], v[24:27], a[152:155], v[40:43]
    s_add_u32 s92, s92, 4096
    v_mul_f32 v76, v236, v76
    v_mfma_f32_16x16x32_bf16 v[44:47], v[24:27], a[156:159], v[44:47]
    s_add_u32 m0, s66, 126976
    ds_read_b64_tr_b16 v[24:25], v4 offset:0
    v_mul_f32 v77, v237, v77
    v_mfma_f32_16x16x32_bf16 v[48:51], v[28:31], a[144:147], v[48:51]
    ds_read_b64_tr_b16 v[26:27], v4 offset:512
    v_mul_f32 v78, v238, v78
    v_mul_f32 v79, v239, v79
    v_mfma_f32_16x16x32_bf16 v[52:55], v[28:31], a[148:151], v[52:55]
    v_mul_f32 v226, s40, v82
    v_add_u32 v5, 40960, v5
    v_mfma_f32_16x16x32_bf16 v[56:59], v[28:31], a[152:155], v[56:59]
    buffer_load_dwordx4 v251, s[20:23], s92 offen sc1 lds
    v_mul_f32 v227, s40, v83
    v_mul_f32 v228, s40, v84
    v_mfma_f32_16x16x32_bf16 v[60:63], v[28:31], a[156:159], v[60:63]
    s_waitcnt lgkmcnt(2)
    ds_read_b64_tr_b16 v[28:29], v5 offset:0
    v_mul_f32 v229, s40, v85
    v_mfma_f32_16x16x32_bf16 v[32:35], v[16:19], a[160:163], v[32:35]
    ds_read_b64_tr_b16 v[30:31], v5 offset:512
    v_exp_f32 v224, v224
    v_mfma_f32_16x16x32_bf16 v[36:39], v[16:19], a[164:167], v[36:39]
    s_add_u32 s92, s92, 4096
    v_mul_f32 v230, s40, v86
    v_mfma_f32_16x16x32_bf16 v[40:43], v[16:19], a[168:171], v[40:43]
    s_add_u32 m0, s66, 131072
    v_exp_f32 v225, v225
    v_mfma_f32_16x16x32_bf16 v[44:47], v[16:19], a[172:175], v[44:47]
    ds_read_b64_tr_b16 v[16:17], v2 offset:8192
    v_exp_f32 v226, v226
    v_mfma_f32_16x16x32_bf16 v[48:51], v[20:23], a[160:163], v[48:51]
    ds_read_b64_tr_b16 v[18:19], v2 offset:8704
    v_mul_f32 v231, s40, v87
    v_mfma_f32_16x16x32_bf16 v[52:55], v[20:23], a[164:167], v[52:55]
    buffer_load_dwordx4 v251, s[20:23], s92 offen sc1 lds
    v_exp_f32 v227, v227
    v_mfma_f32_16x16x32_bf16 v[56:59], v[20:23], a[168:171], v[56:59]
    s_add_u32 s92, s92, 4096
    v_exp_f32 v228, v228
    v_mfma_f32_16x16x32_bf16 v[60:63], v[20:23], a[172:175], v[60:63]
    s_waitcnt lgkmcnt(2)
    ds_read_b64_tr_b16 v[20:21], v3 offset:8192
    v_mfma_f32_16x16x32_bf16 v[32:35], v[24:27], a[176:179], v[32:35]
    ds_read_b64_tr_b16 v[22:23], v3 offset:8704
    v_exp_f32 v229, v229
    v_mfma_f32_16x16x32_bf16 v[36:39], v[24:27], a[180:183], v[36:39]
    s_add_u32 m0, s66, 135168
    v_exp_f32 v230, v230
    v_mfma_f32_16x16x32_bf16 v[40:43], v[24:27], a[184:187], v[40:43]
    v_exp_f32 v231, v231
    v_mfma_f32_16x16x32_bf16 v[44:47], v[24:27], a[188:191], v[44:47]
    buffer_load_dwordx4 v251, s[20:23], s92 offen sc1 lds
    ds_read_b64_tr_b16 v[24:25], v4 offset:8192
    v_add_f32 v224, 1.0, v224
    v_mfma_f32_16x16x32_bf16 v[48:51], v[28:31], a[176:179], v[48:51]
    ds_read_b64_tr_b16 v[26:27], v4 offset:8704
    v_add_f32 v225, 1.0, v225
    v_add_f32 v226, 1.0, v226
    v_mfma_f32_16x16x32_bf16 v[52:55], v[28:31], a[180:183], v[52:55]
    s_add_u32 s92, s92, 4096
    v_add_f32 v227, 1.0, v227
    v_mfma_f32_16x16x32_bf16 v[56:59], v[28:31], a[184:187], v[56:59]
    v_rcp_f32 v224, v224
    v_add_f32 v228, 1.0, v228
    v_mfma_f32_16x16x32_bf16 v[60:63], v[28:31], a[188:191], v[60:63]
    s_waitcnt lgkmcnt(2)
    ds_read_b64_tr_b16 v[28:29], v5 offset:8192
    v_add_f32 v229, 1.0, v229
    v_mfma_f32_16x16x32_bf16 v[32:35], v[16:19], a[192:195], v[32:35]
    s_add_u32 m0, s66, 139264
    ds_read_b64_tr_b16 v[30:31], v5 offset:8704
    v_add_f32 v230, 1.0, v230
    v_mfma_f32_16x16x32_bf16 v[36:39], v[16:19], a[196:199], v[36:39]
    buffer_load_dwordx4 v251, s[20:23], s92 offen sc1 lds
    v_add_f32 v231, 1.0, v231
    v_mfma_f32_16x16x32_bf16 v[40:43], v[16:19], a[200:203], v[40:43]
    v_rcp_f32 v225, v225
    v_mul_f32 v232, s40, v88
    v_mfma_f32_16x16x32_bf16 v[44:47], v[16:19], a[204:207], v[44:47]
    ds_read_b64_tr_b16 v[16:17], v2 offset:16384
    v_rcp_f32 v226, v226
    v_mfma_f32_16x16x32_bf16 v[48:51], v[20:23], a[192:195], v[48:51]
    ds_read_b64_tr_b16 v[18:19], v2 offset:16896
    v_mul_f32 v233, s40, v89
    v_mfma_f32_16x16x32_bf16 v[52:55], v[20:23], a[196:199], v[52:55]
    s_add_u32 s92, s92, 4096
    v_rcp_f32 v227, v227
    v_mfma_f32_16x16x32_bf16 v[56:59], v[20:23], a[200:203], v[56:59]
    s_add_u32 m0, s66, 143360
    v_rcp_f32 v228, v228
    v_mfma_f32_16x16x32_bf16 v[60:63], v[20:23], a[204:207], v[60:63]
    s_waitcnt lgkmcnt(2)
    ds_read_b64_tr_b16 v[20:21], v3 offset:16384
    v_mfma_f32_16x16x32_bf16 v[32:35], v[24:27], a[208:211], v[32:35]
    ds_read_b64_tr_b16 v[22:23], v3 offset:16896
    v_rcp_f32 v229, v229
    v_mfma_f32_16x16x32_bf16 v[36:39], v[24:27], a[212:215], v[36:39]
    buffer_load_dwordx4 v251, s[20:23], s92 offen sc1 lds
    v_rcp_f32 v230, v230
    v_mfma_f32_16x16x32_bf16 v[40:43], v[24:27], a[216:219], v[40:43]
    s_add_u32 s92, s92, 4096
    v_mul_f32 v80, v224, v80
    v_mfma_f32_16x16x32_bf16 v[44:47], v[24:27], a[220:223], v[44:47]
    ds_read_b64_tr_b16 v[24:25], v4 offset:16384
    v_rcp_f32 v231, v231
    v_mfma_f32_16x16x32_bf16 v[48:51], v[28:31], a[208:211], v[48:51]
    ds_read_b64_tr_b16 v[26:27], v4 offset:16896
    v_mul_f32 v81, v225, v81
    v_mul_f32 v82, v226, v82
    v_mfma_f32_16x16x32_bf16 v[52:55], v[28:31], a[212:215], v[52:55]
    s_add_u32 m0, s66, 147456
    v_mul_f32 v83, v227, v83
    v_mfma_f32_16x16x32_bf16 v[56:59], v[28:31], a[216:219], v[56:59]
    v_mul_f32 v84, v228, v84
    v_mul_f32 v85, v229, v85
    v_mul_f32 v86, v230, v86
    v_mfma_f32_16x16x32_bf16 v[60:63], v[28:31], a[220:223], v[60:63]
    s_waitcnt lgkmcnt(2)
    ds_read_b64_tr_b16 v[28:29], v5 offset:16384
    v_mul_f32 v87, v231, v87
    v_mfma_f32_16x16x32_bf16 v[32:35], v[16:19], a[224:227], v[32:35]
    buffer_load_dwordx4 v251, s[20:23], s92 offen sc1 lds
    ds_read_b64_tr_b16 v[30:31], v5 offset:16896
    v_mul_f32 v234, s40, v90
    v_mfma_f32_16x16x32_bf16 v[36:39], v[16:19], a[228:231], v[36:39]
    s_add_u32 s92, s92, 4096
    v_mul_f32 v235, s40, v91
    v_mfma_f32_16x16x32_bf16 v[40:43], v[16:19], a[232:235], v[40:43]
    v_exp_f32 v232, v232
    v_mul_f32 v236, s40, v92
    v_mfma_f32_16x16x32_bf16 v[44:47], v[16:19], a[236:239], v[44:47]
    ds_read_b64_tr_b16 v[16:17], v2 offset:24576
    v_exp_f32 v233, v233
    v_mfma_f32_16x16x32_bf16 v[48:51], v[20:23], a[224:227], v[48:51]
    ds_read_b64_tr_b16 v[18:19], v2 offset:25088
    v_mul_f32 v237, s40, v93
    v_mfma_f32_16x16x32_bf16 v[52:55], v[20:23], a[228:231], v[52:55]
    s_add_u32 m0, s66, 151552
    v_exp_f32 v234, v234
    v_mfma_f32_16x16x32_bf16 v[56:59], v[20:23], a[232:235], v[56:59]
    buffer_load_dwordx4 v251, s[20:23], s92 offen sc1 lds
    v_exp_f32 v235, v235
    v_mfma_f32_16x16x32_bf16 v[60:63], v[20:23], a[236:239], v[60:63]
    s_waitcnt lgkmcnt(2)
    ds_read_b64_tr_b16 v[20:21], v3 offset:24576
    v_mfma_f32_16x16x32_bf16 v[32:35], v[24:27], a[240:243], v[32:35]
    ds_read_b64_tr_b16 v[22:23], v3 offset:25088
    v_add_f32 v232, 1.0, v232
    v_add_f32 v233, 1.0, v233
    v_mfma_f32_16x16x32_bf16 v[36:39], v[24:27], a[244:247], v[36:39]
    s_add_u32 s92, s92, 4096
    v_add_f32 v234, 1.0, v234
    v_add_f32 v235, 1.0, v235
    v_mfma_f32_16x16x32_bf16 v[40:43], v[24:27], a[248:251], v[40:43]
    s_add_u32 m0, s66, 155648
    v_mul_f32 v238, s40, v94
    v_mfma_f32_16x16x32_bf16 v[44:47], v[24:27], a[252:255], v[44:47]
    ds_read_b64_tr_b16 v[24:25], v4 offset:24576
    v_rcp_f32 v232, v232
    v_mfma_f32_16x16x32_bf16 v[48:51], v[28:31], a[240:243], v[48:51]
    ds_read_b64_tr_b16 v[26:27], v4 offset:25088
    v_rcp_f32 v233, v233
    v_mfma_f32_16x16x32_bf16 v[52:55], v[28:31], a[244:247], v[52:55]
    buffer_load_dwordx4 v251, s[20:23], s92 offen sc1 lds
    v_mul_f32 v239, s40, v95
    v_mfma_f32_16x16x32_bf16 v[56:59], v[28:31], a[248:251], v[56:59]
    v_rcp_f32 v234, v234
    v_mfma_f32_16x16x32_bf16 v[60:63], v[28:31], a[252:255], v[60:63]
    s_waitcnt lgkmcnt(2)
    ds_read_b64_tr_b16 v[28:29], v5 offset:24576
    v_mfma_f32_16x16x32_bf16 v[32:35], v[16:19], v[192:195], v[32:35]
    s_add_u32 s92, s92, 4096
    ds_read_b64_tr_b16 v[30:31], v5 offset:25088
    v_mfma_f32_16x16x32_bf16 v[36:39], v[16:19], v[196:199], v[36:39]
    s_add_u32 m0, s66, 159744
    v_mfma_f32_16x16x32_bf16 v[40:43], v[16:19], v[200:203], v[40:43]
    v_rcp_f32 v235, v235
    v_mfma_f32_16x16x32_bf16 v[44:47], v[16:19], v[204:207], v[44:47]
    buffer_load_dwordx4 v251, s[20:23], s92 offen sc1 lds
    v_exp_f32 v236, v236
    v_mfma_f32_16x16x32_bf16 v[48:51], v[20:23], v[192:195], v[48:51]
    v_exp_f32 v237, v237
    v_mfma_f32_16x16x32_bf16 v[52:55], v[20:23], v[196:199], v[52:55]
    s_add_u32 s92, s92, 4096
    v_exp_f32 v238, v238
    v_mfma_f32_16x16x32_bf16 v[56:59], v[20:23], v[200:203], v[56:59]
    v_exp_f32 v239, v239
    v_mul_f32 v88, v232, v88
    v_mfma_f32_16x16x32_bf16 v[60:63], v[20:23], v[204:207], v[60:63]
    s_waitcnt lgkmcnt(0)
    v_mul_f32 v89, v233, v89
    v_mfma_f32_16x16x32_bf16 v[32:35], v[24:27], v[208:211], v[32:35]
    v_mul_f32 v90, v234, v90
    v_mul_f32 v91, v235, v91
    v_add_f32 v236, 1.0, v236
    v_mfma_f32_16x16x32_bf16 v[36:39], v[24:27], v[212:215], v[36:39]
    v_add_f32 v237, 1.0, v237
    v_add_f32 v238, 1.0, v238
    v_add_f32 v239, 1.0, v239
    v_mfma_f32_16x16x32_bf16 v[40:43], v[24:27], v[216:219], v[40:43]
    v_rcp_f32 v236, v236
    v_mfma_f32_16x16x32_bf16 v[44:47], v[24:27], v[220:223], v[44:47]
    v_rcp_f32 v237, v237
    v_mfma_f32_16x16x32_bf16 v[48:51], v[28:31], v[208:211], v[48:51]
    v_rcp_f32 v238, v238
    v_mfma_f32_16x16x32_bf16 v[52:55], v[28:31], v[212:215], v[52:55]
    v_rcp_f32 v239, v239
    v_mfma_f32_16x16x32_bf16 v[56:59], v[28:31], v[216:219], v[56:59]
    v_mul_f32 v92, v236, v92
    v_mul_f32 v93, v237, v93
    v_mul_f32 v94, v238, v94
    v_mfma_f32_16x16x32_bf16 v[60:63], v[28:31], v[220:223], v[60:63]
    v_mul_f32 v95, v239, v95
    s_barrier
    s_add_u32 m0, s66, 0
    s_nop 0
    buffer_load_dwordx4 v251, s[20:23], s93 offen sc1 lds
    s_add_u32 s93, s93, 4096
    s_add_u32 m0, s66, 4096
    s_nop 0
    buffer_load_dwordx4 v251, s[20:23], s93 offen sc1 lds
    s_add_u32 s93, s93, 4096
    s_add_u32 m0, s66, 8192
    s_nop 0
    buffer_load_dwordx4 v251, s[20:23], s93 offen sc1 lds
    s_add_u32 s93, s93, 4096
    s_add_u32 m0, s66, 12288
    s_nop 0
    buffer_load_dwordx4 v251, s[20:23], s93 offen sc1 lds
    s_add_u32 s93, s93, 4096
    s_add_u32 m0, s66, 16384
    s_nop 0
    buffer_load_dwordx4 v251, s[20:23], s93 offen sc1 lds
    s_add_u32 s93, s93, 4096
    s_add_u32 m0, s66, 20480
    s_nop 0
    buffer_load_dwordx4 v251, s[20:23], s93 offen sc1 lds
    s_add_u32 s93, s93, 4096
    s_add_u32 m0, s66, 24576
    s_nop 0
    buffer_load_dwordx4 v251, s[20:23], s93 offen sc1 lds
    s_add_u32 s93, s93, 4096
    s_add_u32 m0, s66, 28672
    s_nop 0
    buffer_load_dwordx4 v251, s[20:23], s93 offen sc1 lds
    s_add_u32 s93, s93, 4096
    s_add_u32 m0, s66, 32768
    s_nop 0
    buffer_load_dwordx4 v251, s[20:23], s93 offen sc1 lds
    s_add_u32 s93, s93, 4096
    s_add_u32 m0, s66, 36864
    s_nop 0
    buffer_load_dwordx4 v251, s[20:23], s93 offen sc1 lds
    s_add_u32 s93, s93, 4096
    s_add_u32 m0, s66, 40960
    s_nop 0
    buffer_load_dwordx4 v251, s[20:23], s93 offen sc1 lds
    s_add_u32 s93, s93, 4096
    s_add_u32 m0, s66, 45056
    s_nop 0
    buffer_load_dwordx4 v251, s[20:23], s93 offen sc1 lds
    s_add_u32 s93, s93, 4096
    s_mul_i32 s35, s30, 18
    s_add_u32 s35, s35, s31
    s_add_u32 s35, s35, 14
    s_lshl_b32 s35, s35, 10
    s_add_u32 s44, s35, 11796480
    s_add_u32 s45, s44, 147456
    s_add_u32 s46, s44, 294912
    s_add_u32 s47, s44, 442368
    v_mul_f32 v32, v32, v64
    v_mul_f32 v33, v33, v65
    v_mul_f32 v34, v34, v66
    v_mul_f32 v35, v35, v67
    v_cvt_pk_bf16_f32 v224, v32, v33
    v_cvt_pk_bf16_f32 v225, v34, v35
    v_mul_f32 v48, v48, v80
    v_mul_f32 v49, v49, v81
    v_mul_f32 v50, v50, v82
    v_mul_f32 v51, v51, v83
    v_cvt_pk_bf16_f32 v226, v48, v49
    v_cvt_pk_bf16_f32 v227, v50, v51
    buffer_store_dwordx4 v[224:227], v14, s[20:23], s44 offen sc1
    v_mul_f32 v36, v36, v68
    v_mul_f32 v37, v37, v69
    v_mul_f32 v38, v38, v70
    v_mul_f32 v39, v39, v71
    v_cvt_pk_bf16_f32 v228, v36, v37
    v_cvt_pk_bf16_f32 v229, v38, v39
    v_mul_f32 v52, v52, v84
    v_mul_f32 v53, v53, v85
    v_mul_f32 v54, v54, v86
    v_mul_f32 v55, v55, v87
    v_cvt_pk_bf16_f32 v230, v52, v53
    v_cvt_pk_bf16_f32 v231, v54, v55
    buffer_store_dwordx4 v[228:231], v14, s[20:23], s45 offen sc1
    v_mul_f32 v40, v40, v72
    v_mul_f32 v41, v41, v73
    v_mul_f32 v42, v42, v74
    v_mul_f32 v43, v43, v75
    v_cvt_pk_bf16_f32 v232, v40, v41
    v_cvt_pk_bf16_f32 v233, v42, v43
    v_mul_f32 v56, v56, v88
    v_mul_f32 v57, v57, v89
    v_mul_f32 v58, v58, v90
    v_mul_f32 v59, v59, v91
    v_cvt_pk_bf16_f32 v234, v56, v57
    v_cvt_pk_bf16_f32 v235, v58, v59
    buffer_store_dwordx4 v[232:235], v14, s[20:23], s46 offen sc1
    v_mul_f32 v44, v44, v76
    v_mul_f32 v45, v45, v77
    v_mul_f32 v46, v46, v78
    v_mul_f32 v47, v47, v79
    v_cvt_pk_bf16_f32 v236, v44, v45
    v_cvt_pk_bf16_f32 v237, v46, v47
    v_mul_f32 v60, v60, v92
    v_mul_f32 v61, v61, v93
    v_mul_f32 v62, v62, v94
    v_mul_f32 v63, v63, v95
    v_cvt_pk_bf16_f32 v238, v60, v61
    v_cvt_pk_bf16_f32 v239, v62, v63
    buffer_store_dwordx4 v[236:239], v14, s[20:23], s47 offen sc1
    v_add_u32 v255, 2, v254
    v_lshrrev_b32 v2, 3, v0
    v_and_b32 v3, 7, v0
    v_mul_u32_u24 v3, 144, v3
    s_lshl_b32 s92, s33, 3
    v_add_u32 v2, s92, v2
    s_lshr_b32 s93, s83, 1
    s_lshl_b32 s93, s93, 5
    v_add_u32 v229, s93, v2
    v_add_u32 v4, 7, v2
    s_mov_b32 s94, 3456
    s_mov_b32 s95, 0x05040100
    s_mov_b32 s96, 0x07060302
    s_mov_b32 s97, 0x3eae1a93
    v_mov_b32 v6, 4294880896
    v_mov_b32 v7, 73728
    v_min_u32 v5, 0, v229
    v_sub_u32 v5, v4, v5
    v_cmp_gt_u32 vcc, 25, v5
    v_mad_u32_u24 v220, v5, s94, v3
    s_nop 0
    v_cndmask_b32 v5, v6, v7, vcc
    v_add_u32 v220, v220, v5
    v_min_u32 v5, 1, v229
    v_sub_u32 v5, v4, v5
    v_cmp_gt_u32 vcc, 25, v5
    v_mad_u32_u24 v221, v5, s94, v3
    s_nop 0
    v_cndmask_b32 v5, v6, v7, vcc
    v_add_u32 v221, v221, v5
    v_min_u32 v5, 2, v229
    v_sub_u32 v5, v4, v5
    v_cmp_gt_u32 vcc, 25, v5
    v_mad_u32_u24 v222, v5, s94, v3
    s_nop 0
    v_cndmask_b32 v5, v6, v7, vcc
    v_add_u32 v222, v222, v5
    v_min_u32 v5, 3, v229
    v_sub_u32 v5, v4, v5
    v_cmp_gt_u32 vcc, 25, v5
    v_mad_u32_u24 v223, v5, s94, v3
    s_nop 0
    v_cndmask_b32 v5, v6, v7, vcc
    v_add_u32 v223, v223, v5
    v_min_u32 v5, 4, v229
    v_sub_u32 v5, v4, v5
    v_cmp_gt_u32 vcc, 25, v5
    v_mad_u32_u24 v224, v5, s94, v3
    s_nop 0
    v_cndmask_b32 v5, v6, v7, vcc
    v_add_u32 v224, v224, v5
    v_min_u32 v5, 5, v229
    v_sub_u32 v5, v4, v5
    v_cmp_gt_u32 vcc, 25, v5
    v_mad_u32_u24 v225, v5, s94, v3
    s_nop 0
    v_cndmask_b32 v5, v6, v7, vcc
    v_add_u32 v225, v225, v5
    v_min_u32 v5, 6, v229
    v_sub_u32 v5, v4, v5
    v_cmp_gt_u32 vcc, 25, v5
    v_mad_u32_u24 v226, v5, s94, v3
    s_nop 0
    v_cndmask_b32 v5, v6, v7, vcc
    v_add_u32 v226, v226, v5
    v_min_u32 v5, 7, v229
    v_sub_u32 v5, v4, v5
    v_cmp_gt_u32 vcc, 25, v5
    v_mad_u32_u24 v227, v5, s94, v3
    s_nop 0
    v_cndmask_b32 v5, v6, v7, vcc
    v_add_u32 v227, v227, v5
    s_waitcnt vmcnt(0)
    buffer_store_dword v255, off, s[20:23], s25 sc1
    s_barrier
    v_lshlrev_b32 v5, 7, v0
    s_sub_u32 s28, s29, 8192
    s_sub_u32 s27, s29, 16384
    buffer_load_dword v240, v5, s[84:87], s27 offen
    buffer_load_dword v240, v5, s[84:87], s28 offen
    buffer_load_dword v240, v5, s[84:87], s29 offen
    ds_read_b128 v[8:11], v220 offset:0
    ds_read_b128 v[12:15], v220 offset:16
    ds_read_b128 v[16:19], v220 offset:32
    ds_read_b128 v[20:23], v220 offset:48
    ds_read_b128 v[24:27], v220 offset:64
    ds_read_b128 v[28:31], v220 offset:80
    ds_read_b128 v[32:35], v220 offset:96
    ds_read_b128 v[36:39], v220 offset:112
    ds_read_b128 v[40:43], v220 offset:128
    ds_read_b128 v[44:47], v220 offset:1152
    ds_read_b128 v[48:51], v220 offset:1168
    ds_read_b128 v[52:55], v220 offset:1184
    ds_read_b128 v[56:59], v220 offset:1200
    ds_read_b128 v[60:63], v220 offset:1216
    ds_read_b128 v[64:67], v220 offset:1232
    ds_read_b128 v[68:71], v220 offset:1248
    ds_read_b128 v[72:75], v220 offset:1264
    ds_read_b128 v[76:79], v220 offset:1280
    s_waitcnt lgkmcnt(0)
    ds_read_b128 v[80:83], v221 offset:1152
    v_dot2_f32_bf16 v116, v8, v44, 0
    v_dot2_f32_bf16 v124, v17, v53, 0
    v_dot2_f32_bf16 v132, v26, v62, 0
    v_dot2_f32_bf16 v140, v35, v71, 0
    ds_read_b128 v[84:87], v221 offset:1168
    v_dot2_f32_bf16 v116, v9, v45, v116
    v_dot2_f32_bf16 v124, v18, v54, v124
    v_dot2_f32_bf16 v132, v27, v63, v132
    v_dot2_f32_bf16 v140, v36, v72, v140
    ds_read_b128 v[88:91], v221 offset:1184
    v_dot2_f32_bf16 v116, v10, v46, v116
    v_dot2_f32_bf16 v124, v19, v55, v124
    v_dot2_f32_bf16 v132, v28, v64, v132
    v_dot2_f32_bf16 v140, v37, v73, v140
    ds_read_b128 v[92:95], v221 offset:1200
    v_dot2_f32_bf16 v116, v11, v47, v116
    v_dot2_f32_bf16 v124, v20, v56, v124
    v_dot2_f32_bf16 v132, v29, v65, v132
    v_dot2_f32_bf16 v140, v38, v74, v140
    ds_read_b128 v[96:99], v221 offset:1216
    v_dot2_f32_bf16 v116, v12, v48, v116
    v_dot2_f32_bf16 v124, v21, v57, v124
    v_dot2_f32_bf16 v132, v30, v66, v132
    v_dot2_f32_bf16 v140, v39, v75, v140
    ds_read_b128 v[100:103], v221 offset:1232
    v_dot2_f32_bf16 v116, v13, v49, v116
    v_dot2_f32_bf16 v124, v22, v58, v124
    v_dot2_f32_bf16 v132, v31, v67, v132
    v_dot2_f32_bf16 v140, v40, v76, v140
    ds_read_b128 v[104:107], v221 offset:1248
    v_dot2_f32_bf16 v116, v14, v50, v116
    v_dot2_f32_bf16 v124, v23, v59, v124
    v_dot2_f32_bf16 v132, v32, v68, v132
    v_dot2_f32_bf16 v140, v41, v77, v140
    ds_read_b128 v[108:111], v221 offset:1264
    v_dot2_f32_bf16 v116, v15, v51, v116
    v_dot2_f32_bf16 v124, v24, v60, v124
    v_dot2_f32_bf16 v132, v33, v69, v132
    v_dot2_f32_bf16 v140, v42, v78, v140
    ds_read_b128 v[112:115], v221 offset:1280
    v_dot2_f32_bf16 v116, v16, v52, v116
    v_dot2_f32_bf16 v124, v25, v61, v124
    v_dot2_f32_bf16 v132, v34, v70, v132
    v_dot2_f32_bf16 v140, v43, v79, v140
    s_waitcnt lgkmcnt(0)
    ds_read_b128 v[44:47], v222 offset:1152
    v_dot2_f32_bf16 v117, v8, v80, 0
    v_dot2_f32_bf16 v125, v17, v89, 0
    v_dot2_f32_bf16 v133, v26, v98, 0
    v_dot2_f32_bf16 v141, v35, v107, 0
    ds_read_b128 v[48:51], v222 offset:1168
    v_dot2_f32_bf16 v117, v9, v81, v117
    v_dot2_f32_bf16 v125, v18, v90, v125
    v_dot2_f32_bf16 v133, v27, v99, v133
    v_dot2_f32_bf16 v141, v36, v108, v141
    ds_read_b128 v[52:55], v222 offset:1184
    v_dot2_f32_bf16 v117, v10, v82, v117
    v_dot2_f32_bf16 v125, v19, v91, v125
    v_dot2_f32_bf16 v133, v28, v100, v133
    v_dot2_f32_bf16 v141, v37, v109, v141
    ds_read_b128 v[56:59], v222 offset:1200
    v_dot2_f32_bf16 v117, v11, v83, v117
    v_dot2_f32_bf16 v125, v20, v92, v125
    v_dot2_f32_bf16 v133, v29, v101, v133
    v_dot2_f32_bf16 v141, v38, v110, v141
    ds_read_b128 v[60:63], v222 offset:1216
    v_dot2_f32_bf16 v117, v12, v84, v117
    v_dot2_f32_bf16 v125, v21, v93, v125
    v_dot2_f32_bf16 v133, v30, v102, v133
    v_dot2_f32_bf16 v141, v39, v111, v141
    ds_read_b128 v[64:67], v222 offset:1232
    v_dot2_f32_bf16 v117, v13, v85, v117
    v_dot2_f32_bf16 v125, v22, v94, v125
    v_dot2_f32_bf16 v133, v31, v103, v133
    v_dot2_f32_bf16 v141, v40, v112, v141
    ds_read_b128 v[68:71], v222 offset:1248
    v_dot2_f32_bf16 v117, v14, v86, v117
    v_dot2_f32_bf16 v125, v23, v95, v125
    v_dot2_f32_bf16 v133, v32, v104, v133
    v_dot2_f32_bf16 v141, v41, v113, v141
    ds_read_b128 v[72:75], v222 offset:1264
    v_dot2_f32_bf16 v117, v15, v87, v117
    v_dot2_f32_bf16 v125, v24, v96, v125
    v_dot2_f32_bf16 v133, v33, v105, v133
    v_dot2_f32_bf16 v141, v42, v114, v141
    ds_read_b128 v[76:79], v222 offset:1280
    v_dot2_f32_bf16 v117, v16, v88, v117
    v_dot2_f32_bf16 v125, v25, v97, v125
    v_dot2_f32_bf16 v133, v34, v106, v133
    v_dot2_f32_bf16 v141, v43, v115, v141
    s_waitcnt lgkmcnt(0)
    ds_read_b128 v[80:83], v223 offset:1152
    v_dot2_f32_bf16 v118, v8, v44, 0
    v_dot2_f32_bf16 v126, v17, v53, 0
    v_dot2_f32_bf16 v134, v26, v62, 0
    v_dot2_f32_bf16 v142, v35, v71, 0
    ds_read_b128 v[84:87], v223 offset:1168
    v_dot2_f32_bf16 v118, v9, v45, v118
    v_dot2_f32_bf16 v126, v18, v54, v126
    v_dot2_f32_bf16 v134, v27, v63, v134
    v_dot2_f32_bf16 v142, v36, v72, v142
    ds_read_b128 v[88:91], v223 offset:1184
    v_dot2_f32_bf16 v118, v10, v46, v118
    v_dot2_f32_bf16 v126, v19, v55, v126
    v_dot2_f32_bf16 v134, v28, v64, v134
    v_dot2_f32_bf16 v142, v37, v73, v142
    ds_read_b128 v[92:95], v223 offset:1200
    v_dot2_f32_bf16 v118, v11, v47, v118
    v_dot2_f32_bf16 v126, v20, v56, v126
    v_dot2_f32_bf16 v134, v29, v65, v134
    v_dot2_f32_bf16 v142, v38, v74, v142
    ds_read_b128 v[96:99], v223 offset:1216
    v_dot2_f32_bf16 v118, v12, v48, v118
    v_dot2_f32_bf16 v126, v21, v57, v126
    v_dot2_f32_bf16 v134, v30, v66, v134
    v_dot2_f32_bf16 v142, v39, v75, v142
    ds_read_b128 v[100:103], v223 offset:1232
    v_dot2_f32_bf16 v118, v13, v49, v118
    v_dot2_f32_bf16 v126, v22, v58, v126
    v_dot2_f32_bf16 v134, v31, v67, v134
    v_dot2_f32_bf16 v142, v40, v76, v142
    ds_read_b128 v[104:107], v223 offset:1248
    v_dot2_f32_bf16 v118, v14, v50, v118
    v_dot2_f32_bf16 v126, v23, v59, v126
    v_dot2_f32_bf16 v134, v32, v68, v134
    v_dot2_f32_bf16 v142, v41, v77, v142
    ds_read_b128 v[108:111], v223 offset:1264
    v_dot2_f32_bf16 v118, v15, v51, v118
    v_dot2_f32_bf16 v126, v24, v60, v126
    v_dot2_f32_bf16 v134, v33, v69, v134
    v_dot2_f32_bf16 v142, v42, v78, v142
    ds_read_b128 v[112:115], v223 offset:1280
    v_dot2_f32_bf16 v118, v16, v52, v118
    v_dot2_f32_bf16 v126, v25, v61, v126
    v_dot2_f32_bf16 v134, v34, v70, v134
    v_dot2_f32_bf16 v142, v43, v79, v142
    s_waitcnt lgkmcnt(0)
    ds_read_b128 v[44:47], v224 offset:1152
    v_dot2_f32_bf16 v119, v8, v80, 0
    v_dot2_f32_bf16 v127, v17, v89, 0
    v_dot2_f32_bf16 v135, v26, v98, 0
    v_dot2_f32_bf16 v143, v35, v107, 0
    ds_read_b128 v[48:51], v224 offset:1168
    v_dot2_f32_bf16 v119, v9, v81, v119
    v_dot2_f32_bf16 v127, v18, v90, v127
    v_dot2_f32_bf16 v135, v27, v99, v135
    v_dot2_f32_bf16 v143, v36, v108, v143
    ds_read_b128 v[52:55], v224 offset:1184
    v_dot2_f32_bf16 v119, v10, v82, v119
    v_dot2_f32_bf16 v127, v19, v91, v127
    v_dot2_f32_bf16 v135, v28, v100, v135
    v_dot2_f32_bf16 v143, v37, v109, v143
    ds_read_b128 v[56:59], v224 offset:1200
    v_dot2_f32_bf16 v119, v11, v83, v119
    v_dot2_f32_bf16 v127, v20, v92, v127
    v_dot2_f32_bf16 v135, v29, v101, v135
    v_dot2_f32_bf16 v143, v38, v110, v143
    ds_read_b128 v[60:63], v224 offset:1216
    v_dot2_f32_bf16 v119, v12, v84, v119
    v_dot2_f32_bf16 v127, v21, v93, v127
    v_dot2_f32_bf16 v135, v30, v102, v135
    v_dot2_f32_bf16 v143, v39, v111, v143
    ds_read_b128 v[64:67], v224 offset:1232
    v_dot2_f32_bf16 v119, v13, v85, v119
    v_dot2_f32_bf16 v127, v22, v94, v127
    v_dot2_f32_bf16 v135, v31, v103, v135
    v_dot2_f32_bf16 v143, v40, v112, v143
    ds_read_b128 v[68:71], v224 offset:1248
    v_dot2_f32_bf16 v119, v14, v86, v119
    v_dot2_f32_bf16 v127, v23, v95, v127
    v_dot2_f32_bf16 v135, v32, v104, v135
    v_dot2_f32_bf16 v143, v41, v113, v143
    ds_read_b128 v[72:75], v224 offset:1264
    v_dot2_f32_bf16 v119, v15, v87, v119
    v_dot2_f32_bf16 v127, v24, v96, v127
    v_dot2_f32_bf16 v135, v33, v105, v135
    v_dot2_f32_bf16 v143, v42, v114, v143
    ds_read_b128 v[76:79], v224 offset:1280
    v_dot2_f32_bf16 v119, v16, v88, v119
    v_dot2_f32_bf16 v127, v25, v97, v127
    v_dot2_f32_bf16 v135, v34, v106, v135
    v_dot2_f32_bf16 v143, v43, v115, v143
    s_waitcnt lgkmcnt(0)
    ds_read_b128 v[80:83], v225 offset:1152
    v_dot2_f32_bf16 v120, v8, v44, 0
    v_dot2_f32_bf16 v128, v17, v53, 0
    v_dot2_f32_bf16 v136, v26, v62, 0
    v_dot2_f32_bf16 v144, v35, v71, 0
    ds_read_b128 v[84:87], v225 offset:1168
    v_dot2_f32_bf16 v120, v9, v45, v120
    v_dot2_f32_bf16 v128, v18, v54, v128
    v_dot2_f32_bf16 v136, v27, v63, v136
    v_dot2_f32_bf16 v144, v36, v72, v144
    ds_read_b128 v[88:91], v225 offset:1184
    v_dot2_f32_bf16 v120, v10, v46, v120
    v_dot2_f32_bf16 v128, v19, v55, v128
    v_dot2_f32_bf16 v136, v28, v64, v136
    v_dot2_f32_bf16 v144, v37, v73, v144
    ds_read_b128 v[92:95], v225 offset:1200
    v_dot2_f32_bf16 v120, v11, v47, v120
    v_dot2_f32_bf16 v128, v20, v56, v128
    v_dot2_f32_bf16 v136, v29, v65, v136
    v_dot2_f32_bf16 v144, v38, v74, v144
    ds_read_b128 v[96:99], v225 offset:1216
    v_dot2_f32_bf16 v120, v12, v48, v120
    v_dot2_f32_bf16 v128, v21, v57, v128
    v_dot2_f32_bf16 v136, v30, v66, v136
    v_dot2_f32_bf16 v144, v39, v75, v144
    ds_read_b128 v[100:103], v225 offset:1232
    v_dot2_f32_bf16 v120, v13, v49, v120
    v_dot2_f32_bf16 v128, v22, v58, v128
    v_dot2_f32_bf16 v136, v31, v67, v136
    v_dot2_f32_bf16 v144, v40, v76, v144
    ds_read_b128 v[104:107], v225 offset:1248
    v_dot2_f32_bf16 v120, v14, v50, v120
    v_dot2_f32_bf16 v128, v23, v59, v128
    v_dot2_f32_bf16 v136, v32, v68, v136
    v_dot2_f32_bf16 v144, v41, v77, v144
    ds_read_b128 v[108:111], v225 offset:1264
    v_dot2_f32_bf16 v120, v15, v51, v120
    v_dot2_f32_bf16 v128, v24, v60, v128
    v_dot2_f32_bf16 v136, v33, v69, v136
    v_dot2_f32_bf16 v144, v42, v78, v144
    ds_read_b128 v[112:115], v225 offset:1280
    v_dot2_f32_bf16 v120, v16, v52, v120
    v_dot2_f32_bf16 v128, v25, v61, v128
    v_dot2_f32_bf16 v136, v34, v70, v136
    v_dot2_f32_bf16 v144, v43, v79, v144
    s_waitcnt lgkmcnt(0)
    ds_read_b128 v[44:47], v226 offset:1152
    v_dot2_f32_bf16 v121, v8, v80, 0
    v_dot2_f32_bf16 v129, v17, v89, 0
    v_dot2_f32_bf16 v137, v26, v98, 0
    v_dot2_f32_bf16 v145, v35, v107, 0
    ds_read_b128 v[48:51], v226 offset:1168
    v_dot2_f32_bf16 v121, v9, v81, v121
    v_dot2_f32_bf16 v129, v18, v90, v129
    v_dot2_f32_bf16 v137, v27, v99, v137
    v_dot2_f32_bf16 v145, v36, v108, v145
    ds_read_b128 v[52:55], v226 offset:1184
    v_dot2_f32_bf16 v121, v10, v82, v121
    v_dot2_f32_bf16 v129, v19, v91, v129
    v_dot2_f32_bf16 v137, v28, v100, v137
    v_dot2_f32_bf16 v145, v37, v109, v145
    ds_read_b128 v[56:59], v226 offset:1200
    v_dot2_f32_bf16 v121, v11, v83, v121
    v_dot2_f32_bf16 v129, v20, v92, v129
    v_dot2_f32_bf16 v137, v29, v101, v137
    v_dot2_f32_bf16 v145, v38, v110, v145
    ds_read_b128 v[60:63], v226 offset:1216
    v_dot2_f32_bf16 v121, v12, v84, v121
    v_dot2_f32_bf16 v129, v21, v93, v129
    v_dot2_f32_bf16 v137, v30, v102, v137
    v_dot2_f32_bf16 v145, v39, v111, v145
    ds_read_b128 v[64:67], v226 offset:1232
    v_dot2_f32_bf16 v121, v13, v85, v121
    v_dot2_f32_bf16 v129, v22, v94, v129
    v_dot2_f32_bf16 v137, v31, v103, v137
    v_dot2_f32_bf16 v145, v40, v112, v145
    ds_read_b128 v[68:71], v226 offset:1248
    v_dot2_f32_bf16 v121, v14, v86, v121
    v_dot2_f32_bf16 v129, v23, v95, v129
    v_dot2_f32_bf16 v137, v32, v104, v137
    v_dot2_f32_bf16 v145, v41, v113, v145
    ds_read_b128 v[72:75], v226 offset:1264
    v_dot2_f32_bf16 v121, v15, v87, v121
    v_dot2_f32_bf16 v129, v24, v96, v129
    v_dot2_f32_bf16 v137, v33, v105, v137
    v_dot2_f32_bf16 v145, v42, v114, v145
    ds_read_b128 v[76:79], v226 offset:1280
    v_dot2_f32_bf16 v121, v16, v88, v121
    v_dot2_f32_bf16 v129, v25, v97, v129
    v_dot2_f32_bf16 v137, v34, v106, v137
    v_dot2_f32_bf16 v145, v43, v115, v145
    s_waitcnt lgkmcnt(0)
    ds_read_b128 v[80:83], v227 offset:1152
    v_dot2_f32_bf16 v122, v8, v44, 0
    v_dot2_f32_bf16 v130, v17, v53, 0
    v_dot2_f32_bf16 v138, v26, v62, 0
    v_dot2_f32_bf16 v146, v35, v71, 0
    ds_read_b128 v[84:87], v227 offset:1168
    v_dot2_f32_bf16 v122, v9, v45, v122
    v_dot2_f32_bf16 v130, v18, v54, v130
    v_dot2_f32_bf16 v138, v27, v63, v138
    v_dot2_f32_bf16 v146, v36, v72, v146
    ds_read_b128 v[88:91], v227 offset:1184
    v_dot2_f32_bf16 v122, v10, v46, v122
    v_dot2_f32_bf16 v130, v19, v55, v130
    v_dot2_f32_bf16 v138, v28, v64, v138
    v_dot2_f32_bf16 v146, v37, v73, v146
    ds_read_b128 v[92:95], v227 offset:1200
    v_dot2_f32_bf16 v122, v11, v47, v122
    v_dot2_f32_bf16 v130, v20, v56, v130
    v_dot2_f32_bf16 v138, v29, v65, v138
    v_dot2_f32_bf16 v146, v38, v74, v146
    ds_read_b128 v[96:99], v227 offset:1216
    v_dot2_f32_bf16 v122, v12, v48, v122
    v_dot2_f32_bf16 v130, v21, v57, v130
    v_dot2_f32_bf16 v138, v30, v66, v138
    v_dot2_f32_bf16 v146, v39, v75, v146
    ds_read_b128 v[100:103], v227 offset:1232
    v_dot2_f32_bf16 v122, v13, v49, v122
    v_dot2_f32_bf16 v130, v22, v58, v130
    v_dot2_f32_bf16 v138, v31, v67, v138
    v_dot2_f32_bf16 v146, v40, v76, v146
    ds_read_b128 v[104:107], v227 offset:1248
    v_dot2_f32_bf16 v122, v14, v50, v122
    v_dot2_f32_bf16 v130, v23, v59, v130
    v_dot2_f32_bf16 v138, v32, v68, v138
    v_dot2_f32_bf16 v146, v41, v77, v146
    ds_read_b128 v[108:111], v227 offset:1264
    v_dot2_f32_bf16 v122, v15, v51, v122
    v_dot2_f32_bf16 v130, v24, v60, v130
    v_dot2_f32_bf16 v138, v33, v69, v138
    v_dot2_f32_bf16 v146, v42, v78, v146
    ds_read_b128 v[112:115], v227 offset:1280
    v_dot2_f32_bf16 v122, v16, v52, v122
    v_dot2_f32_bf16 v130, v25, v61, v130
    v_dot2_f32_bf16 v138, v34, v70, v138
    v_dot2_f32_bf16 v146, v43, v79, v146
    s_waitcnt lgkmcnt(0)
    ds_read_b128 v[44:47], v220 offset:2304
    v_dot2_f32_bf16 v123, v8, v80, 0
    v_dot2_f32_bf16 v131, v17, v89, 0
    v_dot2_f32_bf16 v139, v26, v98, 0
    v_dot2_f32_bf16 v147, v35, v107, 0
    ds_read_b128 v[48:51], v220 offset:2320
    v_dot2_f32_bf16 v123, v9, v81, v123
    v_dot2_f32_bf16 v131, v18, v90, v131
    v_dot2_f32_bf16 v139, v27, v99, v139
    v_dot2_f32_bf16 v147, v36, v108, v147
    ds_read_b128 v[52:55], v220 offset:2336
    v_dot2_f32_bf16 v123, v10, v82, v123
    v_dot2_f32_bf16 v131, v19, v91, v131
    v_dot2_f32_bf16 v139, v28, v100, v139
    v_dot2_f32_bf16 v147, v37, v109, v147
    ds_read_b128 v[56:59], v220 offset:2352
    v_dot2_f32_bf16 v123, v11, v83, v123
    v_dot2_f32_bf16 v131, v20, v92, v131
    v_dot2_f32_bf16 v139, v29, v101, v139
    v_dot2_f32_bf16 v147, v38, v110, v147
    ds_read_b128 v[60:63], v220 offset:2368
    v_dot2_f32_bf16 v123, v12, v84, v123
    v_dot2_f32_bf16 v131, v21, v93, v131
    v_dot2_f32_bf16 v139, v30, v102, v139
    v_dot2_f32_bf16 v147, v39, v111, v147
    ds_read_b128 v[64:67], v220 offset:2384
    v_dot2_f32_bf16 v123, v13, v85, v123
    v_dot2_f32_bf16 v131, v22, v94, v131
    v_dot2_f32_bf16 v139, v31, v103, v139
    v_dot2_f32_bf16 v147, v40, v112, v147
    ds_read_b128 v[68:71], v220 offset:2400
    v_dot2_f32_bf16 v123, v14, v86, v123
    v_dot2_f32_bf16 v131, v23, v95, v131
    v_dot2_f32_bf16 v139, v32, v104, v139
    v_dot2_f32_bf16 v147, v41, v113, v147
    ds_read_b128 v[72:75], v220 offset:2416
    v_dot2_f32_bf16 v123, v15, v87, v123
    v_dot2_f32_bf16 v131, v24, v96, v131
    v_dot2_f32_bf16 v139, v33, v105, v139
    v_dot2_f32_bf16 v147, v42, v114, v147
    ds_read_b128 v[76:79], v220 offset:2432
    v_dot2_f32_bf16 v123, v16, v88, v123
    v_dot2_f32_bf16 v131, v25, v97, v131
    v_dot2_f32_bf16 v139, v34, v106, v139
    v_dot2_f32_bf16 v147, v43, v115, v147
    ds_read_b128 v[80:83], v221 offset:2304
    ds_read_b128 v[84:87], v221 offset:2320
    ds_read_b128 v[88:91], v221 offset:2336
    ds_read_b128 v[92:95], v221 offset:2352
    ds_read_b128 v[96:99], v221 offset:2368
    ds_read_b128 v[100:103], v221 offset:2384
    ds_read_b128 v[104:107], v221 offset:2400
    ds_read_b128 v[108:111], v221 offset:2416
    ds_read_b128 v[112:115], v221 offset:2432
    v_mov_b32 v5, 0xff800000
    v_cmp_le_u32 vcc, 1, v229
    s_nop 1
    v_cndmask_b32 v117, v5, v117, vcc
    v_cndmask_b32 v125, v5, v125, vcc
    v_cndmask_b32 v133, v5, v133, vcc
    v_cndmask_b32 v141, v5, v141, vcc
    v_cmp_le_u32 vcc, 2, v229
    s_nop 1
    v_cndmask_b32 v118, v5, v118, vcc
    v_cndmask_b32 v126, v5, v126, vcc
    v_cndmask_b32 v134, v5, v134, vcc
    v_cndmask_b32 v142, v5, v142, vcc
    v_cmp_le_u32 vcc, 3, v229
    s_nop 1
    v_cndmask_b32 v119, v5, v119, vcc
    v_cndmask_b32 v127, v5, v127, vcc
    v_cndmask_b32 v135, v5, v135, vcc
    v_cndmask_b32 v143, v5, v143, vcc
    v_cmp_le_u32 vcc, 4, v229
    s_nop 1
    v_cndmask_b32 v120, v5, v120, vcc
    v_cndmask_b32 v128, v5, v128, vcc
    v_cndmask_b32 v136, v5, v136, vcc
    v_cndmask_b32 v144, v5, v144, vcc
    v_cmp_le_u32 vcc, 5, v229
    s_nop 1
    v_cndmask_b32 v121, v5, v121, vcc
    v_cndmask_b32 v129, v5, v129, vcc
    v_cndmask_b32 v137, v5, v137, vcc
    v_cndmask_b32 v145, v5, v145, vcc
    v_cmp_le_u32 vcc, 6, v229
    s_nop 1
    v_cndmask_b32 v122, v5, v122, vcc
    v_cndmask_b32 v130, v5, v130, vcc
    v_cndmask_b32 v138, v5, v138, vcc
    v_cndmask_b32 v146, v5, v146, vcc
    v_cmp_le_u32 vcc, 7, v229
    s_nop 1
    v_cndmask_b32 v123, v5, v123, vcc
    v_cndmask_b32 v131, v5, v131, vcc
    v_cndmask_b32 v139, v5, v139, vcc
    v_cndmask_b32 v147, v5, v147, vcc
    v_max3_f32 v8, v116, v117, v118
    v_max3_f32 v9, v124, v125, v126
    v_max3_f32 v10, v132, v133, v134
    v_max3_f32 v11, v140, v141, v142
    v_max3_f32 v8, v8, v119, v120
    v_max3_f32 v9, v9, v127, v128
    v_max3_f32 v10, v10, v135, v136
    v_max3_f32 v11, v11, v143, v144
    v_max3_f32 v8, v8, v121, v122
    v_max3_f32 v9, v9, v129, v130
    v_max3_f32 v10, v10, v137, v138
    v_max3_f32 v11, v11, v145, v146
    v_max_f32 v8, v8, v123
    v_max_f32 v9, v9, v131
    v_max_f32 v10, v10, v139
    v_max_f32 v11, v11, v147
    v_mul_f32 v8, s97, v8
    v_mul_f32 v9, s97, v9
    v_mul_f32 v10, s97, v10
    v_mul_f32 v11, s97, v11
    v_fma_f32 v116, v116, s97, -v8
    v_fma_f32 v117, v117, s97, -v8
    v_fma_f32 v118, v118, s97, -v8
    v_fma_f32 v119, v119, s97, -v8
    v_fma_f32 v120, v120, s97, -v8
    v_fma_f32 v121, v121, s97, -v8
    v_fma_f32 v122, v122, s97, -v8
    v_fma_f32 v123, v123, s97, -v8
    v_fma_f32 v124, v124, s97, -v9
    v_fma_f32 v125, v125, s97, -v9
    v_fma_f32 v126, v126, s97, -v9
    v_fma_f32 v127, v127, s97, -v9
    v_fma_f32 v128, v128, s97, -v9
    v_fma_f32 v129, v129, s97, -v9
    v_fma_f32 v130, v130, s97, -v9
    v_fma_f32 v131, v131, s97, -v9
    v_fma_f32 v132, v132, s97, -v10
    v_fma_f32 v133, v133, s97, -v10
    v_fma_f32 v134, v134, s97, -v10
    v_fma_f32 v135, v135, s97, -v10
    v_fma_f32 v136, v136, s97, -v10
    v_fma_f32 v137, v137, s97, -v10
    v_fma_f32 v138, v138, s97, -v10
    v_fma_f32 v139, v139, s97, -v10
    v_fma_f32 v140, v140, s97, -v11
    v_fma_f32 v141, v141, s97, -v11
    v_fma_f32 v142, v142, s97, -v11
    v_fma_f32 v143, v143, s97, -v11
    v_fma_f32 v144, v144, s97, -v11
    v_fma_f32 v145, v145, s97, -v11
    v_fma_f32 v146, v146, s97, -v11
    v_fma_f32 v147, v147, s97, -v11
    v_exp_f32 v116, v116
    v_exp_f32 v117, v117
    v_exp_f32 v118, v118
    v_exp_f32 v119, v119
    v_exp_f32 v120, v120
    v_exp_f32 v121, v121
    v_exp_f32 v122, v122
    v_exp_f32 v123, v123
    v_exp_f32 v124, v124
    v_exp_f32 v125, v125
    v_exp_f32 v126, v126
    v_exp_f32 v127, v127
    v_exp_f32 v128, v128
    v_exp_f32 v129, v129
    v_exp_f32 v130, v130
    v_exp_f32 v131, v131
    v_exp_f32 v132, v132
    v_exp_f32 v133, v133
    v_exp_f32 v134, v134
    v_exp_f32 v135, v135
    v_exp_f32 v136, v136
    v_exp_f32 v137, v137
    v_exp_f32 v138, v138
    v_exp_f32 v139, v139
    v_exp_f32 v140, v140
    v_exp_f32 v141, v141
    v_exp_f32 v142, v142
    v_exp_f32 v143, v143
    v_exp_f32 v144, v144
    v_exp_f32 v145, v145
    v_exp_f32 v146, v146
    v_exp_f32 v147, v147
    v_add_f32 v8, v116, v117
    v_add_f32 v9, v124, v125
    v_add_f32 v10, v132, v133
    v_add_f32 v11, v140, v141
    v_add_f32 v8, v8, v118
    v_add_f32 v9, v9, v126
    v_add_f32 v10, v10, v134
    v_add_f32 v11, v11, v142
    v_add_f32 v8, v8, v119
    v_add_f32 v9, v9, v127
    v_add_f32 v10, v10, v135
    v_add_f32 v11, v11, v143
    v_add_f32 v8, v8, v120
    v_add_f32 v9, v9, v128
    v_add_f32 v10, v10, v136
    v_add_f32 v11, v11, v144
    v_add_f32 v8, v8, v121
    v_add_f32 v9, v9, v129
    v_add_f32 v10, v10, v137
    v_add_f32 v11, v11, v145
    v_add_f32 v8, v8, v122
    v_add_f32 v9, v9, v130
    v_add_f32 v10, v10, v138
    v_add_f32 v11, v11, v146
    v_add_f32 v8, v8, v123
    v_add_f32 v9, v9, v131
    v_add_f32 v10, v10, v139
    v_add_f32 v11, v11, v147
    v_rcp_f32 v8, v8
    v_rcp_f32 v9, v9
    v_rcp_f32 v10, v10
    v_rcp_f32 v11, v11
    s_nop 0
    v_mul_f32 v116, v116, v8
    v_mul_f32 v117, v117, v8
    v_mul_f32 v118, v118, v8
    v_mul_f32 v119, v119, v8
    v_mul_f32 v120, v120, v8
    v_mul_f32 v121, v121, v8
    v_mul_f32 v122, v122, v8
    v_mul_f32 v123, v123, v8
    v_mul_f32 v124, v124, v9
    v_mul_f32 v125, v125, v9
    v_mul_f32 v126, v126, v9
    v_mul_f32 v127, v127, v9
    v_mul_f32 v128, v128, v9
    v_mul_f32 v129, v129, v9
    v_mul_f32 v130, v130, v9
    v_mul_f32 v131, v131, v9
    v_mul_f32 v132, v132, v10
    v_mul_f32 v133, v133, v10
    v_mul_f32 v134, v134, v10
    v_mul_f32 v135, v135, v10
    v_mul_f32 v136, v136, v10
    v_mul_f32 v137, v137, v10
    v_mul_f32 v138, v138, v10
    v_mul_f32 v139, v139, v10
    v_mul_f32 v140, v140, v11
    v_mul_f32 v141, v141, v11
    v_mul_f32 v142, v142, v11
    v_mul_f32 v143, v143, v11
    v_mul_f32 v144, v144, v11
    v_mul_f32 v145, v145, v11
    v_mul_f32 v146, v146, v11
    v_mul_f32 v147, v147, v11
    v_cvt_pk_bf16_f32 v116, v116, v117
    v_cvt_pk_bf16_f32 v117, v118, v119
    v_cvt_pk_bf16_f32 v118, v120, v121
    v_cvt_pk_bf16_f32 v119, v122, v123
    v_cvt_pk_bf16_f32 v124, v124, v125
    v_cvt_pk_bf16_f32 v125, v126, v127
    v_cvt_pk_bf16_f32 v126, v128, v129
    v_cvt_pk_bf16_f32 v127, v130, v131
    v_cvt_pk_bf16_f32 v132, v132, v133
    v_cvt_pk_bf16_f32 v133, v134, v135
    v_cvt_pk_bf16_f32 v134, v136, v137
    v_cvt_pk_bf16_f32 v135, v138, v139
    v_cvt_pk_bf16_f32 v140, v140, v141
    v_cvt_pk_bf16_f32 v141, v142, v143
    v_cvt_pk_bf16_f32 v142, v144, v145
    v_cvt_pk_bf16_f32 v143, v146, v147
    s_waitcnt lgkmcnt(0)
    v_perm_b32 v230, v80, v44, s95
    v_perm_b32 v234, v80, v44, s96
    v_perm_b32 v231, v81, v45, s95
    v_perm_b32 v235, v81, v45, s96
    v_perm_b32 v232, v82, v46, s95
    v_perm_b32 v236, v82, v46, s96
    v_perm_b32 v233, v83, v47, s95
    v_perm_b32 v237, v83, v47, s96
    ds_read_b128 v[44:47], v222 offset:2304
    ds_read_b128 v[80:83], v223 offset:2304
    v_dot2_f32_bf16 v148, v230, v116, 0
    v_dot2_f32_bf16 v149, v234, v116, 0
    v_dot2_f32_bf16 v150, v231, v116, 0
    v_dot2_f32_bf16 v151, v235, v116, 0
    v_dot2_f32_bf16 v152, v232, v116, 0
    v_dot2_f32_bf16 v153, v236, v116, 0
    v_dot2_f32_bf16 v154, v233, v116, 0
    v_dot2_f32_bf16 v155, v237, v116, 0
    v_perm_b32 v230, v84, v48, s95
    v_perm_b32 v234, v84, v48, s96
    v_perm_b32 v231, v85, v49, s95
    v_perm_b32 v235, v85, v49, s96
    v_perm_b32 v232, v86, v50, s95
    v_perm_b32 v236, v86, v50, s96
    v_perm_b32 v233, v87, v51, s95
    v_perm_b32 v237, v87, v51, s96
    ds_read_b128 v[48:51], v222 offset:2320
    ds_read_b128 v[84:87], v223 offset:2320
    v_dot2_f32_bf16 v156, v230, v116, 0
    v_dot2_f32_bf16 v157, v234, v116, 0
    v_dot2_f32_bf16 v158, v231, v116, 0
    v_dot2_f32_bf16 v159, v235, v116, 0
    v_dot2_f32_bf16 v160, v232, v116, 0
    v_dot2_f32_bf16 v161, v236, v116, 0
    v_dot2_f32_bf16 v162, v233, v116, 0
    v_dot2_f32_bf16 v163, v237, v116, 0
    v_perm_b32 v230, v88, v52, s95
    v_perm_b32 v234, v88, v52, s96
    v_perm_b32 v231, v89, v53, s95
    v_perm_b32 v235, v89, v53, s96
    v_perm_b32 v232, v90, v54, s95
    v_perm_b32 v236, v90, v54, s96
    v_perm_b32 v233, v91, v55, s95
    v_perm_b32 v237, v91, v55, s96
    ds_read_b128 v[52:55], v222 offset:2336
    ds_read_b128 v[88:91], v223 offset:2336
    v_dot2_f32_bf16 v164, v230, v116, 0
    v_dot2_f32_bf16 v165, v234, v116, 0
    v_dot2_f32_bf16 v166, v231, v124, 0
    v_dot2_f32_bf16 v167, v235, v124, 0
    v_dot2_f32_bf16 v168, v232, v124, 0
    v_dot2_f32_bf16 v169, v236, v124, 0
    v_dot2_f32_bf16 v170, v233, v124, 0
    v_dot2_f32_bf16 v171, v237, v124, 0
    v_perm_b32 v230, v92, v56, s95
    v_perm_b32 v234, v92, v56, s96
    v_perm_b32 v231, v93, v57, s95
    v_perm_b32 v235, v93, v57, s96
    v_perm_b32 v232, v94, v58, s95
    v_perm_b32 v236, v94, v58, s96
    v_perm_b32 v233, v95, v59, s95
    v_perm_b32 v237, v95, v59, s96
    ds_read_b128 v[56:59], v222 offset:2352
    ds_read_b128 v[92:95], v223 offset:2352
    v_dot2_f32_bf16 v172, v230, v124, 0
    v_dot2_f32_bf16 v173, v234, v124, 0
    v_dot2_f32_bf16 v174, v231, v124, 0
    v_dot2_f32_bf16 v175, v235, v124, 0
    v_dot2_f32_bf16 v176, v232, v124, 0
    v_dot2_f32_bf16 v177, v236, v124, 0
    v_dot2_f32_bf16 v178, v233, v124, 0
    v_dot2_f32_bf16 v179, v237, v124, 0
    v_perm_b32 v230, v96, v60, s95
    v_perm_b32 v234, v96, v60, s96
    v_perm_b32 v231, v97, v61, s95
    v_perm_b32 v235, v97, v61, s96
    v_perm_b32 v232, v98, v62, s95
    v_perm_b32 v236, v98, v62, s96
    v_perm_b32 v233, v99, v63, s95
    v_perm_b32 v237, v99, v63, s96
    ds_read_b128 v[60:63], v222 offset:2368
    ds_read_b128 v[96:99], v223 offset:2368
    v_dot2_f32_bf16 v180, v230, v124, 0
    v_dot2_f32_bf16 v181, v234, v124, 0
    v_dot2_f32_bf16 v182, v231, v124, 0
    v_dot2_f32_bf16 v183, v235, v124, 0
    v_dot2_f32_bf16 v184, v232, v132, 0
    v_dot2_f32_bf16 v185, v236, v132, 0
    v_dot2_f32_bf16 v186, v233, v132, 0
    v_dot2_f32_bf16 v187, v237, v132, 0
    v_perm_b32 v230, v100, v64, s95
    v_perm_b32 v234, v100, v64, s96
    v_perm_b32 v231, v101, v65, s95
    v_perm_b32 v235, v101, v65, s96
    v_perm_b32 v232, v102, v66, s95
    v_perm_b32 v236, v102, v66, s96
    v_perm_b32 v233, v103, v67, s95
    v_perm_b32 v237, v103, v67, s96
    ds_read_b128 v[64:67], v222 offset:2384
    ds_read_b128 v[100:103], v223 offset:2384
    v_dot2_f32_bf16 v188, v230, v132, 0
    v_dot2_f32_bf16 v189, v234, v132, 0
    v_dot2_f32_bf16 v190, v231, v132, 0
    v_dot2_f32_bf16 v191, v235, v132, 0
    v_dot2_f32_bf16 v192, v232, v132, 0
    v_dot2_f32_bf16 v193, v236, v132, 0
    v_dot2_f32_bf16 v194, v233, v132, 0
    v_dot2_f32_bf16 v195, v237, v132, 0
    v_perm_b32 v230, v104, v68, s95
    v_perm_b32 v234, v104, v68, s96
    v_perm_b32 v231, v105, v69, s95
    v_perm_b32 v235, v105, v69, s96
    v_perm_b32 v232, v106, v70, s95
    v_perm_b32 v236, v106, v70, s96
    v_perm_b32 v233, v107, v71, s95
    v_perm_b32 v237, v107, v71, s96
    ds_read_b128 v[68:71], v222 offset:2400
    ds_read_b128 v[104:107], v223 offset:2400
    v_dot2_f32_bf16 v196, v230, v132, 0
    v_dot2_f32_bf16 v197, v234, v132, 0
    v_dot2_f32_bf16 v198, v231, v132, 0
    v_dot2_f32_bf16 v199, v235, v132, 0
    v_dot2_f32_bf16 v200, v232, v132, 0
    v_dot2_f32_bf16 v201, v236, v132, 0
    v_dot2_f32_bf16 v202, v233, v140, 0
    v_dot2_f32_bf16 v203, v237, v140, 0
    v_perm_b32 v230, v108, v72, s95
    v_perm_b32 v234, v108, v72, s96
    v_perm_b32 v231, v109, v73, s95
    v_perm_b32 v235, v109, v73, s96
    v_perm_b32 v232, v110, v74, s95
    v_perm_b32 v236, v110, v74, s96
    v_perm_b32 v233, v111, v75, s95
    v_perm_b32 v237, v111, v75, s96
    ds_read_b128 v[72:75], v222 offset:2416
    ds_read_b128 v[108:111], v223 offset:2416
    v_dot2_f32_bf16 v204, v230, v140, 0
    v_dot2_f32_bf16 v205, v234, v140, 0
    v_dot2_f32_bf16 v206, v231, v140, 0
    v_dot2_f32_bf16 v207, v235, v140, 0
    v_dot2_f32_bf16 v208, v232, v140, 0
    v_dot2_f32_bf16 v209, v236, v140, 0
    v_dot2_f32_bf16 v210, v233, v140, 0
    v_dot2_f32_bf16 v211, v237, v140, 0
    v_perm_b32 v230, v112, v76, s95
    v_perm_b32 v234, v112, v76, s96
    v_perm_b32 v231, v113, v77, s95
    v_perm_b32 v235, v113, v77, s96
    v_perm_b32 v232, v114, v78, s95
    v_perm_b32 v236, v114, v78, s96
    v_perm_b32 v233, v115, v79, s95
    v_perm_b32 v237, v115, v79, s96
    ds_read_b128 v[76:79], v222 offset:2432
    ds_read_b128 v[112:115], v223 offset:2432
    v_dot2_f32_bf16 v212, v230, v140, 0
    v_dot2_f32_bf16 v213, v234, v140, 0
    v_dot2_f32_bf16 v214, v231, v140, 0
    v_dot2_f32_bf16 v215, v235, v140, 0
    v_dot2_f32_bf16 v216, v232, v140, 0
    v_dot2_f32_bf16 v217, v236, v140, 0
    v_dot2_f32_bf16 v218, v233, v140, 0
    v_dot2_f32_bf16 v219, v237, v140, 0
    s_waitcnt lgkmcnt(0)
    v_perm_b32 v230, v80, v44, s95
    v_perm_b32 v234, v80, v44, s96
    v_perm_b32 v231, v81, v45, s95
    v_perm_b32 v235, v81, v45, s96
    v_perm_b32 v232, v82, v46, s95
    v_perm_b32 v236, v82, v46, s96
    v_perm_b32 v233, v83, v47, s95
    v_perm_b32 v237, v83, v47, s96
    ds_read_b128 v[44:47], v224 offset:2304
    ds_read_b128 v[80:83], v225 offset:2304
    v_dot2_f32_bf16 v148, v230, v117, v148
    v_dot2_f32_bf16 v149, v234, v117, v149
    v_dot2_f32_bf16 v150, v231, v117, v150
    v_dot2_f32_bf16 v151, v235, v117, v151
    v_dot2_f32_bf16 v152, v232, v117, v152
    v_dot2_f32_bf16 v153, v236, v117, v153
    v_dot2_f32_bf16 v154, v233, v117, v154
    v_dot2_f32_bf16 v155, v237, v117, v155
    v_perm_b32 v230, v84, v48, s95
    v_perm_b32 v234, v84, v48, s96
    v_perm_b32 v231, v85, v49, s95
    v_perm_b32 v235, v85, v49, s96
    v_perm_b32 v232, v86, v50, s95
    v_perm_b32 v236, v86, v50, s96
    v_perm_b32 v233, v87, v51, s95
    v_perm_b32 v237, v87, v51, s96
    ds_read_b128 v[48:51], v224 offset:2320
    ds_read_b128 v[84:87], v225 offset:2320
    v_dot2_f32_bf16 v156, v230, v117, v156
    v_dot2_f32_bf16 v157, v234, v117, v157
    v_dot2_f32_bf16 v158, v231, v117, v158
    v_dot2_f32_bf16 v159, v235, v117, v159
    v_dot2_f32_bf16 v160, v232, v117, v160
    v_dot2_f32_bf16 v161, v236, v117, v161
    v_dot2_f32_bf16 v162, v233, v117, v162
    v_dot2_f32_bf16 v163, v237, v117, v163
    v_perm_b32 v230, v88, v52, s95
    v_perm_b32 v234, v88, v52, s96
    v_perm_b32 v231, v89, v53, s95
    v_perm_b32 v235, v89, v53, s96
    v_perm_b32 v232, v90, v54, s95
    v_perm_b32 v236, v90, v54, s96
    v_perm_b32 v233, v91, v55, s95
    v_perm_b32 v237, v91, v55, s96
    ds_read_b128 v[52:55], v224 offset:2336
    ds_read_b128 v[88:91], v225 offset:2336
    v_dot2_f32_bf16 v164, v230, v117, v164
    v_dot2_f32_bf16 v165, v234, v117, v165
    v_dot2_f32_bf16 v166, v231, v125, v166
    v_dot2_f32_bf16 v167, v235, v125, v167
    v_dot2_f32_bf16 v168, v232, v125, v168
    v_dot2_f32_bf16 v169, v236, v125, v169
    v_dot2_f32_bf16 v170, v233, v125, v170
    v_dot2_f32_bf16 v171, v237, v125, v171
    v_perm_b32 v230, v92, v56, s95
    v_perm_b32 v234, v92, v56, s96
    v_perm_b32 v231, v93, v57, s95
    v_perm_b32 v235, v93, v57, s96
    v_perm_b32 v232, v94, v58, s95
    v_perm_b32 v236, v94, v58, s96
    v_perm_b32 v233, v95, v59, s95
    v_perm_b32 v237, v95, v59, s96
    ds_read_b128 v[56:59], v224 offset:2352
    ds_read_b128 v[92:95], v225 offset:2352
    v_dot2_f32_bf16 v172, v230, v125, v172
    v_dot2_f32_bf16 v173, v234, v125, v173
    v_dot2_f32_bf16 v174, v231, v125, v174
    v_dot2_f32_bf16 v175, v235, v125, v175
    v_dot2_f32_bf16 v176, v232, v125, v176
    v_dot2_f32_bf16 v177, v236, v125, v177
    v_dot2_f32_bf16 v178, v233, v125, v178
    v_dot2_f32_bf16 v179, v237, v125, v179
    v_perm_b32 v230, v96, v60, s95
    v_perm_b32 v234, v96, v60, s96
    v_perm_b32 v231, v97, v61, s95
    v_perm_b32 v235, v97, v61, s96
    v_perm_b32 v232, v98, v62, s95
    v_perm_b32 v236, v98, v62, s96
    v_perm_b32 v233, v99, v63, s95
    v_perm_b32 v237, v99, v63, s96
    ds_read_b128 v[60:63], v224 offset:2368
    ds_read_b128 v[96:99], v225 offset:2368
    v_dot2_f32_bf16 v180, v230, v125, v180
    v_dot2_f32_bf16 v181, v234, v125, v181
    v_dot2_f32_bf16 v182, v231, v125, v182
    v_dot2_f32_bf16 v183, v235, v125, v183
    v_dot2_f32_bf16 v184, v232, v133, v184
    v_dot2_f32_bf16 v185, v236, v133, v185
    v_dot2_f32_bf16 v186, v233, v133, v186
    v_dot2_f32_bf16 v187, v237, v133, v187
    v_perm_b32 v230, v100, v64, s95
    v_perm_b32 v234, v100, v64, s96
    v_perm_b32 v231, v101, v65, s95
    v_perm_b32 v235, v101, v65, s96
    v_perm_b32 v232, v102, v66, s95
    v_perm_b32 v236, v102, v66, s96
    v_perm_b32 v233, v103, v67, s95
    v_perm_b32 v237, v103, v67, s96
    ds_read_b128 v[64:67], v224 offset:2384
    ds_read_b128 v[100:103], v225 offset:2384
    v_dot2_f32_bf16 v188, v230, v133, v188
    v_dot2_f32_bf16 v189, v234, v133, v189
    v_dot2_f32_bf16 v190, v231, v133, v190
    v_dot2_f32_bf16 v191, v235, v133, v191
    v_dot2_f32_bf16 v192, v232, v133, v192
    v_dot2_f32_bf16 v193, v236, v133, v193
    v_dot2_f32_bf16 v194, v233, v133, v194
    v_dot2_f32_bf16 v195, v237, v133, v195
    v_perm_b32 v230, v104, v68, s95
    v_perm_b32 v234, v104, v68, s96
    v_perm_b32 v231, v105, v69, s95
    v_perm_b32 v235, v105, v69, s96
    v_perm_b32 v232, v106, v70, s95
    v_perm_b32 v236, v106, v70, s96
    v_perm_b32 v233, v107, v71, s95
    v_perm_b32 v237, v107, v71, s96
    ds_read_b128 v[68:71], v224 offset:2400
    ds_read_b128 v[104:107], v225 offset:2400
    v_dot2_f32_bf16 v196, v230, v133, v196
    v_dot2_f32_bf16 v197, v234, v133, v197
    v_dot2_f32_bf16 v198, v231, v133, v198
    v_dot2_f32_bf16 v199, v235, v133, v199
    v_dot2_f32_bf16 v200, v232, v133, v200
    v_dot2_f32_bf16 v201, v236, v133, v201
    v_dot2_f32_bf16 v202, v233, v141, v202
    v_dot2_f32_bf16 v203, v237, v141, v203
    v_perm_b32 v230, v108, v72, s95
    v_perm_b32 v234, v108, v72, s96
    v_perm_b32 v231, v109, v73, s95
    v_perm_b32 v235, v109, v73, s96
    v_perm_b32 v232, v110, v74, s95
    v_perm_b32 v236, v110, v74, s96
    v_perm_b32 v233, v111, v75, s95
    v_perm_b32 v237, v111, v75, s96
    ds_read_b128 v[72:75], v224 offset:2416
    ds_read_b128 v[108:111], v225 offset:2416
    v_dot2_f32_bf16 v204, v230, v141, v204
    v_dot2_f32_bf16 v205, v234, v141, v205
    v_dot2_f32_bf16 v206, v231, v141, v206
    v_dot2_f32_bf16 v207, v235, v141, v207
    v_dot2_f32_bf16 v208, v232, v141, v208
    v_dot2_f32_bf16 v209, v236, v141, v209
    v_dot2_f32_bf16 v210, v233, v141, v210
    v_dot2_f32_bf16 v211, v237, v141, v211
    v_perm_b32 v230, v112, v76, s95
    v_perm_b32 v234, v112, v76, s96
    v_perm_b32 v231, v113, v77, s95
    v_perm_b32 v235, v113, v77, s96
    v_perm_b32 v232, v114, v78, s95
    v_perm_b32 v236, v114, v78, s96
    v_perm_b32 v233, v115, v79, s95
    v_perm_b32 v237, v115, v79, s96
    ds_read_b128 v[76:79], v224 offset:2432
    ds_read_b128 v[112:115], v225 offset:2432
    v_dot2_f32_bf16 v212, v230, v141, v212
    v_dot2_f32_bf16 v213, v234, v141, v213
    v_dot2_f32_bf16 v214, v231, v141, v214
    v_dot2_f32_bf16 v215, v235, v141, v215
    v_dot2_f32_bf16 v216, v232, v141, v216
    v_dot2_f32_bf16 v217, v236, v141, v217
    v_dot2_f32_bf16 v218, v233, v141, v218
    v_dot2_f32_bf16 v219, v237, v141, v219
    s_waitcnt lgkmcnt(0)
    v_perm_b32 v230, v80, v44, s95
    v_perm_b32 v234, v80, v44, s96
    v_perm_b32 v231, v81, v45, s95
    v_perm_b32 v235, v81, v45, s96
    v_perm_b32 v232, v82, v46, s95
    v_perm_b32 v236, v82, v46, s96
    v_perm_b32 v233, v83, v47, s95
    v_perm_b32 v237, v83, v47, s96
    ds_read_b128 v[44:47], v226 offset:2304
    ds_read_b128 v[80:83], v227 offset:2304
    v_dot2_f32_bf16 v148, v230, v118, v148
    v_dot2_f32_bf16 v149, v234, v118, v149
    v_dot2_f32_bf16 v150, v231, v118, v150
    v_dot2_f32_bf16 v151, v235, v118, v151
    v_dot2_f32_bf16 v152, v232, v118, v152
    v_dot2_f32_bf16 v153, v236, v118, v153
    v_dot2_f32_bf16 v154, v233, v118, v154
    v_dot2_f32_bf16 v155, v237, v118, v155
    v_perm_b32 v230, v84, v48, s95
    v_perm_b32 v234, v84, v48, s96
    v_perm_b32 v231, v85, v49, s95
    v_perm_b32 v235, v85, v49, s96
    v_perm_b32 v232, v86, v50, s95
    v_perm_b32 v236, v86, v50, s96
    v_perm_b32 v233, v87, v51, s95
    v_perm_b32 v237, v87, v51, s96
    ds_read_b128 v[48:51], v226 offset:2320
    ds_read_b128 v[84:87], v227 offset:2320
    v_dot2_f32_bf16 v156, v230, v118, v156
    v_dot2_f32_bf16 v157, v234, v118, v157
    v_dot2_f32_bf16 v158, v231, v118, v158
    v_dot2_f32_bf16 v159, v235, v118, v159
    v_dot2_f32_bf16 v160, v232, v118, v160
    v_dot2_f32_bf16 v161, v236, v118, v161
    v_dot2_f32_bf16 v162, v233, v118, v162
    v_dot2_f32_bf16 v163, v237, v118, v163
    v_perm_b32 v230, v88, v52, s95
    v_perm_b32 v234, v88, v52, s96
    v_perm_b32 v231, v89, v53, s95
    v_perm_b32 v235, v89, v53, s96
    v_perm_b32 v232, v90, v54, s95
    v_perm_b32 v236, v90, v54, s96
    v_perm_b32 v233, v91, v55, s95
    v_perm_b32 v237, v91, v55, s96
    ds_read_b128 v[52:55], v226 offset:2336
    ds_read_b128 v[88:91], v227 offset:2336
    v_dot2_f32_bf16 v164, v230, v118, v164
    v_dot2_f32_bf16 v165, v234, v118, v165
    v_dot2_f32_bf16 v166, v231, v126, v166
    v_dot2_f32_bf16 v167, v235, v126, v167
    v_dot2_f32_bf16 v168, v232, v126, v168
    v_dot2_f32_bf16 v169, v236, v126, v169
    v_dot2_f32_bf16 v170, v233, v126, v170
    v_dot2_f32_bf16 v171, v237, v126, v171
    v_perm_b32 v230, v92, v56, s95
    v_perm_b32 v234, v92, v56, s96
    v_perm_b32 v231, v93, v57, s95
    v_perm_b32 v235, v93, v57, s96
    v_perm_b32 v232, v94, v58, s95
    v_perm_b32 v236, v94, v58, s96
    v_perm_b32 v233, v95, v59, s95
    v_perm_b32 v237, v95, v59, s96
    ds_read_b128 v[56:59], v226 offset:2352
    ds_read_b128 v[92:95], v227 offset:2352
    v_dot2_f32_bf16 v172, v230, v126, v172
    v_dot2_f32_bf16 v173, v234, v126, v173
    v_dot2_f32_bf16 v174, v231, v126, v174
    v_dot2_f32_bf16 v175, v235, v126, v175
    v_dot2_f32_bf16 v176, v232, v126, v176
    v_dot2_f32_bf16 v177, v236, v126, v177
    v_dot2_f32_bf16 v178, v233, v126, v178
    v_dot2_f32_bf16 v179, v237, v126, v179
    v_perm_b32 v230, v96, v60, s95
    v_perm_b32 v234, v96, v60, s96
    v_perm_b32 v231, v97, v61, s95
    v_perm_b32 v235, v97, v61, s96
    v_perm_b32 v232, v98, v62, s95
    v_perm_b32 v236, v98, v62, s96
    v_perm_b32 v233, v99, v63, s95
    v_perm_b32 v237, v99, v63, s96
    ds_read_b128 v[60:63], v226 offset:2368
    ds_read_b128 v[96:99], v227 offset:2368
    v_dot2_f32_bf16 v180, v230, v126, v180
    v_dot2_f32_bf16 v181, v234, v126, v181
    v_dot2_f32_bf16 v182, v231, v126, v182
    v_dot2_f32_bf16 v183, v235, v126, v183
    v_dot2_f32_bf16 v184, v232, v134, v184
    v_dot2_f32_bf16 v185, v236, v134, v185
    v_dot2_f32_bf16 v186, v233, v134, v186
    v_dot2_f32_bf16 v187, v237, v134, v187
    v_perm_b32 v230, v100, v64, s95
    v_perm_b32 v234, v100, v64, s96
    v_perm_b32 v231, v101, v65, s95
    v_perm_b32 v235, v101, v65, s96
    v_perm_b32 v232, v102, v66, s95
    v_perm_b32 v236, v102, v66, s96
    v_perm_b32 v233, v103, v67, s95
    v_perm_b32 v237, v103, v67, s96
    ds_read_b128 v[64:67], v226 offset:2384
    ds_read_b128 v[100:103], v227 offset:2384
    v_dot2_f32_bf16 v188, v230, v134, v188
    v_dot2_f32_bf16 v189, v234, v134, v189
    v_dot2_f32_bf16 v190, v231, v134, v190
    v_dot2_f32_bf16 v191, v235, v134, v191
    v_dot2_f32_bf16 v192, v232, v134, v192
    v_dot2_f32_bf16 v193, v236, v134, v193
    v_dot2_f32_bf16 v194, v233, v134, v194
    v_dot2_f32_bf16 v195, v237, v134, v195
    v_perm_b32 v230, v104, v68, s95
    v_perm_b32 v234, v104, v68, s96
    v_perm_b32 v231, v105, v69, s95
    v_perm_b32 v235, v105, v69, s96
    v_perm_b32 v232, v106, v70, s95
    v_perm_b32 v236, v106, v70, s96
    v_perm_b32 v233, v107, v71, s95
    v_perm_b32 v237, v107, v71, s96
    ds_read_b128 v[68:71], v226 offset:2400
    ds_read_b128 v[104:107], v227 offset:2400
    v_dot2_f32_bf16 v196, v230, v134, v196
    v_dot2_f32_bf16 v197, v234, v134, v197
    v_dot2_f32_bf16 v198, v231, v134, v198
    v_dot2_f32_bf16 v199, v235, v134, v199
    v_dot2_f32_bf16 v200, v232, v134, v200
    v_dot2_f32_bf16 v201, v236, v134, v201
    v_dot2_f32_bf16 v202, v233, v142, v202
    v_dot2_f32_bf16 v203, v237, v142, v203
    v_perm_b32 v230, v108, v72, s95
    v_perm_b32 v234, v108, v72, s96
    v_perm_b32 v231, v109, v73, s95
    v_perm_b32 v235, v109, v73, s96
    v_perm_b32 v232, v110, v74, s95
    v_perm_b32 v236, v110, v74, s96
    v_perm_b32 v233, v111, v75, s95
    v_perm_b32 v237, v111, v75, s96
    ds_read_b128 v[72:75], v226 offset:2416
    ds_read_b128 v[108:111], v227 offset:2416
    v_dot2_f32_bf16 v204, v230, v142, v204
    v_dot2_f32_bf16 v205, v234, v142, v205
    v_dot2_f32_bf16 v206, v231, v142, v206
    v_dot2_f32_bf16 v207, v235, v142, v207
    v_dot2_f32_bf16 v208, v232, v142, v208
    v_dot2_f32_bf16 v209, v236, v142, v209
    v_dot2_f32_bf16 v210, v233, v142, v210
    v_dot2_f32_bf16 v211, v237, v142, v211
    v_perm_b32 v230, v112, v76, s95
    v_perm_b32 v234, v112, v76, s96
    v_perm_b32 v231, v113, v77, s95
    v_perm_b32 v235, v113, v77, s96
    v_perm_b32 v232, v114, v78, s95
    v_perm_b32 v236, v114, v78, s96
    v_perm_b32 v233, v115, v79, s95
    v_perm_b32 v237, v115, v79, s96
    ds_read_b128 v[76:79], v226 offset:2432
    ds_read_b128 v[112:115], v227 offset:2432
    v_dot2_f32_bf16 v212, v230, v142, v212
    v_dot2_f32_bf16 v213, v234, v142, v213
    v_dot2_f32_bf16 v214, v231, v142, v214
    v_dot2_f32_bf16 v215, v235, v142, v215
    v_dot2_f32_bf16 v216, v232, v142, v216
    v_dot2_f32_bf16 v217, v236, v142, v217
    v_dot2_f32_bf16 v218, v233, v142, v218
    v_dot2_f32_bf16 v219, v237, v142, v219
    s_waitcnt lgkmcnt(0)
    v_perm_b32 v230, v80, v44, s95
    v_perm_b32 v234, v80, v44, s96
    v_perm_b32 v231, v81, v45, s95
    v_perm_b32 v235, v81, v45, s96
    v_perm_b32 v232, v82, v46, s95
    v_perm_b32 v236, v82, v46, s96
    v_perm_b32 v233, v83, v47, s95
    v_perm_b32 v237, v83, v47, s96
    v_dot2_f32_bf16 v148, v230, v119, v148
    v_dot2_f32_bf16 v149, v234, v119, v149
    v_dot2_f32_bf16 v150, v231, v119, v150
    v_dot2_f32_bf16 v151, v235, v119, v151
    v_dot2_f32_bf16 v152, v232, v119, v152
    v_dot2_f32_bf16 v153, v236, v119, v153
    v_dot2_f32_bf16 v154, v233, v119, v154
    v_dot2_f32_bf16 v155, v237, v119, v155
    v_perm_b32 v230, v84, v48, s95
    v_perm_b32 v234, v84, v48, s96
    v_perm_b32 v231, v85, v49, s95
    v_perm_b32 v235, v85, v49, s96
    v_perm_b32 v232, v86, v50, s95
    v_perm_b32 v236, v86, v50, s96
    v_perm_b32 v233, v87, v51, s95
    v_perm_b32 v237, v87, v51, s96
    v_dot2_f32_bf16 v156, v230, v119, v156
    v_dot2_f32_bf16 v157, v234, v119, v157
    v_dot2_f32_bf16 v158, v231, v119, v158
    v_dot2_f32_bf16 v159, v235, v119, v159
    v_dot2_f32_bf16 v160, v232, v119, v160
    v_dot2_f32_bf16 v161, v236, v119, v161
    v_dot2_f32_bf16 v162, v233, v119, v162
    v_dot2_f32_bf16 v163, v237, v119, v163
    v_perm_b32 v230, v88, v52, s95
    v_perm_b32 v234, v88, v52, s96
    v_perm_b32 v231, v89, v53, s95
    v_perm_b32 v235, v89, v53, s96
    v_perm_b32 v232, v90, v54, s95
    v_perm_b32 v236, v90, v54, s96
    v_perm_b32 v233, v91, v55, s95
    v_perm_b32 v237, v91, v55, s96
    v_dot2_f32_bf16 v164, v230, v119, v164
    v_dot2_f32_bf16 v165, v234, v119, v165
    v_dot2_f32_bf16 v166, v231, v127, v166
    v_dot2_f32_bf16 v167, v235, v127, v167
    v_dot2_f32_bf16 v168, v232, v127, v168
    v_dot2_f32_bf16 v169, v236, v127, v169
    v_dot2_f32_bf16 v170, v233, v127, v170
    v_dot2_f32_bf16 v171, v237, v127, v171
    v_perm_b32 v230, v92, v56, s95
    v_perm_b32 v234, v92, v56, s96
    v_perm_b32 v231, v93, v57, s95
    v_perm_b32 v235, v93, v57, s96
    v_perm_b32 v232, v94, v58, s95
    v_perm_b32 v236, v94, v58, s96
    v_perm_b32 v233, v95, v59, s95
    v_perm_b32 v237, v95, v59, s96
    v_dot2_f32_bf16 v172, v230, v127, v172
    v_dot2_f32_bf16 v173, v234, v127, v173
    v_dot2_f32_bf16 v174, v231, v127, v174
    v_dot2_f32_bf16 v175, v235, v127, v175
    v_dot2_f32_bf16 v176, v232, v127, v176
    v_dot2_f32_bf16 v177, v236, v127, v177
    v_dot2_f32_bf16 v178, v233, v127, v178
    v_dot2_f32_bf16 v179, v237, v127, v179
    v_perm_b32 v230, v96, v60, s95
    v_perm_b32 v234, v96, v60, s96
    v_perm_b32 v231, v97, v61, s95
    v_perm_b32 v235, v97, v61, s96
    v_perm_b32 v232, v98, v62, s95
    v_perm_b32 v236, v98, v62, s96
    v_perm_b32 v233, v99, v63, s95
    v_perm_b32 v237, v99, v63, s96
    v_dot2_f32_bf16 v180, v230, v127, v180
    v_dot2_f32_bf16 v181, v234, v127, v181
    v_dot2_f32_bf16 v182, v231, v127, v182
    v_dot2_f32_bf16 v183, v235, v127, v183
    v_dot2_f32_bf16 v184, v232, v135, v184
    v_dot2_f32_bf16 v185, v236, v135, v185
    v_dot2_f32_bf16 v186, v233, v135, v186
    v_dot2_f32_bf16 v187, v237, v135, v187
    v_perm_b32 v230, v100, v64, s95
    v_perm_b32 v234, v100, v64, s96
    v_perm_b32 v231, v101, v65, s95
    v_perm_b32 v235, v101, v65, s96
    v_perm_b32 v232, v102, v66, s95
    v_perm_b32 v236, v102, v66, s96
    v_perm_b32 v233, v103, v67, s95
    v_perm_b32 v237, v103, v67, s96
    v_dot2_f32_bf16 v188, v230, v135, v188
    v_dot2_f32_bf16 v189, v234, v135, v189
    v_dot2_f32_bf16 v190, v231, v135, v190
    v_dot2_f32_bf16 v191, v235, v135, v191
    v_dot2_f32_bf16 v192, v232, v135, v192
    v_dot2_f32_bf16 v193, v236, v135, v193
    v_dot2_f32_bf16 v194, v233, v135, v194
    v_dot2_f32_bf16 v195, v237, v135, v195
    v_perm_b32 v230, v104, v68, s95
    v_perm_b32 v234, v104, v68, s96
    v_perm_b32 v231, v105, v69, s95
    v_perm_b32 v235, v105, v69, s96
    v_perm_b32 v232, v106, v70, s95
    v_perm_b32 v236, v106, v70, s96
    v_perm_b32 v233, v107, v71, s95
    v_perm_b32 v237, v107, v71, s96
    v_dot2_f32_bf16 v196, v230, v135, v196
    v_dot2_f32_bf16 v197, v234, v135, v197
    v_dot2_f32_bf16 v198, v231, v135, v198
    v_dot2_f32_bf16 v199, v235, v135, v199
    v_dot2_f32_bf16 v200, v232, v135, v200
    v_dot2_f32_bf16 v201, v236, v135, v201
    v_dot2_f32_bf16 v202, v233, v143, v202
    v_dot2_f32_bf16 v203, v237, v143, v203
    v_perm_b32 v230, v108, v72, s95
    v_perm_b32 v234, v108, v72, s96
    v_perm_b32 v231, v109, v73, s95
    v_perm_b32 v235, v109, v73, s96
    v_perm_b32 v232, v110, v74, s95
    v_perm_b32 v236, v110, v74, s96
    v_perm_b32 v233, v111, v75, s95
    v_perm_b32 v237, v111, v75, s96
    v_dot2_f32_bf16 v204, v230, v143, v204
    v_dot2_f32_bf16 v205, v234, v143, v205
    v_dot2_f32_bf16 v206, v231, v143, v206
    v_dot2_f32_bf16 v207, v235, v143, v207
    v_dot2_f32_bf16 v208, v232, v143, v208
    v_dot2_f32_bf16 v209, v236, v143, v209
    v_dot2_f32_bf16 v210, v233, v143, v210
    v_dot2_f32_bf16 v211, v237, v143, v211
    v_perm_b32 v230, v112, v76, s95
    v_perm_b32 v234, v112, v76, s96
    v_perm_b32 v231, v113, v77, s95
    v_perm_b32 v235, v113, v77, s96
    v_perm_b32 v232, v114, v78, s95
    v_perm_b32 v236, v114, v78, s96
    v_perm_b32 v233, v115, v79, s95
    v_perm_b32 v237, v115, v79, s96
    v_dot2_f32_bf16 v212, v230, v143, v212
    v_dot2_f32_bf16 v213, v234, v143, v213
    v_dot2_f32_bf16 v214, v231, v143, v214
    v_dot2_f32_bf16 v215, v235, v143, v215
    v_dot2_f32_bf16 v216, v232, v143, v216
    v_dot2_f32_bf16 v217, v236, v143, v217
    v_dot2_f32_bf16 v218, v233, v143, v218
    v_dot2_f32_bf16 v219, v237, v143, v219
    v_and_b32 v3, 7, v0
    v_mul_u32_u24 v3, 2304, v3
    v_lshrrev_b32 v2, 3, v0
    v_lshl_add_u32 v3, v2, 4, v3
    s_lshr_b32 s92, s83, 1
    s_lshl_b32 s92, s92, 2
    s_add_u32 s92, s92, s33
    s_mul_i32 s92, s92, 18432
    s_and_b32 s93, s83, 1
    s_lshl_b32 s93, s93, 7
    s_add_u32 s92, s92, s93
    s_add_u32 s92, s92, 2359296
    v_cvt_pk_bf16_f32 v8, v148, v149
    v_cvt_pk_bf16_f32 v9, v150, v151
    v_cvt_pk_bf16_f32 v10, v152, v153
    v_cvt_pk_bf16_f32 v11, v154, v155
    buffer_store_dwordx4 v[8:11], v3, s[20:23], s92 offen offset:0 sc1
    v_cvt_pk_bf16_f32 v12, v156, v157
    v_cvt_pk_bf16_f32 v13, v158, v159
    v_cvt_pk_bf16_f32 v14, v160, v161
    v_cvt_pk_bf16_f32 v15, v162, v163
    buffer_store_dwordx4 v[12:15], v3, s[20:23], s92 offen offset:256 sc1
    v_cvt_pk_bf16_f32 v16, v164, v165
    v_cvt_pk_bf16_f32 v17, v166, v167
    v_cvt_pk_bf16_f32 v18, v168, v169
    v_cvt_pk_bf16_f32 v19, v170, v171
    buffer_store_dwordx4 v[16:19], v3, s[20:23], s92 offen offset:512 sc1
    v_cvt_pk_bf16_f32 v20, v172, v173
    v_cvt_pk_bf16_f32 v21, v174, v175
    v_cvt_pk_bf16_f32 v22, v176, v177
    v_cvt_pk_bf16_f32 v23, v178, v179
    buffer_store_dwordx4 v[20:23], v3, s[20:23], s92 offen offset:768 sc1
    v_cvt_pk_bf16_f32 v24, v180, v181
    v_cvt_pk_bf16_f32 v25, v182, v183
    v_cvt_pk_bf16_f32 v26, v184, v185
    v_cvt_pk_bf16_f32 v27, v186, v187
    buffer_store_dwordx4 v[24:27], v3, s[20:23], s92 offen offset:1024 sc1
    v_cvt_pk_bf16_f32 v28, v188, v189
    v_cvt_pk_bf16_f32 v29, v190, v191
    v_cvt_pk_bf16_f32 v30, v192, v193
    v_cvt_pk_bf16_f32 v31, v194, v195
    buffer_store_dwordx4 v[28:31], v3, s[20:23], s92 offen offset:1280 sc1
    v_cvt_pk_bf16_f32 v32, v196, v197
    v_cvt_pk_bf16_f32 v33, v198, v199
    v_cvt_pk_bf16_f32 v34, v200, v201
    v_cvt_pk_bf16_f32 v35, v202, v203
    buffer_store_dwordx4 v[32:35], v3, s[20:23], s92 offen offset:1536 sc1
    v_cvt_pk_bf16_f32 v36, v204, v205
    v_cvt_pk_bf16_f32 v37, v206, v207
    v_cvt_pk_bf16_f32 v38, v208, v209
    v_cvt_pk_bf16_f32 v39, v210, v211
    buffer_store_dwordx4 v[36:39], v3, s[20:23], s92 offen offset:1792 sc1
    v_cvt_pk_bf16_f32 v40, v212, v213
    v_cvt_pk_bf16_f32 v41, v214, v215
    v_cvt_pk_bf16_f32 v42, v216, v217
    v_cvt_pk_bf16_f32 v43, v218, v219
    buffer_store_dwordx4 v[40:43], v3, s[20:23], s92 offen offset:2048 sc1
    s_lshr_b32 s92, s83, 2
    s_lshl_b32 s92, s92, 7
    s_and_b32 s93, s83, 3
    s_lshl_b32 s93, s93, 2
    s_add_u32 s93, s93, s33
    s_lshl_b32 s93, s93, 2
    s_add_u32 s92, s92, s93
    s_add_u32 s92, s92, 50339840
    v_mov_b32 v2, s39
    s_barrier
    s_cmp_eq_u32 s68, 2
    s_cbranch_scc1 L_flag
    s_mov_b32 s94, s78
    s_and_b32 s79, s94, 31
    s_mul_i32 s80, s79, 73728
    s_add_u32 s80, s80, s73
    s_cmp_lt_u32 s79, 18
    s_cselect_b32 s80, s80, 2147479552
    s_add_u32 m0, s72, 73728
    s_nop 0
    buffer_load_dwordx4 v246, s[84:87], s80 offen offset:0 lds
    s_lshr_b32 s94, s94, 5
    buffer_load_dwordx4 v247, s[84:87], s80 offen offset:1024 lds
    buffer_load_dwordx4 v248, s[84:87], s80 offen offset:2048 lds
    s_add_u32 m0, s72, 86016
    s_nop 0
    s_add_u32 s80, s80, 36864
    buffer_load_dwordx4 v246, s[84:87], s80 offen offset:0 lds
    buffer_load_dwordx4 v247, s[84:87], s80 offen offset:1024 lds
    buffer_load_dwordx4 v248, s[84:87], s80 offen offset:2048 lds
    s_nop 0
    s_nop 0
    s_and_b32 s79, s94, 31
    s_mul_i32 s80, s79, 73728
    s_add_u32 s80, s80, s73
    s_cmp_lt_u32 s79, 18
    s_cselect_b32 s80, s80, 2147479552
    s_add_u32 m0, s72, 98304
    s_nop 0
    buffer_load_dwordx4 v246, s[84:87], s80 offen offset:0 lds
    s_lshr_b32 s94, s94, 5
    buffer_load_dwordx4 v247, s[84:87], s80 offen offset:1024 lds
    buffer_load_dwordx4 v248, s[84:87], s80 offen offset:2048 lds
    s_add_u32 m0, s72, 110592
    s_nop 0
    s_add_u32 s80, s80, 36864
    buffer_load_dwordx4 v246, s[84:87], s80 offen offset:0 lds
    buffer_load_dwordx4 v247, s[84:87], s80 offen offset:1024 lds
    buffer_load_dwordx4 v248, s[84:87], s80 offen offset:2048 lds
    s_nop 0
    s_nop 0
    s_waitcnt vmcnt(12)
L_flag:
    s_cmp_eq_u32 s68, 2
    s_cbranch_scc0 L_f2
    s_waitcnt vmcnt(0)
L_f2:
    buffer_store_dword v2, off, s[20:23], s92 sc1
    s_cmp_eq_u32 s68, 2
    s_cbranch_scc1 L_xf
    s_and_b32 s79, s94, 31
    s_mul_i32 s80, s79, 73728
    s_add_u32 s80, s80, s73
    s_cmp_lt_u32 s79, 18
    s_cselect_b32 s80, s80, 2147479552
    s_add_u32 m0, s72, 122880
    s_nop 0
    buffer_load_dwordx4 v246, s[84:87], s80 offen offset:0 lds
    s_lshr_b32 s94, s94, 5
    buffer_load_dwordx4 v247, s[84:87], s80 offen offset:1024 lds
    buffer_load_dwordx4 v248, s[84:87], s80 offen offset:2048 lds
    s_add_u32 m0, s72, 135168
    s_nop 0
    s_add_u32 s80, s80, 36864
    buffer_load_dwordx4 v246, s[84:87], s80 offen offset:0 lds
    buffer_load_dwordx4 v247, s[84:87], s80 offen offset:1024 lds
    buffer_load_dwordx4 v248, s[84:87], s80 offen offset:2048 lds
    s_nop 0
    s_nop 0
    s_and_b32 s79, s94, 31
    s_mul_i32 s80, s79, 73728
    s_add_u32 s80, s80, s73
    s_cmp_lt_u32 s79, 18
    s_cselect_b32 s80, s80, 2147479552
    s_add_u32 m0, s72, 0
    s_nop 0
    buffer_load_dwordx4 v246, s[84:87], s80 offen offset:0 lds
    s_lshr_b32 s94, s94, 5
    buffer_load_dwordx4 v247, s[84:87], s80 offen offset:1024 lds
    buffer_load_dwordx4 v248, s[84:87], s80 offen offset:2048 lds
    s_add_u32 m0, s72, 12288
    s_nop 0
    s_add_u32 s80, s80, 36864
    buffer_load_dwordx4 v246, s[84:87], s80 offen offset:0 lds
    buffer_load_dwordx4 v247, s[84:87], s80 offen offset:1024 lds
    buffer_load_dwordx4 v248, s[84:87], s80 offen offset:2048 lds
    s_nop 0
    s_nop 0
    s_and_b32 s79, s94, 31
    s_mul_i32 s80, s79, 73728
    s_add_u32 s80, s80, s73
    s_cmp_lt_u32 s79, 18
    s_cselect_b32 s80, s80, 2147479552
    s_add_u32 m0, s72, 24576
    s_nop 0
    buffer_load_dwordx4 v246, s[84:87], s80 offen offset:0 lds
    s_lshr_b32 s94, s94, 5
    buffer_load_dwordx4 v247, s[84:87], s80 offen offset:1024 lds
    buffer_load_dwordx4 v248, s[84:87], s80 offen offset:2048 lds
    s_add_u32 m0, s72, 36864
    s_nop 0
    s_add_u32 s80, s80, 36864
    buffer_load_dwordx4 v246, s[84:87], s80 offen offset:0 lds
    buffer_load_dwordx4 v247, s[84:87], s80 offen offset:1024 lds
    buffer_load_dwordx4 v248, s[84:87], s80 offen offset:2048 lds
    s_nop 0
    s_nop 0
    s_lshl_b32 s93, s57, 7
    s_lshr_b32 s94, s33, 1
    s_lshl_b32 s94, s94, 5
    s_add_u32 s93, s93, s94
    s_and_b32 s94, s33, 1
    s_lshl_b32 s94, s94, 3
    s_add_u32 s93, s93, s94
    s_add_u32 s93, s93, 50339840
    v_and_b32 v3, 1, v0
    v_bfe_u32 v4, v0, 1, 1
    v_lshlrev_b32 v3, 2, v3
    v_lshl_add_u32 v3, v4, 4, v3
    v_lshrrev_b32 v1, 5, v0
    v_mul_u32_u24 v1, 3072, v1
    v_bfe_u32 v96, v0, 2, 3
    v_lshl_add_u32 v1, v96, 7, v1
    v_lshrrev_b32 v96, 1, v96
    v_xor_b32 v96, s69, v96
    v_and_b32 v97, 3, v0
    v_lshl_add_u32 v1, v97, 3, v1
    v_xor_b32 v97, 0, v96
    v_lshl_add_u32 v6, v97, 5, v1
    v_add_u32 v10, 49152, v6
    v_add_u32 v240, 98304, v6
    v_xor_b32 v97, 1, v96
    v_lshl_add_u32 v7, v97, 5, v1
    v_add_u32 v11, 49152, v7
    v_add_u32 v241, 98304, v7
    v_xor_b32 v97, 2, v96
    v_lshl_add_u32 v8, v97, 5, v1
    v_add_u32 v13, 49152, v8
    v_add_u32 v242, 98304, v8
    v_xor_b32 v97, 3, v96
    v_lshl_add_u32 v9, v97, 5, v1
    v_add_u32 v15, 49152, v9
    v_add_u32 v243, 98304, v9
    v_mov_b64 v[96:97], 0
    v_mov_b64 v[98:99], 0
    v_mov_b64 v[100:101], 0
    v_mov_b64 v[102:103], 0
    v_mov_b64 v[104:105], 0
    v_mov_b64 v[106:107], 0
    v_mov_b64 v[108:109], 0
    v_mov_b64 v[110:111], 0
    v_mov_b64 v[112:113], 0
    v_mov_b64 v[114:115], 0
    v_mov_b64 v[116:117], 0
    v_mov_b64 v[118:119], 0
    v_mov_b64 v[120:121], 0
    v_mov_b64 v[122:123], 0
    v_mov_b64 v[124:125], 0
    v_mov_b64 v[126:127], 0
    v_mov_b64 v[128:129], 0
    v_mov_b64 v[130:131], 0
    v_mov_b64 v[132:133], 0
    v_mov_b64 v[134:135], 0
    v_mov_b64 v[136:137], 0
    v_mov_b64 v[138:139], 0
    v_mov_b64 v[140:141], 0
    v_mov_b64 v[142:143], 0
    v_mov_b64 v[144:145], 0
    v_mov_b64 v[146:147], 0
    v_mov_b64 v[148:149], 0
    v_mov_b64 v[150:151], 0
    v_mov_b64 v[152:153], 0
    v_mov_b64 v[154:155], 0
    v_mov_b64 v[156:157], 0
    v_mov_b64 v[158:159], 0
    v_mov_b64 v[160:161], 0
    v_mov_b64 v[162:163], 0
    v_mov_b64 v[164:165], 0
    v_mov_b64 v[166:167], 0
    v_mov_b64 v[168:169], 0
    v_mov_b64 v[170:171], 0
    v_mov_b64 v[172:173], 0
    v_mov_b64 v[174:175], 0
    v_mov_b64 v[176:177], 0
    v_mov_b64 v[178:179], 0
    v_mov_b64 v[180:181], 0
    v_mov_b64 v[182:183], 0
    v_mov_b64 v[184:185], 0
    v_mov_b64 v[186:187], 0
    v_mov_b64 v[188:189], 0
    v_mov_b64 v[190:191], 0
    s_mov_b32 s3, 0
P_o:
    s_add_u32 s3, s3, 1
    s_cmp_gt_u32 s3, 1000000
    s_cbranch_scc1 P_o_ok
    buffer_load_dword v4, v3, s[20:23], s93 offen sc1
    s_waitcnt vmcnt(0)
P_o_t:
    v_cmp_ne_u32 vcc, s39, v4
    s_nop 1
    s_cmp_eq_u64 vcc, 0
    s_cbranch_scc1 P_o_ok
    s_sleep 1
    s_branch P_o
P_o_ok:
    s_and_b32 s79, s78, 31
    s_lshl_b32 s81, s79, 11
    s_add_u32 s81, s81, s74
    s_cmp_lt_u32 s79, 18
    s_cselect_b32 s81, s81, 2147479552
    buffer_load_dwordx4 a[0:3], v249, s[20:23], s81 offen offset:0 sc1
    s_lshr_b32 s78, s78, 5
    buffer_load_dwordx4 a[4:7], v250, s[20:23], s81 offen offset:0 sc1
    buffer_load_dwordx4 a[8:11], v249, s[20:23], s81 offen offset:1024 sc1
    buffer_load_dwordx4 a[12:15], v250, s[20:23], s81 offen offset:1024 sc1
    s_and_b32 s79, s78, 31
    s_lshl_b32 s81, s79, 11
    s_add_u32 s81, s81, s74
    s_cmp_lt_u32 s79, 18
    s_cselect_b32 s81, s81, 2147479552
    buffer_load_dwordx4 a[16:19], v249, s[20:23], s81 offen offset:0 sc1
    s_lshr_b32 s78, s78, 5
    buffer_load_dwordx4 a[20:23], v250, s[20:23], s81 offen offset:0 sc1
    buffer_load_dwordx4 a[24:27], v249, s[20:23], s81 offen offset:1024 sc1
    buffer_load_dwordx4 a[28:31], v250, s[20:23], s81 offen offset:1024 sc1
    s_and_b32 s79, s78, 31
    s_lshl_b32 s81, s79, 11
    s_add_u32 s81, s81, s74
    s_cmp_lt_u32 s79, 18
    s_cselect_b32 s81, s81, 2147479552
    buffer_load_dwordx4 a[32:35], v249, s[20:23], s81 offen offset:0 sc1
    s_lshr_b32 s78, s78, 5
    buffer_load_dwordx4 a[36:39], v250, s[20:23], s81 offen offset:0 sc1
    buffer_load_dwordx4 a[40:43], v249, s[20:23], s81 offen offset:1024 sc1
    buffer_load_dwordx4 a[44:47], v250, s[20:23], s81 offen offset:1024 sc1
    s_and_b32 s79, s78, 31
    s_lshl_b32 s81, s79, 11
    s_add_u32 s81, s81, s74
    s_cmp_lt_u32 s79, 18
    s_cselect_b32 s81, s81, 2147479552
    buffer_load_dwordx4 a[48:51], v249, s[20:23], s81 offen offset:0 sc1
    s_lshr_b32 s78, s78, 5
    buffer_load_dwordx4 a[52:55], v250, s[20:23], s81 offen offset:0 sc1
    buffer_load_dwordx4 a[56:59], v249, s[20:23], s81 offen offset:1024 sc1
    buffer_load_dwordx4 a[60:63], v250, s[20:23], s81 offen offset:1024 sc1
    s_and_b32 s79, s78, 31
    s_lshl_b32 s81, s79, 11
    s_add_u32 s81, s81, s74
    s_cmp_lt_u32 s79, 18
    s_cselect_b32 s81, s81, 2147479552
    buffer_load_dwordx4 a[64:67], v249, s[20:23], s81 offen offset:0 sc1
    s_lshr_b32 s78, s78, 5
    buffer_load_dwordx4 a[68:71], v250, s[20:23], s81 offen offset:0 sc1
    buffer_load_dwordx4 a[72:75], v249, s[20:23], s81 offen offset:1024 sc1
    buffer_load_dwordx4 a[76:79], v250, s[20:23], s81 offen offset:1024 sc1
    s_waitcnt vmcnt(0)
    s_barrier
    s_mov_b32 s25, 2147479552
    s_mov_b32 s27, 0
    v_mov_b32 v244, 0
    s_mul_i32 s97, s70, 245760
    s_add_u32 s97, s97, s72
    s_add_u32 s97, s97, 30670848
    s_add_u32 s94, s97, 61440
    s_add_u32 s95, s97, 122880
    s_add_u32 s96, s97, 184320
    s_add_u32 s63, s62, 16
    ds_read_b64_tr_b16 v[16:17], v10 offset:24576
    ds_read_b64_tr_b16 v[18:19], v10 offset:30720
    ds_read_b64_tr_b16 v[20:21], v11 offset:24576
    ds_read_b64_tr_b16 v[22:23], v11 offset:30720
    ds_read_b64_tr_b16 v[24:25], v13 offset:24576
    ds_read_b64_tr_b16 v[26:27], v13 offset:30720
    ds_read_b64_tr_b16 v[28:29], v15 offset:24576
    ds_read_b64_tr_b16 v[30:31], v15 offset:30720
    ds_read_b64_tr_b16 v[64:65], v10 offset:25600
    ds_read_b64_tr_b16 v[66:67], v10 offset:31744
    ds_read_b64_tr_b16 v[68:69], v11 offset:25600
    ds_read_b64_tr_b16 v[70:71], v11 offset:31744
    s_waitcnt lgkmcnt(8)
    s_branch C_go
L_xf:
    s_lshr_b32 s57, s83, 3
    s_lshl_b32 s57, s57, 1
    s_and_b32 s93, s83, 1
    s_add_u32 s57, s57, s93
    s_lshl_b32 s92, s57, 2
    s_add_u32 s92, s92, s33
    s_mul_i32 s92, s92, 36864
    s_add_u32 s94, s88, s92
    s_addc_u32 s95, s89, 0
    s_mul_i32 s93, s33, 36864
    s_mov_b32 s82, 36
L_xl:
    s_mov_b32 m0, s93
    s_add_u32 s93, s93, 1024
    global_load_lds_dwordx4 v251, s[94:95]
    s_add_u32 s94, s94, 1024
    s_addc_u32 s95, s95, 0
    s_sub_u32 s82, s82, 1
    s_cmp_lg_u32 s82, 0
    s_cbranch_scc1 L_xl
    v_and_b32 v4, 7, v0
    v_lshlrev_b32 v4, 1, v4
    v_bfe_u32 v5, v0, 3, 1
    v_add_u32 v4, v4, v5
    v_mul_u32_u24 v4, 1152, v4
    v_lshrrev_b32 v5, 4, v0
    v_lshl_add_u32 v4, v5, 3, v4
    s_mul_i32 s93, s33, 36864
    v_add_u32 v4, s93, v4
    s_mul_i32 s92, s57, 737280
    s_add_u32 s92, s92, s72
    s_add_u32 s92, s92, 30720000
    v_min_u32 v5, 2, v0
    v_lshlrev_b32 v5, 7, v5
    s_mul_i32 s24, s57, 384
    s_lshl_b32 s93, s33, 5
    s_add_u32 s24, s24, s93
    s_add_u32 s24, s24, 50331668
    s_waitcnt vmcnt(0)
    ds_read_b64 v[8:9], v4 offset:0
    ds_read_b64 v[10:11], v4 offset:18432
    ds_read_b64 v[12:13], v4 offset:32
    ds_read_b64 v[14:15], v4 offset:18464
    ds_read_b64 v[16:17], v4 offset:64
    ds_read_b64 v[18:19], v4 offset:18496
    ds_read_b64 v[20:21], v4 offset:96
    ds_read_b64 v[22:23], v4 offset:18528
    ds_read_b64 v[24:25], v4 offset:128
    ds_read_b64 v[26:27], v4 offset:18560
    ds_read_b64 v[28:29], v4 offset:160
    ds_read_b64 v[30:31], v4 offset:18592
    ds_read_b64 v[32:33], v4 offset:192
    ds_read_b64 v[34:35], v4 offset:18624
    ds_read_b64 v[36:37], v4 offset:224
    ds_read_b64 v[38:39], v4 offset:18656
    ds_read_b64 v[40:41], v4 offset:256
    ds_read_b64 v[42:43], v4 offset:18688
    ds_read_b64 v[44:45], v4 offset:288
    ds_read_b64 v[46:47], v4 offset:18720
    ds_read_b64 v[48:49], v4 offset:320
    ds_read_b64 v[50:51], v4 offset:18752
    ds_read_b64 v[52:53], v4 offset:352
    ds_read_b64 v[54:55], v4 offset:18784
    ds_read_b64 v[56:57], v4 offset:384
    ds_read_b64 v[58:59], v4 offset:18816
    ds_read_b64 v[60:61], v4 offset:416
    ds_read_b64 v[62:63], v4 offset:18848
    ds_read_b64 v[64:65], v4 offset:448
    ds_read_b64 v[66:67], v4 offset:18880
    ds_read_b64 v[68:69], v4 offset:480
    ds_read_b64 v[70:71], v4 offset:18912
    ds_read_b64 v[72:73], v4 offset:512
    ds_read_b64 v[74:75], v4 offset:18944
    ds_read_b64 v[76:77], v4 offset:544
    ds_read_b64 v[78:79], v4 offset:18976
    ds_read_b64 v[80:81], v4 offset:576
    ds_read_b64 v[82:83], v4 offset:19008
    ds_read_b64 v[84:85], v4 offset:608
    ds_read_b64 v[86:87], v4 offset:19040
    ds_read_b64 v[88:89], v4 offset:640
    ds_read_b64 v[90:91], v4 offset:19072
    ds_read_b64 v[92:93], v4 offset:672
    ds_read_b64 v[94:95], v4 offset:19104
    ds_read_b64 v[96:97], v4 offset:704
    ds_read_b64 v[98:99], v4 offset:19136
    ds_read_b64 v[100:101], v4 offset:736
    ds_read_b64 v[102:103], v4 offset:19168
    ds_read_b64 v[104:105], v4 offset:768
    ds_read_b64 v[106:107], v4 offset:19200
    ds_read_b64 v[108:109], v4 offset:800
    ds_read_b64 v[110:111], v4 offset:19232
    ds_read_b64 v[112:113], v4 offset:832
    ds_read_b64 v[114:115], v4 offset:19264
    ds_read_b64 v[116:117], v4 offset:864
    ds_read_b64 v[118:119], v4 offset:19296
    ds_read_b64 v[120:121], v4 offset:896
    ds_read_b64 v[122:123], v4 offset:19328
    ds_read_b64 v[124:125], v4 offset:928
    ds_read_b64 v[126:127], v4 offset:19360
    ds_read_b64 v[128:129], v4 offset:960
    ds_read_b64 v[130:131], v4 offset:19392
    ds_read_b64 v[132:133], v4 offset:992
    ds_read_b64 v[134:135], v4 offset:19424
    ds_read_b64 v[136:137], v4 offset:1024
    ds_read_b64 v[138:139], v4 offset:19456
    ds_read_b64 v[140:141], v4 offset:1056
    ds_read_b64 v[142:143], v4 offset:19488
    ds_read_b64 v[144:145], v4 offset:1088
    ds_read_b64 v[146:147], v4 offset:19520
    ds_read_b64 v[148:149], v4 offset:1120
    ds_read_b64 v[150:151], v4 offset:19552
    s_waitcnt lgkmcnt(0)
    s_add_u32 s93, s92, 0
    buffer_store_dwordx4 v[8:11], v251, s[20:23], s93 offen offset:0 sc1
    buffer_store_dwordx4 v[24:27], v251, s[20:23], s93 offen offset:1024 sc1
    buffer_store_dwordx4 v[40:43], v251, s[20:23], s93 offen offset:2048 sc1
    s_add_u32 s93, s92, 61440
    buffer_store_dwordx4 v[12:15], v251, s[20:23], s93 offen offset:0 sc1
    buffer_store_dwordx4 v[28:31], v251, s[20:23], s93 offen offset:1024 sc1
    buffer_store_dwordx4 v[44:47], v251, s[20:23], s93 offen offset:2048 sc1
    s_add_u32 s93, s92, 122880
    buffer_store_dwordx4 v[16:19], v251, s[20:23], s93 offen offset:0 sc1
    buffer_store_dwordx4 v[32:35], v251, s[20:23], s93 offen offset:1024 sc1
    buffer_store_dwordx4 v[48:51], v251, s[20:23], s93 offen offset:2048 sc1
    s_add_u32 s93, s92, 184320
    buffer_store_dwordx4 v[20:23], v251, s[20:23], s93 offen offset:0 sc1
    buffer_store_dwordx4 v[36:39], v251, s[20:23], s93 offen offset:1024 sc1
    buffer_store_dwordx4 v[52:55], v251, s[20:23], s93 offen offset:2048 sc1
    s_add_u32 s93, s92, 245760
    buffer_store_dwordx4 v[56:59], v251, s[20:23], s93 offen offset:0 sc1
    buffer_store_dwordx4 v[72:75], v251, s[20:23], s93 offen offset:1024 sc1
    buffer_store_dwordx4 v[88:91], v251, s[20:23], s93 offen offset:2048 sc1
    s_add_u32 s93, s92, 307200
    buffer_store_dwordx4 v[60:63], v251, s[20:23], s93 offen offset:0 sc1
    buffer_store_dwordx4 v[76:79], v251, s[20:23], s93 offen offset:1024 sc1
    buffer_store_dwordx4 v[92:95], v251, s[20:23], s93 offen offset:2048 sc1
    s_add_u32 s93, s92, 368640
    buffer_store_dwordx4 v[64:67], v251, s[20:23], s93 offen offset:0 sc1
    buffer_store_dwordx4 v[80:83], v251, s[20:23], s93 offen offset:1024 sc1
    buffer_store_dwordx4 v[96:99], v251, s[20:23], s93 offen offset:2048 sc1
    s_add_u32 s93, s92, 430080
    buffer_store_dwordx4 v[68:71], v251, s[20:23], s93 offen offset:0 sc1
    buffer_store_dwordx4 v[84:87], v251, s[20:23], s93 offen offset:1024 sc1
    buffer_store_dwordx4 v[100:103], v251, s[20:23], s93 offen offset:2048 sc1
    s_add_u32 s93, s92, 491520
    buffer_store_dwordx4 v[104:107], v251, s[20:23], s93 offen offset:0 sc1
    buffer_store_dwordx4 v[120:123], v251, s[20:23], s93 offen offset:1024 sc1
    buffer_store_dwordx4 v[136:139], v251, s[20:23], s93 offen offset:2048 sc1
    s_add_u32 s93, s92, 552960
    buffer_store_dwordx4 v[108:111], v251, s[20:23], s93 offen offset:0 sc1
    buffer_store_dwordx4 v[124:127], v251, s[20:23], s93 offen offset:1024 sc1
    buffer_store_dwordx4 v[140:143], v251, s[20:23], s93 offen offset:2048 sc1
    s_add_u32 s93, s92, 614400
    buffer_store_dwordx4 v[112:115], v251, s[20:23], s93 offen offset:0 sc1
    buffer_store_dwordx4 v[128:131], v251, s[20:23], s93 offen offset:1024 sc1
    buffer_store_dwordx4 v[144:147], v251, s[20:23], s93 offen offset:2048 sc1
    s_add_u32 s93, s92, 675840
    buffer_store_dwordx4 v[116:119], v251, s[20:23], s93 offen offset:0 sc1
    buffer_store_dwordx4 v[132:135], v251, s[20:23], s93 offen offset:1024 sc1
    buffer_store_dwordx4 v[148:151], v251, s[20:23], s93 offen offset:2048 sc1
    s_waitcnt vmcnt(0)
    buffer_store_dword v2, v5, s[20:23], s24 offen sc1
    s_branch C_fin
C_go:
C_loop:
    v_mfma_f32_16x16x32_bf16 v[96:99], v[16:19], a[0:3], v[96:99]
    v_mfma_f32_16x16x32_bf16 v[100:103], v[16:19], a[4:7], v[100:103]
    ds_read_b64_tr_b16 v[16:17], v13 offset:25600
    s_and_b32 s79, s75, 31
    v_mfma_f32_16x16x32_bf16 v[104:107], v[20:23], a[0:3], v[104:107]
    ds_read_b64_tr_b16 v[18:19], v13 offset:31744
    s_mul_i32 s80, s79, 73728
    v_mfma_f32_16x16x32_bf16 v[108:111], v[20:23], a[4:7], v[108:111]
    s_waitcnt lgkmcnt(6)
    ds_read_b64_tr_b16 v[20:21], v15 offset:25600
    v_mfma_f32_16x16x32_bf16 v[112:115], v[24:27], a[0:3], v[112:115]
    ds_read_b64_tr_b16 v[22:23], v15 offset:31744
    s_lshl_b32 s81, s79, 11
    v_mfma_f32_16x16x32_bf16 v[116:119], v[24:27], a[4:7], v[116:119]
    ds_read_b64_tr_b16 v[24:25], v10 offset:26624
    s_add_u32 s80, s80, s73
    v_mfma_f32_16x16x32_bf16 v[120:123], v[28:31], a[0:3], v[120:123]
    ds_read_b64_tr_b16 v[26:27], v10 offset:32768
    s_add_u32 s81, s81, s74
    v_mfma_f32_16x16x32_bf16 v[124:127], v[28:31], a[4:7], v[124:127]
    s_waitcnt lgkmcnt(6)
    ds_read_b64_tr_b16 v[28:29], v11 offset:26624
    v_mfma_f32_16x16x32_bf16 v[128:131], v[64:67], a[0:3], v[128:131]
    ds_read_b64_tr_b16 v[30:31], v11 offset:32768
    s_cmp_lt_u32 s79, 18
    v_mfma_f32_16x16x32_bf16 v[132:135], v[64:67], a[4:7], v[132:135]
    ds_read_b64_tr_b16 v[64:65], v13 offset:26624
    s_cselect_b32 s80, s80, 2147479552
    v_mfma_f32_16x16x32_bf16 v[136:139], v[68:71], a[0:3], v[136:139]
    ds_read_b64_tr_b16 v[66:67], v13 offset:32768
    s_cselect_b32 s81, s81, 2147479552
    v_mfma_f32_16x16x32_bf16 v[140:143], v[68:71], a[4:7], v[140:143]
    s_waitcnt lgkmcnt(6)
    ds_read_b64_tr_b16 v[68:69], v15 offset:26624
    v_mfma_f32_16x16x32_bf16 v[144:147], v[16:19], a[0:3], v[144:147]
    ds_read_b64_tr_b16 v[70:71], v15 offset:32768
    s_add_u32 m0, s72, 49152
    v_mfma_f32_16x16x32_bf16 v[148:151], v[16:19], a[4:7], v[148:151]
    ds_read_b64_tr_b16 v[16:17], v10 offset:36864
    buffer_load_dwordx4 a[80:83], v249, s[20:23], s81 offen offset:0 sc1
    v_mfma_f32_16x16x32_bf16 v[152:155], v[20:23], a[0:3], v[152:155]
    ds_read_b64_tr_b16 v[18:19], v10 offset:43008
    v_mfma_f32_16x16x32_bf16 v[156:159], v[20:23], a[4:7], v[156:159]
    s_waitcnt lgkmcnt(6)
    ds_read_b64_tr_b16 v[20:21], v11 offset:36864
    v_mfma_f32_16x16x32_bf16 v[160:163], v[24:27], a[0:3], v[160:163]
    ds_read_b64_tr_b16 v[22:23], v11 offset:43008
    buffer_load_dwordx4 v246, s[84:87], s80 offen offset:0 lds
    v_mfma_f32_16x16x32_bf16 v[164:167], v[24:27], a[4:7], v[164:167]
    ds_read_b64_tr_b16 v[24:25], v13 offset:36864
    v_mfma_f32_16x16x32_bf16 v[168:171], v[28:31], a[0:3], v[168:171]
    ds_read_b64_tr_b16 v[26:27], v13 offset:43008
    s_lshr_b32 s75, s75, 5
    v_mfma_f32_16x16x32_bf16 v[172:175], v[28:31], a[4:7], v[172:175]
    s_waitcnt lgkmcnt(6)
    ds_read_b64_tr_b16 v[28:29], v15 offset:36864
    v_mfma_f32_16x16x32_bf16 v[176:179], v[64:67], a[0:3], v[176:179]
    ds_read_b64_tr_b16 v[30:31], v15 offset:43008
    buffer_load_dwordx4 v247, s[84:87], s80 offen offset:1024 lds
    v_mfma_f32_16x16x32_bf16 v[180:183], v[64:67], a[4:7], v[180:183]
    ds_read_b64_tr_b16 v[64:65], v10 offset:37888
    v_mfma_f32_16x16x32_bf16 v[184:187], v[68:71], a[0:3], v[184:187]
    ds_read_b64_tr_b16 v[66:67], v10 offset:44032
    v_mfma_f32_16x16x32_bf16 v[188:191], v[68:71], a[4:7], v[188:191]
    s_waitcnt lgkmcnt(6)
    ds_read_b64_tr_b16 v[68:69], v11 offset:37888
    v_mfma_f32_16x16x32_bf16 v[96:99], v[16:19], a[8:11], v[96:99]
    ds_read_b64_tr_b16 v[70:71], v11 offset:44032
    buffer_load_dwordx4 v248, s[84:87], s80 offen offset:2048 lds
    v_mfma_f32_16x16x32_bf16 v[100:103], v[16:19], a[12:15], v[100:103]
    ds_read_b64_tr_b16 v[16:17], v13 offset:37888
    s_add_u32 m0, s72, 61440
    v_mfma_f32_16x16x32_bf16 v[104:107], v[20:23], a[8:11], v[104:107]
    ds_read_b64_tr_b16 v[18:19], v13 offset:44032
    buffer_load_dwordx4 a[84:87], v250, s[20:23], s81 offen offset:0 sc1
    v_mfma_f32_16x16x32_bf16 v[108:111], v[20:23], a[12:15], v[108:111]
    s_waitcnt lgkmcnt(6)
    ds_read_b64_tr_b16 v[20:21], v15 offset:37888
    v_mfma_f32_16x16x32_bf16 v[112:115], v[24:27], a[8:11], v[112:115]
    ds_read_b64_tr_b16 v[22:23], v15 offset:44032
    v_mfma_f32_16x16x32_bf16 v[116:119], v[24:27], a[12:15], v[116:119]
    ds_read_b64_tr_b16 v[24:25], v10 offset:38912
    s_add_u32 s80, s80, 36864
    v_mfma_f32_16x16x32_bf16 v[120:123], v[28:31], a[8:11], v[120:123]
    ds_read_b64_tr_b16 v[26:27], v10 offset:45056
    buffer_load_dwordx4 v246, s[84:87], s80 offen offset:0 lds
    v_mfma_f32_16x16x32_bf16 v[124:127], v[28:31], a[12:15], v[124:127]
    s_waitcnt lgkmcnt(6)
    ds_read_b64_tr_b16 v[28:29], v11 offset:38912
    v_mfma_f32_16x16x32_bf16 v[128:131], v[64:67], a[8:11], v[128:131]
    ds_read_b64_tr_b16 v[30:31], v11 offset:45056
    v_mfma_f32_16x16x32_bf16 v[132:135], v[64:67], a[12:15], v[132:135]
    ds_read_b64_tr_b16 v[64:65], v13 offset:38912
    v_mfma_f32_16x16x32_bf16 v[136:139], v[68:71], a[8:11], v[136:139]
    ds_read_b64_tr_b16 v[66:67], v13 offset:45056
    buffer_load_dwordx4 v247, s[84:87], s80 offen offset:1024 lds
    v_mfma_f32_16x16x32_bf16 v[140:143], v[68:71], a[12:15], v[140:143]
    s_waitcnt lgkmcnt(6)
    ds_read_b64_tr_b16 v[68:69], v15 offset:38912
    v_mfma_f32_16x16x32_bf16 v[144:147], v[16:19], a[8:11], v[144:147]
    ds_read_b64_tr_b16 v[70:71], v15 offset:45056
    v_mfma_f32_16x16x32_bf16 v[148:151], v[16:19], a[12:15], v[148:151]
    s_waitcnt vmcnt(33)
    s_barrier
    ds_read_b64_tr_b16 v[16:17], v240 offset:0
    v_mfma_f32_16x16x32_bf16 v[152:155], v[20:23], a[8:11], v[152:155]
    ds_read_b64_tr_b16 v[18:19], v240 offset:6144
    buffer_load_dwordx4 v248, s[84:87], s80 offen offset:2048 lds
    v_mfma_f32_16x16x32_bf16 v[156:159], v[20:23], a[12:15], v[156:159]
    s_waitcnt lgkmcnt(6)
    ds_read_b64_tr_b16 v[20:21], v241 offset:0
    v_mfma_f32_16x16x32_bf16 v[160:163], v[24:27], a[8:11], v[160:163]
    ds_read_b64_tr_b16 v[22:23], v241 offset:6144
    v_mfma_f32_16x16x32_bf16 v[164:167], v[24:27], a[12:15], v[164:167]
    ds_read_b64_tr_b16 v[24:25], v242 offset:0
    v_mfma_f32_16x16x32_bf16 v[168:171], v[28:31], a[8:11], v[168:171]
    ds_read_b64_tr_b16 v[26:27], v242 offset:6144
    buffer_load_dwordx4 a[88:91], v249, s[20:23], s81 offen offset:1024 sc1
    v_mfma_f32_16x16x32_bf16 v[172:175], v[28:31], a[12:15], v[172:175]
    s_waitcnt lgkmcnt(6)
    ds_read_b64_tr_b16 v[28:29], v243 offset:0
    v_mfma_f32_16x16x32_bf16 v[176:179], v[64:67], a[8:11], v[176:179]
    ds_read_b64_tr_b16 v[30:31], v243 offset:6144
    v_mfma_f32_16x16x32_bf16 v[180:183], v[64:67], a[12:15], v[180:183]
    ds_read_b64_tr_b16 v[64:65], v240 offset:1024
    v_mfma_f32_16x16x32_bf16 v[184:187], v[68:71], a[8:11], v[184:187]
    ds_read_b64_tr_b16 v[66:67], v240 offset:7168
    buffer_load_dwordx4 a[92:95], v250, s[20:23], s81 offen offset:1024 sc1
    v_mfma_f32_16x16x32_bf16 v[188:191], v[68:71], a[12:15], v[188:191]
    s_waitcnt lgkmcnt(6)
    ds_read_b64_tr_b16 v[68:69], v241 offset:1024
    ds_read_b64_tr_b16 v[70:71], v241 offset:7168
    v_mfma_f32_16x16x32_bf16 v[96:99], v[16:19], a[16:19], v[96:99]
    v_mfma_f32_16x16x32_bf16 v[100:103], v[16:19], a[20:23], v[100:103]
    ds_read_b64_tr_b16 v[16:17], v242 offset:1024
    s_and_b32 s79, s75, 31
    v_mfma_f32_16x16x32_bf16 v[104:107], v[20:23], a[16:19], v[104:107]
    ds_read_b64_tr_b16 v[18:19], v242 offset:7168
    s_mul_i32 s80, s79, 73728
    v_mfma_f32_16x16x32_bf16 v[108:111], v[20:23], a[20:23], v[108:111]
    s_waitcnt lgkmcnt(6)
    ds_read_b64_tr_b16 v[20:21], v243 offset:1024
    v_mfma_f32_16x16x32_bf16 v[112:115], v[24:27], a[16:19], v[112:115]
    ds_read_b64_tr_b16 v[22:23], v243 offset:7168
    s_lshl_b32 s81, s79, 11
    v_mfma_f32_16x16x32_bf16 v[116:119], v[24:27], a[20:23], v[116:119]
    ds_read_b64_tr_b16 v[24:25], v240 offset:2048
    s_add_u32 s80, s80, s73
    v_mfma_f32_16x16x32_bf16 v[120:123], v[28:31], a[16:19], v[120:123]
    ds_read_b64_tr_b16 v[26:27], v240 offset:8192
    s_add_u32 s81, s81, s74
    v_mfma_f32_16x16x32_bf16 v[124:127], v[28:31], a[20:23], v[124:127]
    s_waitcnt lgkmcnt(6)
    ds_read_b64_tr_b16 v[28:29], v241 offset:2048
    v_mfma_f32_16x16x32_bf16 v[128:131], v[64:67], a[16:19], v[128:131]
    ds_read_b64_tr_b16 v[30:31], v241 offset:8192
    s_cmp_lt_u32 s79, 18
    v_mfma_f32_16x16x32_bf16 v[132:135], v[64:67], a[20:23], v[132:135]
    ds_read_b64_tr_b16 v[64:65], v242 offset:2048
    s_cselect_b32 s80, s80, 2147479552
    v_mfma_f32_16x16x32_bf16 v[136:139], v[68:71], a[16:19], v[136:139]
    ds_read_b64_tr_b16 v[66:67], v242 offset:8192
    s_cselect_b32 s81, s81, 2147479552
    v_mfma_f32_16x16x32_bf16 v[140:143], v[68:71], a[20:23], v[140:143]
    s_waitcnt lgkmcnt(6)
    ds_read_b64_tr_b16 v[68:69], v243 offset:2048
    v_mfma_f32_16x16x32_bf16 v[144:147], v[16:19], a[16:19], v[144:147]
    ds_read_b64_tr_b16 v[70:71], v243 offset:8192
    s_add_u32 m0, s72, 73728
    v_mfma_f32_16x16x32_bf16 v[148:151], v[16:19], a[20:23], v[148:151]
    ds_read_b64_tr_b16 v[16:17], v240 offset:12288
    buffer_load_dwordx4 a[0:3], v249, s[20:23], s81 offen offset:0 sc1
    v_mfma_f32_16x16x32_bf16 v[152:155], v[20:23], a[16:19], v[152:155]
    ds_read_b64_tr_b16 v[18:19], v240 offset:18432
    v_mfma_f32_16x16x32_bf16 v[156:159], v[20:23], a[20:23], v[156:159]
    s_waitcnt lgkmcnt(6)
    ds_read_b64_tr_b16 v[20:21], v241 offset:12288
    v_mfma_f32_16x16x32_bf16 v[160:163], v[24:27], a[16:19], v[160:163]
    ds_read_b64_tr_b16 v[22:23], v241 offset:18432
    buffer_load_dwordx4 v246, s[84:87], s80 offen offset:0 lds
    v_mfma_f32_16x16x32_bf16 v[164:167], v[24:27], a[20:23], v[164:167]
    ds_read_b64_tr_b16 v[24:25], v242 offset:12288
    v_mfma_f32_16x16x32_bf16 v[168:171], v[28:31], a[16:19], v[168:171]
    ds_read_b64_tr_b16 v[26:27], v242 offset:18432
    s_lshr_b32 s75, s75, 5
    v_mfma_f32_16x16x32_bf16 v[172:175], v[28:31], a[20:23], v[172:175]
    s_waitcnt lgkmcnt(6)
    ds_read_b64_tr_b16 v[28:29], v243 offset:12288
    v_mfma_f32_16x16x32_bf16 v[176:179], v[64:67], a[16:19], v[176:179]
    ds_read_b64_tr_b16 v[30:31], v243 offset:18432
    buffer_load_dwordx4 v247, s[84:87], s80 offen offset:1024 lds
    v_mfma_f32_16x16x32_bf16 v[180:183], v[64:67], a[20:23], v[180:183]
    ds_read_b64_tr_b16 v[64:65], v240 offset:13312
    v_mfma_f32_16x16x32_bf16 v[184:187], v[68:71], a[16:19], v[184:187]
    ds_read_b64_tr_b16 v[66:67], v240 offset:19456
    v_mfma_f32_16x16x32_bf16 v[188:191], v[68:71], a[20:23], v[188:191]
    s_waitcnt lgkmcnt(6)
    ds_read_b64_tr_b16 v[68:69], v241 offset:13312
    v_mfma_f32_16x16x32_bf16 v[96:99], v[16:19], a[24:27], v[96:99]
    ds_read_b64_tr_b16 v[70:71], v241 offset:19456
    buffer_load_dwordx4 v248, s[84:87], s80 offen offset:2048 lds
    v_mfma_f32_16x16x32_bf16 v[100:103], v[16:19], a[28:31], v[100:103]
    ds_read_b64_tr_b16 v[16:17], v242 offset:13312
    s_add_u32 m0, s72, 86016
    v_mfma_f32_16x16x32_bf16 v[104:107], v[20:23], a[24:27], v[104:107]
    ds_read_b64_tr_b16 v[18:19], v242 offset:19456
    buffer_load_dwordx4 a[4:7], v250, s[20:23], s81 offen offset:0 sc1
    v_mfma_f32_16x16x32_bf16 v[108:111], v[20:23], a[28:31], v[108:111]
    s_waitcnt lgkmcnt(6)
    ds_read_b64_tr_b16 v[20:21], v243 offset:13312
    v_mfma_f32_16x16x32_bf16 v[112:115], v[24:27], a[24:27], v[112:115]
    ds_read_b64_tr_b16 v[22:23], v243 offset:19456
    v_mfma_f32_16x16x32_bf16 v[116:119], v[24:27], a[28:31], v[116:119]
    ds_read_b64_tr_b16 v[24:25], v240 offset:14336
    s_add_u32 s80, s80, 36864
    v_mfma_f32_16x16x32_bf16 v[120:123], v[28:31], a[24:27], v[120:123]
    ds_read_b64_tr_b16 v[26:27], v240 offset:20480
    buffer_load_dwordx4 v246, s[84:87], s80 offen offset:0 lds
    v_mfma_f32_16x16x32_bf16 v[124:127], v[28:31], a[28:31], v[124:127]
    s_waitcnt lgkmcnt(6)
    ds_read_b64_tr_b16 v[28:29], v241 offset:14336
    v_mfma_f32_16x16x32_bf16 v[128:131], v[64:67], a[24:27], v[128:131]
    ds_read_b64_tr_b16 v[30:31], v241 offset:20480
    v_mfma_f32_16x16x32_bf16 v[132:135], v[64:67], a[28:31], v[132:135]
    ds_read_b64_tr_b16 v[64:65], v242 offset:14336
    v_mfma_f32_16x16x32_bf16 v[136:139], v[68:71], a[24:27], v[136:139]
    ds_read_b64_tr_b16 v[66:67], v242 offset:20480
    buffer_load_dwordx4 v247, s[84:87], s80 offen offset:1024 lds
    v_mfma_f32_16x16x32_bf16 v[140:143], v[68:71], a[28:31], v[140:143]
    s_waitcnt lgkmcnt(6)
    ds_read_b64_tr_b16 v[68:69], v243 offset:14336
    v_mfma_f32_16x16x32_bf16 v[144:147], v[16:19], a[24:27], v[144:147]
    ds_read_b64_tr_b16 v[70:71], v243 offset:20480
    v_mfma_f32_16x16x32_bf16 v[148:151], v[16:19], a[28:31], v[148:151]
    s_waitcnt vmcnt(33)
    s_barrier
    ds_read_b64_tr_b16 v[16:17], v240 offset:24576
    v_mfma_f32_16x16x32_bf16 v[152:155], v[20:23], a[24:27], v[152:155]
    ds_read_b64_tr_b16 v[18:19], v240 offset:30720
    buffer_load_dwordx4 v248, s[84:87], s80 offen offset:2048 lds
    v_mfma_f32_16x16x32_bf16 v[156:159], v[20:23], a[28:31], v[156:159]
    s_waitcnt lgkmcnt(6)
    ds_read_b64_tr_b16 v[20:21], v241 offset:24576
    v_mfma_f32_16x16x32_bf16 v[160:163], v[24:27], a[24:27], v[160:163]
    ds_read_b64_tr_b16 v[22:23], v241 offset:30720
    v_mfma_f32_16x16x32_bf16 v[164:167], v[24:27], a[28:31], v[164:167]
    ds_read_b64_tr_b16 v[24:25], v242 offset:24576
    v_mfma_f32_16x16x32_bf16 v[168:171], v[28:31], a[24:27], v[168:171]
    ds_read_b64_tr_b16 v[26:27], v242 offset:30720
    buffer_load_dwordx4 a[8:11], v249, s[20:23], s81 offen offset:1024 sc1
    v_mfma_f32_16x16x32_bf16 v[172:175], v[28:31], a[28:31], v[172:175]
    s_waitcnt lgkmcnt(6)
    ds_read_b64_tr_b16 v[28:29], v243 offset:24576
    v_mfma_f32_16x16x32_bf16 v[176:179], v[64:67], a[24:27], v[176:179]
    ds_read_b64_tr_b16 v[30:31], v243 offset:30720
    v_mfma_f32_16x16x32_bf16 v[180:183], v[64:67], a[28:31], v[180:183]
    ds_read_b64_tr_b16 v[64:65], v240 offset:25600
    v_mfma_f32_16x16x32_bf16 v[184:187], v[68:71], a[24:27], v[184:187]
    ds_read_b64_tr_b16 v[66:67], v240 offset:31744
    buffer_load_dwordx4 a[12:15], v250, s[20:23], s81 offen offset:1024 sc1
    v_mfma_f32_16x16x32_bf16 v[188:191], v[68:71], a[28:31], v[188:191]
    s_waitcnt lgkmcnt(6)
    ds_read_b64_tr_b16 v[68:69], v241 offset:25600
    ds_read_b64_tr_b16 v[70:71], v241 offset:31744
    v_mfma_f32_16x16x32_bf16 v[96:99], v[16:19], a[32:35], v[96:99]
    v_mfma_f32_16x16x32_bf16 v[100:103], v[16:19], a[36:39], v[100:103]
    ds_read_b64_tr_b16 v[16:17], v242 offset:25600
    s_and_b32 s79, s75, 31
    v_mfma_f32_16x16x32_bf16 v[104:107], v[20:23], a[32:35], v[104:107]
    ds_read_b64_tr_b16 v[18:19], v242 offset:31744
    s_mul_i32 s80, s79, 73728
    v_mfma_f32_16x16x32_bf16 v[108:111], v[20:23], a[36:39], v[108:111]
    s_waitcnt lgkmcnt(6)
    ds_read_b64_tr_b16 v[20:21], v243 offset:25600
    v_mfma_f32_16x16x32_bf16 v[112:115], v[24:27], a[32:35], v[112:115]
    ds_read_b64_tr_b16 v[22:23], v243 offset:31744
    s_lshl_b32 s81, s79, 11
    v_mfma_f32_16x16x32_bf16 v[116:119], v[24:27], a[36:39], v[116:119]
    ds_read_b64_tr_b16 v[24:25], v240 offset:26624
    s_add_u32 s80, s80, s73
    v_mfma_f32_16x16x32_bf16 v[120:123], v[28:31], a[32:35], v[120:123]
    ds_read_b64_tr_b16 v[26:27], v240 offset:32768
    s_add_u32 s81, s81, s74
    v_mfma_f32_16x16x32_bf16 v[124:127], v[28:31], a[36:39], v[124:127]
    s_waitcnt lgkmcnt(6)
    ds_read_b64_tr_b16 v[28:29], v241 offset:26624
    v_mfma_f32_16x16x32_bf16 v[128:131], v[64:67], a[32:35], v[128:131]
    ds_read_b64_tr_b16 v[30:31], v241 offset:32768
    s_cmp_lt_u32 s79, 18
    v_mfma_f32_16x16x32_bf16 v[132:135], v[64:67], a[36:39], v[132:135]
    ds_read_b64_tr_b16 v[64:65], v242 offset:26624
    s_cselect_b32 s80, s80, 2147479552
    v_mfma_f32_16x16x32_bf16 v[136:139], v[68:71], a[32:35], v[136:139]
    ds_read_b64_tr_b16 v[66:67], v242 offset:32768
    s_cselect_b32 s81, s81, 2147479552
    v_mfma_f32_16x16x32_bf16 v[140:143], v[68:71], a[36:39], v[140:143]
    s_waitcnt lgkmcnt(6)
    ds_read_b64_tr_b16 v[68:69], v243 offset:26624
    v_mfma_f32_16x16x32_bf16 v[144:147], v[16:19], a[32:35], v[144:147]
    ds_read_b64_tr_b16 v[70:71], v243 offset:32768
    s_add_u32 m0, s72, 98304
    v_mfma_f32_16x16x32_bf16 v[148:151], v[16:19], a[36:39], v[148:151]
    ds_read_b64_tr_b16 v[16:17], v240 offset:36864
    buffer_load_dwordx4 a[16:19], v249, s[20:23], s81 offen offset:0 sc1
    v_mfma_f32_16x16x32_bf16 v[152:155], v[20:23], a[32:35], v[152:155]
    ds_read_b64_tr_b16 v[18:19], v240 offset:43008
    v_mfma_f32_16x16x32_bf16 v[156:159], v[20:23], a[36:39], v[156:159]
    s_waitcnt lgkmcnt(6)
    ds_read_b64_tr_b16 v[20:21], v241 offset:36864
    v_mfma_f32_16x16x32_bf16 v[160:163], v[24:27], a[32:35], v[160:163]
    ds_read_b64_tr_b16 v[22:23], v241 offset:43008
    buffer_load_dwordx4 v246, s[84:87], s80 offen offset:0 lds
    v_mfma_f32_16x16x32_bf16 v[164:167], v[24:27], a[36:39], v[164:167]
    ds_read_b64_tr_b16 v[24:25], v242 offset:36864
    v_mfma_f32_16x16x32_bf16 v[168:171], v[28:31], a[32:35], v[168:171]
    ds_read_b64_tr_b16 v[26:27], v242 offset:43008
    s_lshr_b32 s75, s75, 5
    v_mfma_f32_16x16x32_bf16 v[172:175], v[28:31], a[36:39], v[172:175]
    s_waitcnt lgkmcnt(6)
    ds_read_b64_tr_b16 v[28:29], v243 offset:36864
    v_mfma_f32_16x16x32_bf16 v[176:179], v[64:67], a[32:35], v[176:179]
    ds_read_b64_tr_b16 v[30:31], v243 offset:43008
    buffer_load_dwordx4 v247, s[84:87], s80 offen offset:1024 lds
    v_mfma_f32_16x16x32_bf16 v[180:183], v[64:67], a[36:39], v[180:183]
    ds_read_b64_tr_b16 v[64:65], v240 offset:37888
    v_mfma_f32_16x16x32_bf16 v[184:187], v[68:71], a[32:35], v[184:187]
    ds_read_b64_tr_b16 v[66:67], v240 offset:44032
    v_mfma_f32_16x16x32_bf16 v[188:191], v[68:71], a[36:39], v[188:191]
    s_waitcnt lgkmcnt(6)
    ds_read_b64_tr_b16 v[68:69], v241 offset:37888
    v_mfma_f32_16x16x32_bf16 v[96:99], v[16:19], a[40:43], v[96:99]
    ds_read_b64_tr_b16 v[70:71], v241 offset:44032
    buffer_load_dwordx4 v248, s[84:87], s80 offen offset:2048 lds
    v_mfma_f32_16x16x32_bf16 v[100:103], v[16:19], a[44:47], v[100:103]
    ds_read_b64_tr_b16 v[16:17], v242 offset:37888
    s_add_u32 m0, s72, 110592
    v_mfma_f32_16x16x32_bf16 v[104:107], v[20:23], a[40:43], v[104:107]
    ds_read_b64_tr_b16 v[18:19], v242 offset:44032
    buffer_load_dwordx4 a[20:23], v250, s[20:23], s81 offen offset:0 sc1
    v_mfma_f32_16x16x32_bf16 v[108:111], v[20:23], a[44:47], v[108:111]
    s_waitcnt lgkmcnt(6)
    ds_read_b64_tr_b16 v[20:21], v243 offset:37888
    v_mfma_f32_16x16x32_bf16 v[112:115], v[24:27], a[40:43], v[112:115]
    ds_read_b64_tr_b16 v[22:23], v243 offset:44032
    v_mfma_f32_16x16x32_bf16 v[116:119], v[24:27], a[44:47], v[116:119]
    ds_read_b64_tr_b16 v[24:25], v240 offset:38912
    s_add_u32 s80, s80, 36864
    v_mfma_f32_16x16x32_bf16 v[120:123], v[28:31], a[40:43], v[120:123]
    ds_read_b64_tr_b16 v[26:27], v240 offset:45056
    buffer_load_dwordx4 v246, s[84:87], s80 offen offset:0 lds
    v_mfma_f32_16x16x32_bf16 v[124:127], v[28:31], a[44:47], v[124:127]
    s_waitcnt lgkmcnt(6)
    ds_read_b64_tr_b16 v[28:29], v241 offset:38912
    v_mfma_f32_16x16x32_bf16 v[128:131], v[64:67], a[40:43], v[128:131]
    ds_read_b64_tr_b16 v[30:31], v241 offset:45056
    v_mfma_f32_16x16x32_bf16 v[132:135], v[64:67], a[44:47], v[132:135]
    ds_read_b64_tr_b16 v[64:65], v242 offset:38912
    v_mfma_f32_16x16x32_bf16 v[136:139], v[68:71], a[40:43], v[136:139]
    ds_read_b64_tr_b16 v[66:67], v242 offset:45056
    buffer_load_dwordx4 v247, s[84:87], s80 offen offset:1024 lds
    v_mfma_f32_16x16x32_bf16 v[140:143], v[68:71], a[44:47], v[140:143]
    s_waitcnt lgkmcnt(6)
    ds_read_b64_tr_b16 v[68:69], v243 offset:38912
    v_mfma_f32_16x16x32_bf16 v[144:147], v[16:19], a[40:43], v[144:147]
    ds_read_b64_tr_b16 v[70:71], v243 offset:45056
    v_mfma_f32_16x16x32_bf16 v[148:151], v[16:19], a[44:47], v[148:151]
    s_waitcnt vmcnt(33)
    s_barrier
    ds_read_b64_tr_b16 v[16:17], v6 offset:0
    v_mfma_f32_16x16x32_bf16 v[152:155], v[20:23], a[40:43], v[152:155]
    ds_read_b64_tr_b16 v[18:19], v6 offset:6144
    buffer_load_dwordx4 v248, s[84:87], s80 offen offset:2048 lds
    v_mfma_f32_16x16x32_bf16 v[156:159], v[20:23], a[44:47], v[156:159]
    s_waitcnt lgkmcnt(6)
    ds_read_b64_tr_b16 v[20:21], v7 offset:0
    v_mfma_f32_16x16x32_bf16 v[160:163], v[24:27], a[40:43], v[160:163]
    ds_read_b64_tr_b16 v[22:23], v7 offset:6144
    v_mfma_f32_16x16x32_bf16 v[164:167], v[24:27], a[44:47], v[164:167]
    ds_read_b64_tr_b16 v[24:25], v8 offset:0
    v_mfma_f32_16x16x32_bf16 v[168:171], v[28:31], a[40:43], v[168:171]
    ds_read_b64_tr_b16 v[26:27], v8 offset:6144
    buffer_load_dwordx4 a[24:27], v249, s[20:23], s81 offen offset:1024 sc1
    v_mfma_f32_16x16x32_bf16 v[172:175], v[28:31], a[44:47], v[172:175]
    s_waitcnt lgkmcnt(6)
    ds_read_b64_tr_b16 v[28:29], v9 offset:0
    v_mfma_f32_16x16x32_bf16 v[176:179], v[64:67], a[40:43], v[176:179]
    ds_read_b64_tr_b16 v[30:31], v9 offset:6144
    v_mfma_f32_16x16x32_bf16 v[180:183], v[64:67], a[44:47], v[180:183]
    ds_read_b64_tr_b16 v[64:65], v6 offset:1024
    v_mfma_f32_16x16x32_bf16 v[184:187], v[68:71], a[40:43], v[184:187]
    ds_read_b64_tr_b16 v[66:67], v6 offset:7168
    buffer_load_dwordx4 a[28:31], v250, s[20:23], s81 offen offset:1024 sc1
    v_mfma_f32_16x16x32_bf16 v[188:191], v[68:71], a[44:47], v[188:191]
    s_waitcnt lgkmcnt(6)
    ds_read_b64_tr_b16 v[68:69], v7 offset:1024
    ds_read_b64_tr_b16 v[70:71], v7 offset:7168
    s_cmp_eq_u32 s82, 3
    s_cbranch_scc1 C_done
    v_mfma_f32_16x16x32_bf16 v[96:99], v[16:19], a[48:51], v[96:99]
    v_mfma_f32_16x16x32_bf16 v[100:103], v[16:19], a[52:55], v[100:103]
    ds_read_b64_tr_b16 v[16:17], v8 offset:1024
    s_cmp_eq_u32 s27, 0
    s_cbranch_scc1 K_C_sk
    s_add_u32 s6, s67, s27
    v_subrev_u32 v245, s6, v245
    v_cmp_lt_u32 vcc, 2, v245
    s_mov_b32 s3, 0
    s_cbranch_vccz K_C_ok
K_C_c:
    buffer_load_dword v245, v244, s[20:23], s26 offen sc1
    s_add_u32 s3, s3, 1
    s_cmp_gt_u32 s3, 1000000
    s_cbranch_scc1 K_C_ok
    s_waitcnt vmcnt(0)
    v_subrev_u32 v245, s6, v245
    v_cmp_lt_u32 vcc, 2, v245
    s_nop 0
    s_cbranch_vccnz K_C_c
K_C_ok:
    s_mov_b32 s27, 3
K_C_sk:
    v_mfma_f32_16x16x32_bf16 v[104:107], v[20:23], a[48:51], v[104:107]
    ds_read_b64_tr_b16 v[18:19], v8 offset:7168
    buffer_store_dword v255, off, s[20:23], s25 sc1
    v_mfma_f32_16x16x32_bf16 v[108:111], v[20:23], a[52:55], v[108:111]
    s_waitcnt lgkmcnt(6)
    ds_read_b64_tr_b16 v[20:21], v9 offset:1024
    v_mfma_f32_16x16x32_bf16 v[112:115], v[24:27], a[48:51], v[112:115]
    ds_read_b64_tr_b16 v[22:23], v9 offset:7168
    s_mov_b32 s25, 2147479552
    v_mfma_f32_16x16x32_bf16 v[116:119], v[24:27], a[52:55], v[116:119]
    ds_read_b64_tr_b16 v[24:25], v6 offset:2048
    s_and_b32 s79, s75, 31
    v_mfma_f32_16x16x32_bf16 v[120:123], v[28:31], a[48:51], v[120:123]
    ds_read_b64_tr_b16 v[26:27], v6 offset:8192
    s_mul_i32 s80, s79, 73728
    v_mfma_f32_16x16x32_bf16 v[124:127], v[28:31], a[52:55], v[124:127]
    s_waitcnt lgkmcnt(6)
    ds_read_b64_tr_b16 v[28:29], v7 offset:2048
    v_mfma_f32_16x16x32_bf16 v[128:131], v[64:67], a[48:51], v[128:131]
    ds_read_b64_tr_b16 v[30:31], v7 offset:8192
    s_lshl_b32 s81, s79, 11
    v_mfma_f32_16x16x32_bf16 v[132:135], v[64:67], a[52:55], v[132:135]
    ds_read_b64_tr_b16 v[64:65], v8 offset:2048
    s_add_u32 s80, s80, s73
    v_mfma_f32_16x16x32_bf16 v[136:139], v[68:71], a[48:51], v[136:139]
    ds_read_b64_tr_b16 v[66:67], v8 offset:8192
    s_add_u32 s81, s81, s74
    v_mfma_f32_16x16x32_bf16 v[140:143], v[68:71], a[52:55], v[140:143]
    s_waitcnt lgkmcnt(6)
    ds_read_b64_tr_b16 v[68:69], v9 offset:2048
    v_mfma_f32_16x16x32_bf16 v[144:147], v[16:19], a[48:51], v[144:147]
    ds_read_b64_tr_b16 v[70:71], v9 offset:8192
    s_cmp_lt_u32 s79, 18
    v_mfma_f32_16x16x32_bf16 v[148:151], v[16:19], a[52:55], v[148:151]
    ds_read_b64_tr_b16 v[16:17], v6 offset:12288
    s_cselect_b32 s80, s80, 2147479552
    v_mfma_f32_16x16x32_bf16 v[152:155], v[20:23], a[48:51], v[152:155]
    ds_read_b64_tr_b16 v[18:19], v6 offset:18432
    s_cselect_b32 s81, s81, 2147479552
    v_mfma_f32_16x16x32_bf16 v[156:159], v[20:23], a[52:55], v[156:159]
    s_waitcnt lgkmcnt(6)
    ds_read_b64_tr_b16 v[20:21], v7 offset:12288
    v_mfma_f32_16x16x32_bf16 v[160:163], v[24:27], a[48:51], v[160:163]
    ds_read_b64_tr_b16 v[22:23], v7 offset:18432
    s_add_u32 m0, s72, 122880
    v_mfma_f32_16x16x32_bf16 v[164:167], v[24:27], a[52:55], v[164:167]
    ds_read_b64_tr_b16 v[24:25], v8 offset:12288
    buffer_load_dwordx4 a[32:35], v249, s[20:23], s81 offen offset:0 sc1
    v_mfma_f32_16x16x32_bf16 v[168:171], v[28:31], a[48:51], v[168:171]
    ds_read_b64_tr_b16 v[26:27], v8 offset:18432
    v_mfma_f32_16x16x32_bf16 v[172:175], v[28:31], a[52:55], v[172:175]
    s_waitcnt lgkmcnt(6)
    ds_read_b64_tr_b16 v[28:29], v9 offset:12288
    v_mfma_f32_16x16x32_bf16 v[176:179], v[64:67], a[48:51], v[176:179]
    ds_read_b64_tr_b16 v[30:31], v9 offset:18432
    buffer_load_dwordx4 v246, s[84:87], s80 offen offset:0 lds
    v_mfma_f32_16x16x32_bf16 v[180:183], v[64:67], a[52:55], v[180:183]
    ds_read_b64_tr_b16 v[64:65], v6 offset:13312
    s_lshr_b32 s75, s75, 5
    v_mfma_f32_16x16x32_bf16 v[184:187], v[68:71], a[48:51], v[184:187]
    ds_read_b64_tr_b16 v[66:67], v6 offset:19456
    buffer_load_dwordx4 v247, s[84:87], s80 offen offset:1024 lds
    v_mfma_f32_16x16x32_bf16 v[188:191], v[68:71], a[52:55], v[188:191]
    s_waitcnt lgkmcnt(6)
    ds_read_b64_tr_b16 v[68:69], v7 offset:13312
    v_mfma_f32_16x16x32_bf16 v[96:99], v[16:19], a[56:59], v[96:99]
    ds_read_b64_tr_b16 v[70:71], v7 offset:19456
    v_mfma_f32_16x16x32_bf16 v[100:103], v[16:19], a[60:63], v[100:103]
    ds_read_b64_tr_b16 v[16:17], v8 offset:13312
    v_mfma_f32_16x16x32_bf16 v[104:107], v[20:23], a[56:59], v[104:107]
    ds_read_b64_tr_b16 v[18:19], v8 offset:19456
    buffer_load_dwordx4 v248, s[84:87], s80 offen offset:2048 lds
    v_mfma_f32_16x16x32_bf16 v[108:111], v[20:23], a[60:63], v[108:111]
    s_waitcnt lgkmcnt(6)
    ds_read_b64_tr_b16 v[20:21], v9 offset:13312
    v_mfma_f32_16x16x32_bf16 v[112:115], v[24:27], a[56:59], v[112:115]
    ds_read_b64_tr_b16 v[22:23], v9 offset:19456
    s_add_u32 m0, s72, 135168
    v_mfma_f32_16x16x32_bf16 v[116:119], v[24:27], a[60:63], v[116:119]
    ds_read_b64_tr_b16 v[24:25], v6 offset:14336
    buffer_load_dwordx4 a[36:39], v250, s[20:23], s81 offen offset:0 sc1
    v_mfma_f32_16x16x32_bf16 v[120:123], v[28:31], a[56:59], v[120:123]
    ds_read_b64_tr_b16 v[26:27], v6 offset:20480
    s_add_u32 s80, s80, 36864
    v_mfma_f32_16x16x32_bf16 v[124:127], v[28:31], a[60:63], v[124:127]
    s_waitcnt lgkmcnt(6)
    ds_read_b64_tr_b16 v[28:29], v7 offset:14336
    v_mfma_f32_16x16x32_bf16 v[128:131], v[64:67], a[56:59], v[128:131]
    ds_read_b64_tr_b16 v[30:31], v7 offset:20480
    buffer_load_dwordx4 v246, s[84:87], s80 offen offset:0 lds
    v_mfma_f32_16x16x32_bf16 v[132:135], v[64:67], a[60:63], v[132:135]
    ds_read_b64_tr_b16 v[64:65], v8 offset:14336
    v_mfma_f32_16x16x32_bf16 v[136:139], v[68:71], a[56:59], v[136:139]
    ds_read_b64_tr_b16 v[66:67], v8 offset:20480
    v_mfma_f32_16x16x32_bf16 v[140:143], v[68:71], a[60:63], v[140:143]
    s_waitcnt lgkmcnt(6)
    ds_read_b64_tr_b16 v[68:69], v9 offset:14336
    v_mfma_f32_16x16x32_bf16 v[144:147], v[16:19], a[56:59], v[144:147]
    ds_read_b64_tr_b16 v[70:71], v9 offset:20480
    buffer_load_dwordx4 v247, s[84:87], s80 offen offset:1024 lds
    v_mfma_f32_16x16x32_bf16 v[148:151], v[16:19], a[60:63], v[148:151]
    s_waitcnt vmcnt(33)
    s_barrier
    ds_read_b64_tr_b16 v[16:17], v6 offset:24576
    v_mfma_f32_16x16x32_bf16 v[152:155], v[20:23], a[56:59], v[152:155]
    ds_read_b64_tr_b16 v[18:19], v6 offset:30720
    v_mfma_f32_16x16x32_bf16 v[156:159], v[20:23], a[60:63], v[156:159]
    s_waitcnt lgkmcnt(6)
    ds_read_b64_tr_b16 v[20:21], v7 offset:24576
    v_mfma_f32_16x16x32_bf16 v[160:163], v[24:27], a[56:59], v[160:163]
    ds_read_b64_tr_b16 v[22:23], v7 offset:30720
    buffer_load_dwordx4 v248, s[84:87], s80 offen offset:2048 lds
    v_mfma_f32_16x16x32_bf16 v[164:167], v[24:27], a[60:63], v[164:167]
    ds_read_b64_tr_b16 v[24:25], v8 offset:24576
    v_mfma_f32_16x16x32_bf16 v[168:171], v[28:31], a[56:59], v[168:171]
    ds_read_b64_tr_b16 v[26:27], v8 offset:30720
    buffer_load_dwordx4 a[40:43], v249, s[20:23], s81 offen offset:1024 sc1
    v_mfma_f32_16x16x32_bf16 v[172:175], v[28:31], a[60:63], v[172:175]
    s_waitcnt lgkmcnt(6)
    ds_read_b64_tr_b16 v[28:29], v9 offset:24576
    v_mfma_f32_16x16x32_bf16 v[176:179], v[64:67], a[56:59], v[176:179]
    ds_read_b64_tr_b16 v[30:31], v9 offset:30720
    v_mfma_f32_16x16x32_bf16 v[180:183], v[64:67], a[60:63], v[180:183]
    ds_read_b64_tr_b16 v[64:65], v6 offset:25600
    v_mfma_f32_16x16x32_bf16 v[184:187], v[68:71], a[56:59], v[184:187]
    ds_read_b64_tr_b16 v[66:67], v6 offset:31744
    buffer_load_dwordx4 a[44:47], v250, s[20:23], s81 offen offset:1024 sc1
    v_mfma_f32_16x16x32_bf16 v[188:191], v[68:71], a[60:63], v[188:191]
    s_waitcnt lgkmcnt(6)
    ds_read_b64_tr_b16 v[68:69], v7 offset:25600
    ds_read_b64_tr_b16 v[70:71], v7 offset:31744
    v_mfma_f32_16x16x32_bf16 v[96:99], v[16:19], a[64:67], v[96:99]
    v_mfma_f32_16x16x32_bf16 v[100:103], v[16:19], a[68:71], v[100:103]
    ds_read_b64_tr_b16 v[16:17], v8 offset:25600
    s_and_b32 s79, s75, 31
    v_mfma_f32_16x16x32_bf16 v[104:107], v[20:23], a[64:67], v[104:107]
    ds_read_b64_tr_b16 v[18:19], v8 offset:31744
    s_mul_i32 s80, s79, 73728
    v_mfma_f32_16x16x32_bf16 v[108:111], v[20:23], a[68:71], v[108:111]
    s_waitcnt lgkmcnt(6)
    ds_read_b64_tr_b16 v[20:21], v9 offset:25600
    v_mfma_f32_16x16x32_bf16 v[112:115], v[24:27], a[64:67], v[112:115]
    ds_read_b64_tr_b16 v[22:23], v9 offset:31744
    s_lshl_b32 s81, s79, 11
    v_mfma_f32_16x16x32_bf16 v[116:119], v[24:27], a[68:71], v[116:119]
    ds_read_b64_tr_b16 v[24:25], v6 offset:26624
    s_add_u32 s80, s80, s73
    v_mfma_f32_16x16x32_bf16 v[120:123], v[28:31], a[64:67], v[120:123]
    ds_read_b64_tr_b16 v[26:27], v6 offset:32768
    s_add_u32 s81, s81, s74
    v_mfma_f32_16x16x32_bf16 v[124:127], v[28:31], a[68:71], v[124:127]
    s_waitcnt lgkmcnt(6)
    ds_read_b64_tr_b16 v[28:29], v7 offset:26624
    v_mfma_f32_16x16x32_bf16 v[128:131], v[64:67], a[64:67], v[128:131]
    ds_read_b64_tr_b16 v[30:31], v7 offset:32768
    s_cmp_lt_u32 s79, 18
    v_mfma_f32_16x16x32_bf16 v[132:135], v[64:67], a[68:71], v[132:135]
    ds_read_b64_tr_b16 v[64:65], v8 offset:26624
    s_cselect_b32 s80, s80, 2147479552
    v_mfma_f32_16x16x32_bf16 v[136:139], v[68:71], a[64:67], v[136:139]
    ds_read_b64_tr_b16 v[66:67], v8 offset:32768
    s_cselect_b32 s81, s81, 2147479552
    v_mfma_f32_16x16x32_bf16 v[140:143], v[68:71], a[68:71], v[140:143]
    s_waitcnt lgkmcnt(6)
    ds_read_b64_tr_b16 v[68:69], v9 offset:26624
    v_mfma_f32_16x16x32_bf16 v[144:147], v[16:19], a[64:67], v[144:147]
    ds_read_b64_tr_b16 v[70:71], v9 offset:32768
    s_add_u32 m0, s72, 0
    v_mfma_f32_16x16x32_bf16 v[148:151], v[16:19], a[68:71], v[148:151]
    ds_read_b64_tr_b16 v[16:17], v6 offset:36864
    buffer_load_dwordx4 a[48:51], v249, s[20:23], s81 offen offset:0 sc1
    v_mfma_f32_16x16x32_bf16 v[152:155], v[20:23], a[64:67], v[152:155]
    ds_read_b64_tr_b16 v[18:19], v6 offset:43008
    v_mfma_f32_16x16x32_bf16 v[156:159], v[20:23], a[68:71], v[156:159]
    s_waitcnt lgkmcnt(6)
    ds_read_b64_tr_b16 v[20:21], v7 offset:36864
    v_mfma_f32_16x16x32_bf16 v[160:163], v[24:27], a[64:67], v[160:163]
    ds_read_b64_tr_b16 v[22:23], v7 offset:43008
    buffer_load_dwordx4 v246, s[84:87], s80 offen offset:0 lds
    v_mfma_f32_16x16x32_bf16 v[164:167], v[24:27], a[68:71], v[164:167]
    ds_read_b64_tr_b16 v[24:25], v8 offset:36864
    v_mfma_f32_16x16x32_bf16 v[168:171], v[28:31], a[64:67], v[168:171]
    ds_read_b64_tr_b16 v[26:27], v8 offset:43008
    s_lshr_b32 s75, s75, 5
    v_mfma_f32_16x16x32_bf16 v[172:175], v[28:31], a[68:71], v[172:175]
    s_waitcnt lgkmcnt(6)
    ds_read_b64_tr_b16 v[28:29], v9 offset:36864
    v_mfma_f32_16x16x32_bf16 v[176:179], v[64:67], a[64:67], v[176:179]
    ds_read_b64_tr_b16 v[30:31], v9 offset:43008
    buffer_load_dwordx4 v247, s[84:87], s80 offen offset:1024 lds
    v_mfma_f32_16x16x32_bf16 v[180:183], v[64:67], a[68:71], v[180:183]
    ds_read_b64_tr_b16 v[64:65], v6 offset:37888
    v_mfma_f32_16x16x32_bf16 v[184:187], v[68:71], a[64:67], v[184:187]
    ds_read_b64_tr_b16 v[66:67], v6 offset:44032
    v_mfma_f32_16x16x32_bf16 v[188:191], v[68:71], a[68:71], v[188:191]
    s_waitcnt lgkmcnt(6)
    ds_read_b64_tr_b16 v[68:69], v7 offset:37888
    v_mfma_f32_16x16x32_bf16 v[96:99], v[16:19], a[72:75], v[96:99]
    ds_read_b64_tr_b16 v[70:71], v7 offset:44032
    buffer_load_dwordx4 v248, s[84:87], s80 offen offset:2048 lds
    v_mfma_f32_16x16x32_bf16 v[100:103], v[16:19], a[76:79], v[100:103]
    ds_read_b64_tr_b16 v[16:17], v8 offset:37888
    s_add_u32 m0, s72, 12288
    v_mfma_f32_16x16x32_bf16 v[104:107], v[20:23], a[72:75], v[104:107]
    ds_read_b64_tr_b16 v[18:19], v8 offset:44032
    buffer_load_dwordx4 a[52:55], v250, s[20:23], s81 offen offset:0 sc1
    v_mfma_f32_16x16x32_bf16 v[108:111], v[20:23], a[76:79], v[108:111]
    s_waitcnt lgkmcnt(6)
    ds_read_b64_tr_b16 v[20:21], v9 offset:37888
    v_mfma_f32_16x16x32_bf16 v[112:115], v[24:27], a[72:75], v[112:115]
    ds_read_b64_tr_b16 v[22:23], v9 offset:44032
    v_mfma_f32_16x16x32_bf16 v[116:119], v[24:27], a[76:79], v[116:119]
    ds_read_b64_tr_b16 v[24:25], v6 offset:38912
    s_add_u32 s80, s80, 36864
    v_mfma_f32_16x16x32_bf16 v[120:123], v[28:31], a[72:75], v[120:123]
    ds_read_b64_tr_b16 v[26:27], v6 offset:45056
    buffer_load_dwordx4 v246, s[84:87], s80 offen offset:0 lds
    v_mfma_f32_16x16x32_bf16 v[124:127], v[28:31], a[76:79], v[124:127]
    s_waitcnt lgkmcnt(6)
    ds_read_b64_tr_b16 v[28:29], v7 offset:38912
    v_mfma_f32_16x16x32_bf16 v[128:131], v[64:67], a[72:75], v[128:131]
    ds_read_b64_tr_b16 v[30:31], v7 offset:45056
    v_mfma_f32_16x16x32_bf16 v[132:135], v[64:67], a[76:79], v[132:135]
    ds_read_b64_tr_b16 v[64:65], v8 offset:38912
    v_mfma_f32_16x16x32_bf16 v[136:139], v[68:71], a[72:75], v[136:139]
    ds_read_b64_tr_b16 v[66:67], v8 offset:45056
    buffer_load_dwordx4 v247, s[84:87], s80 offen offset:1024 lds
    v_mfma_f32_16x16x32_bf16 v[140:143], v[68:71], a[76:79], v[140:143]
    s_waitcnt lgkmcnt(6)
    ds_read_b64_tr_b16 v[68:69], v9 offset:38912
    v_mfma_f32_16x16x32_bf16 v[144:147], v[16:19], a[72:75], v[144:147]
    ds_read_b64_tr_b16 v[70:71], v9 offset:45056
    v_mfma_f32_16x16x32_bf16 v[148:151], v[16:19], a[76:79], v[148:151]
    s_waitcnt vmcnt(33)
    s_barrier
    ds_read_b64_tr_b16 v[16:17], v10 offset:0
    v_mfma_f32_16x16x32_bf16 v[152:155], v[20:23], a[72:75], v[152:155]
    ds_read_b64_tr_b16 v[18:19], v10 offset:6144
    buffer_load_dwordx4 v248, s[84:87], s80 offen offset:2048 lds
    v_mfma_f32_16x16x32_bf16 v[156:159], v[20:23], a[76:79], v[156:159]
    s_waitcnt lgkmcnt(6)
    ds_read_b64_tr_b16 v[20:21], v11 offset:0
    v_mfma_f32_16x16x32_bf16 v[160:163], v[24:27], a[72:75], v[160:163]
    ds_read_b64_tr_b16 v[22:23], v11 offset:6144
    v_mfma_f32_16x16x32_bf16 v[164:167], v[24:27], a[76:79], v[164:167]
    ds_read_b64_tr_b16 v[24:25], v13 offset:0
    v_mfma_f32_16x16x32_bf16 v[168:171], v[28:31], a[72:75], v[168:171]
    ds_read_b64_tr_b16 v[26:27], v13 offset:6144
    buffer_load_dwordx4 a[56:59], v249, s[20:23], s81 offen offset:1024 sc1
    v_mfma_f32_16x16x32_bf16 v[172:175], v[28:31], a[76:79], v[172:175]
    s_waitcnt lgkmcnt(6)
    ds_read_b64_tr_b16 v[28:29], v15 offset:0
    v_mfma_f32_16x16x32_bf16 v[176:179], v[64:67], a[72:75], v[176:179]
    ds_read_b64_tr_b16 v[30:31], v15 offset:6144
    v_mfma_f32_16x16x32_bf16 v[180:183], v[64:67], a[76:79], v[180:183]
    ds_read_b64_tr_b16 v[64:65], v10 offset:1024
    v_mfma_f32_16x16x32_bf16 v[184:187], v[68:71], a[72:75], v[184:187]
    ds_read_b64_tr_b16 v[66:67], v10 offset:7168
    buffer_load_dwordx4 a[60:63], v250, s[20:23], s81 offen offset:1024 sc1
    v_mfma_f32_16x16x32_bf16 v[188:191], v[68:71], a[76:79], v[188:191]
    s_waitcnt lgkmcnt(6)
    ds_read_b64_tr_b16 v[68:69], v11 offset:1024
    ds_read_b64_tr_b16 v[70:71], v11 offset:7168
    v_mfma_f32_16x16x32_bf16 v[96:99], v[16:19], a[80:83], v[96:99]
    v_mfma_f32_16x16x32_bf16 v[100:103], v[16:19], a[84:87], v[100:103]
    ds_read_b64_tr_b16 v[16:17], v13 offset:1024
    buffer_load_dword v245, v244, s[20:23], s26 offen sc1
    v_mfma_f32_16x16x32_bf16 v[104:107], v[20:23], a[80:83], v[104:107]
    ds_read_b64_tr_b16 v[18:19], v13 offset:7168
    s_and_b32 s79, s75, 31
    v_mfma_f32_16x16x32_bf16 v[108:111], v[20:23], a[84:87], v[108:111]
    s_waitcnt lgkmcnt(6)
    ds_read_b64_tr_b16 v[20:21], v15 offset:1024
    v_mfma_f32_16x16x32_bf16 v[112:115], v[24:27], a[80:83], v[112:115]
    ds_read_b64_tr_b16 v[22:23], v15 offset:7168
    s_mul_i32 s80, s79, 73728
    v_mfma_f32_16x16x32_bf16 v[116:119], v[24:27], a[84:87], v[116:119]
    ds_read_b64_tr_b16 v[24:25], v10 offset:2048
    s_lshl_b32 s81, s79, 11
    v_mfma_f32_16x16x32_bf16 v[120:123], v[28:31], a[80:83], v[120:123]
    ds_read_b64_tr_b16 v[26:27], v10 offset:8192
    s_add_u32 s80, s80, s73
    v_mfma_f32_16x16x32_bf16 v[124:127], v[28:31], a[84:87], v[124:127]
    s_waitcnt lgkmcnt(6)
    ds_read_b64_tr_b16 v[28:29], v11 offset:2048
    v_mfma_f32_16x16x32_bf16 v[128:131], v[64:67], a[80:83], v[128:131]
    ds_read_b64_tr_b16 v[30:31], v11 offset:8192
    s_add_u32 s81, s81, s74
    v_mfma_f32_16x16x32_bf16 v[132:135], v[64:67], a[84:87], v[132:135]
    ds_read_b64_tr_b16 v[64:65], v13 offset:2048
    s_cmp_lt_u32 s79, 18
    v_mfma_f32_16x16x32_bf16 v[136:139], v[68:71], a[80:83], v[136:139]
    ds_read_b64_tr_b16 v[66:67], v13 offset:8192
    s_cselect_b32 s80, s80, 2147479552
    v_mfma_f32_16x16x32_bf16 v[140:143], v[68:71], a[84:87], v[140:143]
    s_waitcnt lgkmcnt(6)
    ds_read_b64_tr_b16 v[68:69], v15 offset:2048
    v_mfma_f32_16x16x32_bf16 v[144:147], v[16:19], a[80:83], v[144:147]
    ds_read_b64_tr_b16 v[70:71], v15 offset:8192
    s_cselect_b32 s81, s81, 2147479552
    v_mfma_f32_16x16x32_bf16 v[148:151], v[16:19], a[84:87], v[148:151]
    ds_read_b64_tr_b16 v[16:17], v10 offset:12288
    s_add_u32 m0, s72, 24576
    v_mfma_f32_16x16x32_bf16 v[152:155], v[20:23], a[80:83], v[152:155]
    ds_read_b64_tr_b16 v[18:19], v10 offset:18432
    buffer_load_dwordx4 a[64:67], v249, s[20:23], s81 offen offset:0 sc1
    v_mfma_f32_16x16x32_bf16 v[156:159], v[20:23], a[84:87], v[156:159]
    s_waitcnt lgkmcnt(6)
    ds_read_b64_tr_b16 v[20:21], v11 offset:12288
    v_mfma_f32_16x16x32_bf16 v[160:163], v[24:27], a[80:83], v[160:163]
    ds_read_b64_tr_b16 v[22:23], v11 offset:18432
    v_mfma_f32_16x16x32_bf16 v[164:167], v[24:27], a[84:87], v[164:167]
    ds_read_b64_tr_b16 v[24:25], v13 offset:12288
    buffer_load_dwordx4 v246, s[84:87], s80 offen offset:0 lds
    v_mfma_f32_16x16x32_bf16 v[168:171], v[28:31], a[80:83], v[168:171]
    ds_read_b64_tr_b16 v[26:27], v13 offset:18432
    v_mfma_f32_16x16x32_bf16 v[172:175], v[28:31], a[84:87], v[172:175]
    s_waitcnt lgkmcnt(6)
    ds_read_b64_tr_b16 v[28:29], v15 offset:12288
    v_mfma_f32_16x16x32_bf16 v[176:179], v[64:67], a[80:83], v[176:179]
    ds_read_b64_tr_b16 v[30:31], v15 offset:18432
    s_lshr_b32 s75, s75, 5
    v_mfma_f32_16x16x32_bf16 v[180:183], v[64:67], a[84:87], v[180:183]
    ds_read_b64_tr_b16 v[64:65], v10 offset:13312
    buffer_load_dwordx4 v247, s[84:87], s80 offen offset:1024 lds
    v_mfma_f32_16x16x32_bf16 v[184:187], v[68:71], a[80:83], v[184:187]
    ds_read_b64_tr_b16 v[66:67], v10 offset:19456
    v_mfma_f32_16x16x32_bf16 v[188:191], v[68:71], a[84:87], v[188:191]
    s_waitcnt lgkmcnt(6)
    ds_read_b64_tr_b16 v[68:69], v11 offset:13312
    v_mfma_f32_16x16x32_bf16 v[96:99], v[16:19], a[88:91], v[96:99]
    ds_read_b64_tr_b16 v[70:71], v11 offset:19456
    buffer_load_dwordx4 v248, s[84:87], s80 offen offset:2048 lds
    v_mfma_f32_16x16x32_bf16 v[100:103], v[16:19], a[92:95], v[100:103]
    ds_read_b64_tr_b16 v[16:17], v13 offset:13312
    v_mfma_f32_16x16x32_bf16 v[104:107], v[20:23], a[88:91], v[104:107]
    ds_read_b64_tr_b16 v[18:19], v13 offset:19456
    s_add_u32 m0, s72, 36864
    v_mfma_f32_16x16x32_bf16 v[108:111], v[20:23], a[92:95], v[108:111]
    s_waitcnt lgkmcnt(6)
    ds_read_b64_tr_b16 v[20:21], v15 offset:13312
    v_mfma_f32_16x16x32_bf16 v[112:115], v[24:27], a[88:91], v[112:115]
    ds_read_b64_tr_b16 v[22:23], v15 offset:19456
    buffer_load_dwordx4 a[68:71], v250, s[20:23], s81 offen offset:0 sc1
    v_mfma_f32_16x16x32_bf16 v[116:119], v[24:27], a[92:95], v[116:119]
    ds_read_b64_tr_b16 v[24:25], v10 offset:14336
    s_add_u32 s80, s80, 36864
    v_mfma_f32_16x16x32_bf16 v[120:123], v[28:31], a[88:91], v[120:123]
    ds_read_b64_tr_b16 v[26:27], v10 offset:20480
    buffer_load_dwordx4 v246, s[84:87], s80 offen offset:0 lds
    v_mfma_f32_16x16x32_bf16 v[124:127], v[28:31], a[92:95], v[124:127]
    s_waitcnt lgkmcnt(6)
    ds_read_b64_tr_b16 v[28:29], v11 offset:14336
    v_mfma_f32_16x16x32_bf16 v[128:131], v[64:67], a[88:91], v[128:131]
    ds_read_b64_tr_b16 v[30:31], v11 offset:20480
    v_mfma_f32_16x16x32_bf16 v[132:135], v[64:67], a[92:95], v[132:135]
    ds_read_b64_tr_b16 v[64:65], v13 offset:14336
    v_mfma_f32_16x16x32_bf16 v[136:139], v[68:71], a[88:91], v[136:139]
    ds_read_b64_tr_b16 v[66:67], v13 offset:20480
    buffer_load_dwordx4 v247, s[84:87], s80 offen offset:1024 lds
    v_mfma_f32_16x16x32_bf16 v[140:143], v[68:71], a[92:95], v[140:143]
    s_waitcnt lgkmcnt(6)
    ds_read_b64_tr_b16 v[68:69], v15 offset:14336
    v_mfma_f32_16x16x32_bf16 v[144:147], v[16:19], a[88:91], v[144:147]
    ds_read_b64_tr_b16 v[70:71], v15 offset:20480
    v_mfma_f32_16x16x32_bf16 v[148:151], v[16:19], a[92:95], v[148:151]
    s_waitcnt vmcnt(33)
    s_barrier
    ds_read_b64_tr_b16 v[16:17], v10 offset:24576
    v_mfma_f32_16x16x32_bf16 v[152:155], v[20:23], a[88:91], v[152:155]
    ds_read_b64_tr_b16 v[18:19], v10 offset:30720
    buffer_load_dwordx4 v248, s[84:87], s80 offen offset:2048 lds
    v_mfma_f32_16x16x32_bf16 v[156:159], v[20:23], a[92:95], v[156:159]
    s_waitcnt lgkmcnt(6)
    ds_read_b64_tr_b16 v[20:21], v11 offset:24576
    v_mfma_f32_16x16x32_bf16 v[160:163], v[24:27], a[88:91], v[160:163]
    ds_read_b64_tr_b16 v[22:23], v11 offset:30720
    v_mfma_f32_16x16x32_bf16 v[164:167], v[24:27], a[92:95], v[164:167]
    ds_read_b64_tr_b16 v[24:25], v13 offset:24576
    v_mfma_f32_16x16x32_bf16 v[168:171], v[28:31], a[88:91], v[168:171]
    ds_read_b64_tr_b16 v[26:27], v13 offset:30720
    buffer_load_dwordx4 a[72:75], v249, s[20:23], s81 offen offset:1024 sc1
    v_mfma_f32_16x16x32_bf16 v[172:175], v[28:31], a[92:95], v[172:175]
    s_waitcnt lgkmcnt(6)
    ds_read_b64_tr_b16 v[28:29], v15 offset:24576
    v_mfma_f32_16x16x32_bf16 v[176:179], v[64:67], a[88:91], v[176:179]
    ds_read_b64_tr_b16 v[30:31], v15 offset:30720
    v_mfma_f32_16x16x32_bf16 v[180:183], v[64:67], a[92:95], v[180:183]
    ds_read_b64_tr_b16 v[64:65], v10 offset:25600
    v_mfma_f32_16x16x32_bf16 v[184:187], v[68:71], a[88:91], v[184:187]
    ds_read_b64_tr_b16 v[66:67], v10 offset:31744
    buffer_load_dwordx4 a[76:79], v250, s[20:23], s81 offen offset:1024 sc1
    v_mfma_f32_16x16x32_bf16 v[188:191], v[68:71], a[92:95], v[188:191]
    s_waitcnt lgkmcnt(6)
    ds_read_b64_tr_b16 v[68:69], v11 offset:25600
    ds_read_b64_tr_b16 v[70:71], v11 offset:31744
    s_mov_b32 s75, s76
    s_mov_b32 s76, s77
    s_sub_u32 s82, s82, 6
    s_cmp_eq_u32 s82, 0
    s_cbranch_scc0 C_loop
C_done:
    s_add_u32 s76, s97, 0
    s_add_u32 s77, s97, 12288
    s_add_u32 s78, s97, 24576
    s_add_u32 s79, s97, 36864
    s_add_u32 s80, s97, 49152
    v_min_u32 v3, 4, v0
    v_add_u32 v3, 1, v3
    v_xor_b32 v4, s69, v3
    v_cmp_gt_u32 vcc, 4, v3
    s_nop 1
    v_cndmask_b32 v3, v3, v4, vcc
    v_lshlrev_b32 v244, 2, v3
    v_cvt_pk_bf16_f32 v192, v104, v105
    v_cvt_pk_bf16_f32 v193, v106, v107
    v_cvt_pk_bf16_f32 v194, v108, v109
    v_cvt_pk_bf16_f32 v195, v110, v111
    buffer_store_dwordx4 v[192:195], v251, s[20:23], s94 offen offset:0 sc1
    v_cvt_pk_bf16_f32 v196, v136, v137
    v_cvt_pk_bf16_f32 v197, v138, v139
    v_cvt_pk_bf16_f32 v198, v140, v141
    v_cvt_pk_bf16_f32 v199, v142, v143
    buffer_store_dwordx4 v[196:199], v251, s[20:23], s94 offen offset:1024 sc1
    v_cvt_pk_bf16_f32 v200, v168, v169
    v_cvt_pk_bf16_f32 v201, v170, v171
    v_cvt_pk_bf16_f32 v202, v172, v173
    v_cvt_pk_bf16_f32 v203, v174, v175
    buffer_store_dwordx4 v[200:203], v251, s[20:23], s94 offen offset:2048 sc1
    v_cvt_pk_bf16_f32 v204, v112, v113
    v_cvt_pk_bf16_f32 v205, v114, v115
    v_cvt_pk_bf16_f32 v206, v116, v117
    v_cvt_pk_bf16_f32 v207, v118, v119
    buffer_store_dwordx4 v[204:207], v251, s[20:23], s95 offen offset:0 sc1
    v_cvt_pk_bf16_f32 v208, v144, v145
    v_cvt_pk_bf16_f32 v209, v146, v147
    v_cvt_pk_bf16_f32 v210, v148, v149
    v_cvt_pk_bf16_f32 v211, v150, v151
    buffer_store_dwordx4 v[208:211], v251, s[20:23], s95 offen offset:1024 sc1
    v_cvt_pk_bf16_f32 v212, v176, v177
    v_cvt_pk_bf16_f32 v213, v178, v179
    v_cvt_pk_bf16_f32 v214, v180, v181
    v_cvt_pk_bf16_f32 v215, v182, v183
    buffer_store_dwordx4 v[212:215], v251, s[20:23], s95 offen offset:2048 sc1
    v_cvt_pk_bf16_f32 v216, v120, v121
    v_cvt_pk_bf16_f32 v217, v122, v123
    v_cvt_pk_bf16_f32 v218, v124, v125
    v_cvt_pk_bf16_f32 v219, v126, v127
    buffer_store_dwordx4 v[216:219], v251, s[20:23], s96 offen offset:0 sc1
    v_cvt_pk_bf16_f32 v220, v152, v153
    v_cvt_pk_bf16_f32 v221, v154, v155
    v_cvt_pk_bf16_f32 v222, v156, v157
    v_cvt_pk_bf16_f32 v223, v158, v159
    buffer_store_dwordx4 v[220:223], v251, s[20:23], s96 offen offset:1024 sc1
    v_cvt_pk_bf16_f32 v224, v184, v185
    v_cvt_pk_bf16_f32 v225, v186, v187
    v_cvt_pk_bf16_f32 v226, v188, v189
    v_cvt_pk_bf16_f32 v227, v190, v191
    buffer_store_dwordx4 v[224:227], v251, s[20:23], s96 offen offset:2048 sc1
    s_cmp_eq_u32 s68, 0
    s_cbranch_scc1 C_sent
    v_cvt_pk_bf16_f32 v32, v96, v97
    v_cvt_pk_bf16_f32 v33, v98, v99
    v_cvt_pk_bf16_f32 v34, v100, v101
    v_cvt_pk_bf16_f32 v35, v102, v103
    buffer_store_dwordx4 v[32:35], v251, s[20:23], s97 offen offset:0 sc1
    v_cvt_pk_bf16_f32 v36, v128, v129
    v_cvt_pk_bf16_f32 v37, v130, v131
    v_cvt_pk_bf16_f32 v38, v132, v133
    v_cvt_pk_bf16_f32 v39, v134, v135
    buffer_store_dwordx4 v[36:39], v251, s[20:23], s97 offen offset:1024 sc1
    v_cvt_pk_bf16_f32 v40, v160, v161
    v_cvt_pk_bf16_f32 v41, v162, v163
    v_cvt_pk_bf16_f32 v42, v164, v165
    v_cvt_pk_bf16_f32 v43, v166, v167
    buffer_store_dwordx4 v[40:43], v251, s[20:23], s97 offen offset:2048 sc1
    v_mov_b32 v2, s39
    s_waitcnt vmcnt(0)
    buffer_store_dword v2, off, s[20:23], s63 sc1
    s_branch C_fin
C_sent:
    buffer_load_dword v4, v244, s[20:23], s62 offen sc1
    v_mov_b32 v2, s39
    s_waitcnt vmcnt(1)
    buffer_store_dword v2, off, s[20:23], s63 sc1
    s_waitcnt vmcnt(1)
    s_mov_b32 s3, 0
    s_branch P_x_t
P_x:
    s_add_u32 s3, s3, 1
    s_cmp_gt_u32 s3, 1000000
    s_cbranch_scc1 P_x_ok
    buffer_load_dword v4, v244, s[20:23], s62 offen sc1
    s_waitcnt vmcnt(0)
P_x_t:
    v_cmp_ne_u32 vcc, s39, v4
    s_nop 1
    s_cmp_eq_u64 vcc, 0
    s_cbranch_scc1 P_x_ok
    s_sleep 2
    s_branch P_x
P_x_ok:
    buffer_load_dwordx4 v[32:35], v251, s[20:23], s76 offen offset:0 sc1
    buffer_load_dwordx4 v[192:195], v251, s[20:23], s77 offen offset:0 sc1
    buffer_load_dwordx4 v[196:199], v251, s[20:23], s78 offen offset:0 sc1
    buffer_load_dwordx4 v[200:203], v251, s[20:23], s79 offen offset:0 sc1
    buffer_load_dwordx4 v[36:39], v251, s[20:23], s80 offen offset:0 sc1
    buffer_load_dwordx4 v[40:43], v251, s[20:23], s76 offen offset:1024 sc1
    buffer_load_dwordx4 v[204:207], v251, s[20:23], s77 offen offset:1024 sc1
    buffer_load_dwordx4 v[208:211], v251, s[20:23], s78 offen offset:1024 sc1
    buffer_load_dwordx4 v[212:215], v251, s[20:23], s79 offen offset:1024 sc1
    buffer_load_dwordx4 v[44:47], v251, s[20:23], s80 offen offset:1024 sc1
    buffer_load_dwordx4 v[48:51], v251, s[20:23], s76 offen offset:2048 sc1
    buffer_load_dwordx4 v[216:219], v251, s[20:23], s77 offen offset:2048 sc1
    buffer_load_dwordx4 v[220:223], v251, s[20:23], s78 offen offset:2048 sc1
    buffer_load_dwordx4 v[224:227], v251, s[20:23], s79 offen offset:2048 sc1
    buffer_load_dwordx4 v[52:55], v251, s[20:23], s80 offen offset:2048 sc1
    v_mov_b32 v4, s40
    v_mov_b32 v5, s40
    s_waitcnt vmcnt(10)
    v_lshlrev_b32 v16, 16, v192
    v_and_b32 v17, s41, v192
    v_lshlrev_b32 v18, 16, v193
    v_and_b32 v19, s41, v193
    v_lshlrev_b32 v20, 16, v194
    v_and_b32 v21, s41, v194
    v_lshlrev_b32 v22, 16, v195
    v_and_b32 v23, s41, v195
    v_pk_add_f32 v[96:97], v[96:97], v[16:17]
    v_pk_add_f32 v[98:99], v[98:99], v[18:19]
    v_pk_add_f32 v[100:101], v[100:101], v[20:21]
    v_pk_add_f32 v[102:103], v[102:103], v[22:23]
    v_lshlrev_b32 v24, 16, v196
    v_and_b32 v25, s41, v196
    v_lshlrev_b32 v26, 16, v197
    v_and_b32 v27, s41, v197
    v_lshlrev_b32 v28, 16, v198
    v_and_b32 v29, s41, v198
    v_lshlrev_b32 v30, 16, v199
    v_and_b32 v31, s41, v199
    v_pk_add_f32 v[96:97], v[96:97], v[24:25]
    v_pk_add_f32 v[98:99], v[98:99], v[26:27]
    v_pk_add_f32 v[100:101], v[100:101], v[28:29]
    v_pk_add_f32 v[102:103], v[102:103], v[30:31]
    v_lshlrev_b32 v16, 16, v200
    v_and_b32 v17, s41, v200
    v_lshlrev_b32 v18, 16, v201
    v_and_b32 v19, s41, v201
    v_lshlrev_b32 v20, 16, v202
    v_and_b32 v21, s41, v202
    v_lshlrev_b32 v22, 16, v203
    v_and_b32 v23, s41, v203
    v_pk_add_f32 v[96:97], v[96:97], v[16:17]
    v_pk_add_f32 v[98:99], v[98:99], v[18:19]
    v_pk_add_f32 v[100:101], v[100:101], v[20:21]
    v_pk_add_f32 v[102:103], v[102:103], v[22:23]
    v_pk_mul_f32 v[16:17], v[96:97], v[4:5]
    v_pk_mul_f32 v[18:19], v[98:99], v[4:5]
    v_pk_mul_f32 v[20:21], v[100:101], v[4:5]
    v_pk_mul_f32 v[22:23], v[102:103], v[4:5]
    v_exp_f32 v16, v16
    v_exp_f32 v17, v17
    v_exp_f32 v18, v18
    v_exp_f32 v19, v19
    v_exp_f32 v20, v20
    v_exp_f32 v21, v21
    v_exp_f32 v22, v22
    v_exp_f32 v23, v23
    v_lshlrev_b32 v64, 16, v32
    v_and_b32 v65, s41, v32
    v_lshlrev_b32 v66, 16, v33
    v_and_b32 v67, s41, v33
    v_lshlrev_b32 v68, 16, v34
    v_and_b32 v69, s41, v34
    v_lshlrev_b32 v70, 16, v35
    v_and_b32 v71, s41, v35
    v_pk_add_f32 v[16:17], v[16:17], 1.0 op_sel_hi:[1,0]
    v_pk_add_f32 v[18:19], v[18:19], 1.0 op_sel_hi:[1,0]
    v_pk_add_f32 v[20:21], v[20:21], 1.0 op_sel_hi:[1,0]
    v_pk_add_f32 v[22:23], v[22:23], 1.0 op_sel_hi:[1,0]
    v_rcp_f32 v16, v16
    v_rcp_f32 v17, v17
    v_rcp_f32 v18, v18
    v_rcp_f32 v19, v19
    v_rcp_f32 v20, v20
    v_rcp_f32 v21, v21
    v_rcp_f32 v22, v22
    v_rcp_f32 v23, v23
    v_lshlrev_b32 v72, 16, v36
    v_and_b32 v73, s41, v36
    v_lshlrev_b32 v74, 16, v37
    v_and_b32 v75, s41, v37
    v_lshlrev_b32 v76, 16, v38
    v_and_b32 v77, s41, v38
    v_lshlrev_b32 v78, 16, v39
    v_and_b32 v79, s41, v39
    v_pk_mul_f32 v[64:65], v[64:65], v[96:97]
    v_pk_mul_f32 v[66:67], v[66:67], v[98:99]
    v_pk_mul_f32 v[68:69], v[68:69], v[100:101]
    v_pk_mul_f32 v[70:71], v[70:71], v[102:103]
    v_pk_fma_f32 v[72:73], v[16:17], v[64:65], v[72:73]
    v_pk_fma_f32 v[74:75], v[18:19], v[66:67], v[74:75]
    v_pk_fma_f32 v[76:77], v[20:21], v[68:69], v[76:77]
    v_pk_fma_f32 v[78:79], v[22:23], v[70:71], v[78:79]
    v_cvt_pk_bf16_f32 v36, v72, v73
    v_cvt_pk_bf16_f32 v37, v74, v75
    v_cvt_pk_bf16_f32 v38, v76, v77
    v_cvt_pk_bf16_f32 v39, v78, v79
    global_store_dwordx2 v252, v[36:37], s[90:91] offset:0
    global_store_dwordx2 v253, v[38:39], s[90:91] offset:0
    s_waitcnt vmcnt(7)
    v_lshlrev_b32 v16, 16, v204
    v_and_b32 v17, s41, v204
    v_lshlrev_b32 v18, 16, v205
    v_and_b32 v19, s41, v205
    v_lshlrev_b32 v20, 16, v206
    v_and_b32 v21, s41, v206
    v_lshlrev_b32 v22, 16, v207
    v_and_b32 v23, s41, v207
    v_pk_add_f32 v[128:129], v[128:129], v[16:17]
    v_pk_add_f32 v[130:131], v[130:131], v[18:19]
    v_pk_add_f32 v[132:133], v[132:133], v[20:21]
    v_pk_add_f32 v[134:135], v[134:135], v[22:23]
    v_lshlrev_b32 v24, 16, v208
    v_and_b32 v25, s41, v208
    v_lshlrev_b32 v26, 16, v209
    v_and_b32 v27, s41, v209
    v_lshlrev_b32 v28, 16, v210
    v_and_b32 v29, s41, v210
    v_lshlrev_b32 v30, 16, v211
    v_and_b32 v31, s41, v211
    v_pk_add_f32 v[128:129], v[128:129], v[24:25]
    v_pk_add_f32 v[130:131], v[130:131], v[26:27]
    v_pk_add_f32 v[132:133], v[132:133], v[28:29]
    v_pk_add_f32 v[134:135], v[134:135], v[30:31]
    v_lshlrev_b32 v16, 16, v212
    v_and_b32 v17, s41, v212
    v_lshlrev_b32 v18, 16, v213
    v_and_b32 v19, s41, v213
    v_lshlrev_b32 v20, 16, v214
    v_and_b32 v21, s41, v214
    v_lshlrev_b32 v22, 16, v215
    v_and_b32 v23, s41, v215
    v_pk_add_f32 v[128:129], v[128:129], v[16:17]
    v_pk_add_f32 v[130:131], v[130:131], v[18:19]
    v_pk_add_f32 v[132:133], v[132:133], v[20:21]
    v_pk_add_f32 v[134:135], v[134:135], v[22:23]
    v_pk_mul_f32 v[16:17], v[128:129], v[4:5]
    v_pk_mul_f32 v[18:19], v[130:131], v[4:5]
    v_pk_mul_f32 v[20:21], v[132:133], v[4:5]
    v_pk_mul_f32 v[22:23], v[134:135], v[4:5]
    v_exp_f32 v16, v16
    v_exp_f32 v17, v17
    v_exp_f32 v18, v18
    v_exp_f32 v19, v19
    v_exp_f32 v20, v20
    v_exp_f32 v21, v21
    v_exp_f32 v22, v22
    v_exp_f32 v23, v23
    v_lshlrev_b32 v64, 16, v40
    v_and_b32 v65, s41, v40
    v_lshlrev_b32 v66, 16, v41
    v_and_b32 v67, s41, v41
    v_lshlrev_b32 v68, 16, v42
    v_and_b32 v69, s41, v42
    v_lshlrev_b32 v70, 16, v43
    v_and_b32 v71, s41, v43
    v_pk_add_f32 v[16:17], v[16:17], 1.0 op_sel_hi:[1,0]
    v_pk_add_f32 v[18:19], v[18:19], 1.0 op_sel_hi:[1,0]
    v_pk_add_f32 v[20:21], v[20:21], 1.0 op_sel_hi:[1,0]
    v_pk_add_f32 v[22:23], v[22:23], 1.0 op_sel_hi:[1,0]
    v_rcp_f32 v16, v16
    v_rcp_f32 v17, v17
    v_rcp_f32 v18, v18
    v_rcp_f32 v19, v19
    v_rcp_f32 v20, v20
    v_rcp_f32 v21, v21
    v_rcp_f32 v22, v22
    v_rcp_f32 v23, v23
    v_lshlrev_b32 v72, 16, v44
    v_and_b32 v73, s41, v44
    v_lshlrev_b32 v74, 16, v45
    v_and_b32 v75, s41, v45
    v_lshlrev_b32 v76, 16, v46
    v_and_b32 v77, s41, v46
    v_lshlrev_b32 v78, 16, v47
    v_and_b32 v79, s41, v47
    v_pk_mul_f32 v[64:65], v[64:65], v[128:129]
    v_pk_mul_f32 v[66:67], v[66:67], v[130:131]
    v_pk_mul_f32 v[68:69], v[68:69], v[132:133]
    v_pk_mul_f32 v[70:71], v[70:71], v[134:135]
    v_pk_fma_f32 v[72:73], v[16:17], v[64:65], v[72:73]
    v_pk_fma_f32 v[74:75], v[18:19], v[66:67], v[74:75]
    v_pk_fma_f32 v[76:77], v[20:21], v[68:69], v[76:77]
    v_pk_fma_f32 v[78:79], v[22:23], v[70:71], v[78:79]
    v_cvt_pk_bf16_f32 v44, v72, v73
    v_cvt_pk_bf16_f32 v45, v74, v75
    v_cvt_pk_bf16_f32 v46, v76, v77
    v_cvt_pk_bf16_f32 v47, v78, v79
    global_store_dwordx2 v252, v[44:45], s[90:91] offset:128
    global_store_dwordx2 v253, v[46:47], s[90:91] offset:128
    s_waitcnt vmcnt(4)
    v_lshlrev_b32 v16, 16, v216
    v_and_b32 v17, s41, v216
    v_lshlrev_b32 v18, 16, v217
    v_and_b32 v19, s41, v217
    v_lshlrev_b32 v20, 16, v218
    v_and_b32 v21, s41, v218
    v_lshlrev_b32 v22, 16, v219
    v_and_b32 v23, s41, v219
    v_pk_add_f32 v[160:161], v[160:161], v[16:17]
    v_pk_add_f32 v[162:163], v[162:163], v[18:19]
    v_pk_add_f32 v[164:165], v[164:165], v[20:21]
    v_pk_add_f32 v[166:167], v[166:167], v[22:23]
    v_lshlrev_b32 v24, 16, v220
    v_and_b32 v25, s41, v220
    v_lshlrev_b32 v26, 16, v221
    v_and_b32 v27, s41, v221
    v_lshlrev_b32 v28, 16, v222
    v_and_b32 v29, s41, v222
    v_lshlrev_b32 v30, 16, v223
    v_and_b32 v31, s41, v223
    v_pk_add_f32 v[160:161], v[160:161], v[24:25]
    v_pk_add_f32 v[162:163], v[162:163], v[26:27]
    v_pk_add_f32 v[164:165], v[164:165], v[28:29]
    v_pk_add_f32 v[166:167], v[166:167], v[30:31]
    v_lshlrev_b32 v16, 16, v224
    v_and_b32 v17, s41, v224
    v_lshlrev_b32 v18, 16, v225
    v_and_b32 v19, s41, v225
    v_lshlrev_b32 v20, 16, v226
    v_and_b32 v21, s41, v226
    v_lshlrev_b32 v22, 16, v227
    v_and_b32 v23, s41, v227
    v_pk_add_f32 v[160:161], v[160:161], v[16:17]
    v_pk_add_f32 v[162:163], v[162:163], v[18:19]
    v_pk_add_f32 v[164:165], v[164:165], v[20:21]
    v_pk_add_f32 v[166:167], v[166:167], v[22:23]
    v_pk_mul_f32 v[16:17], v[160:161], v[4:5]
    v_pk_mul_f32 v[18:19], v[162:163], v[4:5]
    v_pk_mul_f32 v[20:21], v[164:165], v[4:5]
    v_pk_mul_f32 v[22:23], v[166:167], v[4:5]
    v_exp_f32 v16, v16
    v_exp_f32 v17, v17
    v_exp_f32 v18, v18
    v_exp_f32 v19, v19
    v_exp_f32 v20, v20
    v_exp_f32 v21, v21
    v_exp_f32 v22, v22
    v_exp_f32 v23, v23
    v_lshlrev_b32 v64, 16, v48
    v_and_b32 v65, s41, v48
    v_lshlrev_b32 v66, 16, v49
    v_and_b32 v67, s41, v49
    v_lshlrev_b32 v68, 16, v50
    v_and_b32 v69, s41, v50
    v_lshlrev_b32 v70, 16, v51
    v_and_b32 v71, s41, v51
    v_pk_add_f32 v[16:17], v[16:17], 1.0 op_sel_hi:[1,0]
    v_pk_add_f32 v[18:19], v[18:19], 1.0 op_sel_hi:[1,0]
    v_pk_add_f32 v[20:21], v[20:21], 1.0 op_sel_hi:[1,0]
    v_pk_add_f32 v[22:23], v[22:23], 1.0 op_sel_hi:[1,0]
    v_rcp_f32 v16, v16
    v_rcp_f32 v17, v17
    v_rcp_f32 v18, v18
    v_rcp_f32 v19, v19
    v_rcp_f32 v20, v20
    v_rcp_f32 v21, v21
    v_rcp_f32 v22, v22
    v_rcp_f32 v23, v23
    v_lshlrev_b32 v72, 16, v52
    v_and_b32 v73, s41, v52
    v_lshlrev_b32 v74, 16, v53
    v_and_b32 v75, s41, v53
    v_lshlrev_b32 v76, 16, v54
    v_and_b32 v77, s41, v54
    v_lshlrev_b32 v78, 16, v55
    v_and_b32 v79, s41, v55
    v_pk_mul_f32 v[64:65], v[64:65], v[160:161]
    v_pk_mul_f32 v[66:67], v[66:67], v[162:163]
    v_pk_mul_f32 v[68:69], v[68:69], v[164:165]
    v_pk_mul_f32 v[70:71], v[70:71], v[166:167]
    v_pk_fma_f32 v[72:73], v[16:17], v[64:65], v[72:73]
    v_pk_fma_f32 v[74:75], v[18:19], v[66:67], v[74:75]
    v_pk_fma_f32 v[76:77], v[20:21], v[68:69], v[76:77]
    v_pk_fma_f32 v[78:79], v[22:23], v[70:71], v[78:79]
    v_cvt_pk_bf16_f32 v52, v72, v73
    v_cvt_pk_bf16_f32 v53, v74, v75
    v_cvt_pk_bf16_f32 v54, v76, v77
    v_cvt_pk_bf16_f32 v55, v78, v79
    global_store_dwordx2 v252, v[52:53], s[90:91] offset:256
    global_store_dwordx2 v253, v[54:55], s[90:91] offset:256
C_fin:
KF_end:
KF_last:
    s_endpgm
.section .rodata,"a"
.p2align 6
.amdhsa_kernel recurrent_scan__sliding_local_dilated__swiglu_ffn__prompt_kernel
  .amdhsa_next_free_vgpr 512
  .amdhsa_next_free_sgpr 102
  .amdhsa_accum_offset 256
  .amdhsa_group_segment_fixed_size 0
  .amdhsa_kernarg_size 80
  .amdhsa_user_sgpr_count 2
  .amdhsa_user_sgpr_kernarg_segment_ptr 1
  .amdhsa_system_sgpr_workgroup_id_x 1
.end_amdhsa_kernel
```
